```python
import torch

def _softmax(x, axis=-1):
    return torch.softmax(x, dim=axis)
def _gelu(x):
    return torch.nn.functional.gelu(x, approximate="tanh")
def _silu(x):
    return torch.nn.functional.silu(x)
def _sigmoid(x):
    return torch.sigmoid(x)
def _layernorm(x, axis=-1, eps=1e-5):
    m = x.mean(dim=axis, keepdim=True)
    v = x.var(dim=axis, keepdim=True, unbiased=False)
    return (x - m) / torch.sqrt(v + eps)
def _scatter_add(tgt, idx, src, axis=0):
    return tgt.clone().index_add_(axis, idx, src)
def _segment_sum(src, seg, n):
    out = torch.zeros((n,) + src.shape[1:], dtype=src.dtype)
    return out.index_add_(0, seg, src)
def _pad(x, pw):
    flat = tuple(v for pair in reversed(pw) for v in pair)
    return torch.nn.functional.pad(x, flat)

kernel_name = 'recurrent_scan__sliding_block_cached__geglu_ffn__prompt'

def setup_inputs():

    _w = (lambda a: (lambda t: t.to(torch.bfloat16) if t.is_floating_point() else t)(torch.as_tensor(a)))
    def _A_setup():
        B, Sq, D = 1, 2048, 1024
        Hq, Hkv, Sk, Dh = 32, 4, 2048, 128
        assert Hq % Hkv == 0, (Hq, Hkv)
        return {
            "x": _w((lambda *s: torch.randn(*s, dtype=torch.bfloat16) * 0.05)(B, Sq, D)),
            "k_cache": _w((lambda *s: torch.randn(*s, dtype=torch.bfloat16) * 0.8)(B, Hkv, Sk, Dh)),
            "v_cache": _w((lambda *s: torch.randn(*s, dtype=torch.bfloat16) * 0.2)(B, Hkv, Sk, Dh)),
            "wq": _w((lambda *s: torch.randn(*s, dtype=torch.bfloat16) * 0.8)(D, Hq * Dh) * (D ** -0.5)),
            "wo": _w((lambda *s: torch.randn(*s, dtype=torch.bfloat16) * 0.2)(Hq * Dh, D) * ((Hq * Dh) ** -0.5)),
        }
    _A_in = _A_setup()

    def _B_setup():
        B, S, D, F = 1, 2048, 1024, 3584
        return {
            "x": _w((lambda *s: torch.randn(*s, dtype=torch.bfloat16) * 0.05)(B, S, D)),
            "w_gate": _w((lambda *s: torch.randn(*s, dtype=torch.bfloat16) * 0.1)(D, F)),
            "w_up": _w((lambda *s: torch.randn(*s, dtype=torch.bfloat16) * 0.1)(D, F)),
            "w_down": _w((lambda *s: torch.randn(*s, dtype=torch.bfloat16) * 0.1)(F, D)),
        }
    _B_in = _B_setup()

    return {
        "A_x": _A_in["x"],
        "A_k_cache": _A_in["k_cache"],
        "A_v_cache": _A_in["v_cache"],
        "A_wq": _A_in["wq"],
        "A_wo": _A_in["wo"],
        "B_x": _B_in["x"],
        "B_w_gate": _B_in["w_gate"],
        "B_w_up": _B_in["w_up"],
        "B_w_down": _B_in["w_down"],
    }

def reference(A_x, A_k_cache, A_v_cache, A_wq, A_wo, B_x, B_w_gate, B_w_up, B_w_down):
    def _A_ref(x, k_cache, v_cache, wq, wo):
        B, Sq, D = x.shape
        Hq, Dh = 32, 128
        Hkv, Sk = k_cache.shape[1], k_cache.shape[2]
        W = min(4096, max(256, Sk // 4))
        rep = Hq // Hkv
        q = (lambda x, *d: x.permute(*d))((x @ wq).reshape(B, Sq, Hq, Dh), 0, 2, 1, 3)
        k = (lambda x, n, axis: torch.repeat_interleave(x, n, dim=axis))(k_cache[:, :, Sk - W:, :], rep, axis=1)
        v = (lambda x, n, axis: torch.repeat_interleave(x, n, dim=axis))(v_cache[:, :, Sk - W:, :], rep, axis=1)
        scores = torch.einsum("bhqd,bhkd->bhqk", q, k) * (Dh ** -0.5)
        p = _softmax(scores, axis=-1)
        o = torch.einsum("bhqk,bhkd->bhqd", p, v)
        return (lambda x, *d: x.permute(*d))(o, 0, 2, 1, 3).reshape(B, Sq, Hq * Dh) @ wo

    def _B_ref(x, w_gate, w_up, w_down):
        return (_gelu(x @ w_gate) * (x @ w_up)) @ w_down

    x = A_x
    xn = _layernorm(x, axis=-1)
    s = _A_ref(xn, A_k_cache, A_v_cache, A_wq, A_wo)
    g = _silu(_B_ref(xn, B_w_gate, B_w_up, B_w_down))
    return x + s * g
```

```asm
; @launch grid=(256,1,1) block=(256,1,1) lds=163840
.amdgcn_target "amdgcn-amd-amdhsa--gfx950"
.text
.globl recurrent_scan__sliding_block_cached__geglu_ffn__prompt_kernel
.p2align 8
.type recurrent_scan__sliding_block_cached__geglu_ffn__prompt_kernel,@function
recurrent_scan__sliding_block_cached__geglu_ffn__prompt_kernel:
    s_cmp_ge_u32 s2, 256
    s_cbranch_scc1 L_done
    s_getpc_b64 s[74:75]
    v_lshrrev_b32 v60, 2, v0
    v_lshlrev_b32 v60, 7, v60
    global_load_dword v60, v60, s[74:75] offset:128
    s_load_dwordx2 s[36:37], s[0:1], 0
    s_load_dwordx2 s[10:11], s[0:1], 88
    s_load_dwordx2 s[8:9], s[0:1], 24
    s_load_dwordx4 s[12:15], s[0:1], 48
    s_load_dwordx4 s[4:7], s[0:1], 8
    s_load_dwordx2 s[28:29], s[0:1], 32
    s_load_dwordx2 s[32:33], s[0:1], 64
    v_mov_b32 v31, v0
    v_lshrrev_b32 v24, 6, v0
    v_and_b32 v0, 63, v0
    v_lshlrev_b32 v1, 4, v0
    v_lshl_add_u32 v25, v24, 12, v1
    s_mov_b32 s38, 4194304
    s_mov_b32 s39, 0x20000
    s_lshl_b32 s3, s2, 14
    v_readfirstlane_b32 s44, v24
    s_waitcnt lgkmcnt(0)
    buffer_load_dwordx4 v[32:35], v25, s[36:39], s3 offen offset:0
    buffer_load_dwordx4 v[36:39], v25, s[36:39], s3 offen offset:1024
    buffer_load_dwordx4 v[40:43], v25, s[36:39], s3 offen offset:2048
    buffer_load_dwordx4 v[44:47], v25, s[36:39], s3 offen offset:3072
    s_add_u32 s16, s10, 245366784
    s_addc_u32 s17, s11, 0
    s_load_dword s54, s[16:17], 0
    s_lshr_b32 s45, s2, 5
    s_and_b32 s46, s2, 7
    s_lshl_b32 s46, s46, 2
    s_bfe_u32 s49, s2, 0x20003
    s_add_u32 s46, s46, s49
    s_lshl_b32 s48, s45, 2
    s_add_u32 s48, s48, s44
    v_add_u32 v24, 0, v0
    v_mul_u32_u24 v25, 4682, v24
    v_lshrrev_b32 v25, 16, v25
    v_mul_u32_u24 v27, 6944, v25
    v_lshl_add_u32 v3, v24, 4, v27
    v_add_u32 v24, 64, v0
    v_mul_u32_u24 v25, 4682, v24
    v_lshrrev_b32 v25, 16, v25
    v_mul_u32_u24 v27, 6944, v25
    v_lshl_add_u32 v4, v24, 4, v27
    v_subrev_u32 v4, 1024, v4
    v_add_u32 v24, 128, v0
    v_mul_u32_u24 v25, 4682, v24
    v_lshrrev_b32 v25, 16, v25
    v_mul_u32_u24 v27, 6944, v25
    v_lshl_add_u32 v5, v24, 4, v27
    v_subrev_u32 v5, 2048, v5
    v_add_u32 v24, 192, v0
    v_mul_u32_u24 v25, 4682, v24
    v_lshrrev_b32 v25, 16, v25
    v_mul_u32_u24 v27, 6944, v25
    v_lshl_add_u32 v6, v24, 4, v27
    v_subrev_u32 v6, 3072, v6
    v_add_u32 v24, 256, v0
    v_mul_u32_u24 v25, 4682, v24
    v_lshrrev_b32 v25, 16, v25
    v_mul_u32_u24 v27, 6944, v25
    v_lshl_add_u32 v7, v24, 4, v27
    v_add_u32 v24, 320, v0
    v_mul_u32_u24 v25, 4682, v24
    v_lshrrev_b32 v25, 16, v25
    v_mul_u32_u24 v27, 6944, v25
    v_lshl_add_u32 v8, v24, 4, v27
    v_subrev_u32 v8, 1024, v8
    v_add_u32 v24, 384, v0
    v_mul_u32_u24 v25, 4682, v24
    v_lshrrev_b32 v25, 16, v25
    v_mul_u32_u24 v27, 6944, v25
    v_lshl_add_u32 v9, v24, 4, v27
    v_subrev_u32 v9, 2048, v9
    s_mov_b32 s58, 0
    s_mov_b32 s59, 0
    s_mov_b32 s60, 128
    s_mov_b32 s64, 0
    s_lshr_b32 s49, s44, 1
    s_mul_i32 s61, s49, 7168
    s_mul_i32 s53, s49, 229376
    s_mul_i32 s50, s46, 224
    s_add_u32 s53, s53, s50
    s_and_b32 s49, s44, 1
    s_mul_i32 s50, s49, 14336
    s_add_u32 s61, s61, s50
    s_sub_u32 s22, 7340032, s53
    s_mov_b32 s23, 0x20000
    s_cmp_eq_u32 s49, 0
    s_cselect_b32 s20, s12, s14
    s_cselect_b32 s21, s13, s15
    s_add_u32 s20, s20, s53
    s_addc_u32 s21, s21, 0
    s_add_u32 m0, s64, s61
    s_nop 0
    buffer_load_dwordx4 v3, s[20:23], s58 offen offset:0 lds
    buffer_load_dwordx4 v4, s[20:23], s58 offen offset:1024 lds
    buffer_load_dwordx4 v5, s[20:23], s58 offen offset:2048 lds
    buffer_load_dwordx4 v6, s[20:23], s58 offen offset:3072 lds
    v_bfe_u32 v24, v0, 1, 2
    v_lshrrev_b32 v25, 4, v0
    v_xor_b32 v24, v24, v25
    v_lshlrev_b32 v24, 5, v24
    v_and_b32 v25, 1, v0
    v_lshl_add_u32 v24, v25, 4, v24
    v_lshrrev_b32 v25, 3, v0
    v_lshl_add_u32 v10, v25, 13, v24
    v_add_u32 v11, 64512, v10
    s_lshl_b32 s62, s44, 11
    s_add_u32 s62, s62, 28672
    s_lshl_b32 s49, s44, 17
    s_lshl_b32 s50, s46, 8
    s_add_u32 s49, s49, s50
    s_add_u32 s24, s8, s49
    s_addc_u32 s25, s9, 0
    s_sub_u32 s26, 8388608, s49
    s_mov_b32 s27, 0x20000
    s_mov_b32 s12, s16
    s_mov_b32 s13, s17
    s_mov_b32 s14, 167936
    s_mov_b32 s15, 0x20000
    v_lshrrev_b32 v48, 2, v0
    v_mul_u32_u24 v48, 656, v48
    v_and_b32 v49, 1, v0
    v_mul_u32_u24 v49, 320, v49
    v_add_u32 v48, v48, v49
    v_bfe_u32 v49, v0, 1, 1
    v_lshl_add_u32 v48, v49, 3, v48
    s_lshl_b32 s49, s44, 5
    s_add_u32 s49, s49, 135168
    v_add_u32 v48, s49, v48
    v_lshrrev_b32 v50, 5, v31
    v_mul_u32_u24 v49, 656, v50
    v_bfe_u32 v51, v31, 3, 2
    v_mul_u32_u24 v52, 160, v51
    v_add_u32 v49, v49, v52
    v_and_b32 v52, 7, v31
    v_lshl_add_u32 v49, v52, 4, v49
    v_add_u32 v49, 135168, v49
    s_bfe_u32 s49, s2, 0x20001
    s_and_b32 s50, s2, 1
    v_and_b32 v50, 1, v50
    v_lshl_add_u32 v50, v50, 2, s49
    v_lshl_add_u32 v53, v51, 1, s50
    v_cmp_le_u32 vcc, 3, v50
    v_lshl_add_u32 v54, v50, 3, v53
    v_add_u32 v50, 64, v50
    v_addc_co_u32 v50, vcc, 0, v50, vcc
    v_cmp_eq_u32 vcc, 3, v53
    v_lshrrev_b32 v53, 6, v31
    v_mul_u32_u24 v53, 10240, v53
    v_cndmask_b32 v50, v54, v50, vcc
    v_lshl_add_u32 v50, v50, 7, v53
    v_lshl_add_u32 v50, v52, 4, v50
    s_lshr_b32 s3, s2, 3
    s_mul_i32 s3, s3, 163840
    s_add_u32 s3, s3, 192937984
    s_add_u32 s36, s10, s3
    s_addc_u32 s37, s11, 0
    s_mov_b32 s38, 163840
    s_lshl_b32 s3, s45, 13
    s_and_b32 s49, s2, 31
    s_lshl_b32 s49, s49, 3
    s_add_u32 s3, s3, s49
    s_add_u32 s3, s3, 36864
    v_lshlrev_b32 v30, 8, v0
    v_add_u32 v30, s3, v30
    s_lshl_b32 s3, s2, 8
    s_lshl_b32 s49, s44, 6
    s_add_u32 s3, s3, s49
    s_add_u32 s3, s3, 36864
    v_and_b32 v2, 7, v0
    v_lshlrev_b32 v2, 3, v2
    v_add_u32 v2, s3, v2
    s_waitcnt vmcnt(4) lgkmcnt(0)
    s_add_u32 s54, s54, 1
    s_xor_b32 s55, s54, 0x5bd1e995
    v_readfirstlane_b32 s68, v32
    v_readfirstlane_b32 s70, v40
    v_lshlrev_b32 v64, 16, v32
    v_and_b32 v65, 0xffff0000, v32
    v_lshlrev_b32 v66, 16, v33
    v_and_b32 v67, 0xffff0000, v33
    v_lshlrev_b32 v68, 16, v34
    v_and_b32 v69, 0xffff0000, v34
    v_lshlrev_b32 v70, 16, v35
    v_and_b32 v71, 0xffff0000, v35
    v_lshlrev_b32 v72, 16, v36
    v_and_b32 v73, 0xffff0000, v36
    v_lshlrev_b32 v74, 16, v37
    v_and_b32 v75, 0xffff0000, v37
    v_lshlrev_b32 v76, 16, v38
    v_and_b32 v77, 0xffff0000, v38
    v_lshlrev_b32 v78, 16, v39
    v_and_b32 v79, 0xffff0000, v39
    v_lshlrev_b32 v112, 16, v40
    v_and_b32 v113, 0xffff0000, v40
    v_lshlrev_b32 v114, 16, v41
    v_and_b32 v115, 0xffff0000, v41
    v_lshlrev_b32 v116, 16, v42
    v_and_b32 v117, 0xffff0000, v42
    v_lshlrev_b32 v118, 16, v43
    v_and_b32 v119, 0xffff0000, v43
    v_lshlrev_b32 v120, 16, v44
    v_and_b32 v121, 0xffff0000, v44
    v_lshlrev_b32 v122, 16, v45
    v_and_b32 v123, 0xffff0000, v45
    v_lshlrev_b32 v124, 16, v46
    v_and_b32 v125, 0xffff0000, v46
    v_lshlrev_b32 v126, 16, v47
    v_and_b32 v127, 0xffff0000, v47
    s_lshl_b32 s68, s68, 16
    s_lshl_b32 s70, s70, 16
    v_pk_add_f32 v[80:81], v[64:65], s[68:69] op_sel_hi:[1,0] neg_lo:[0,1] neg_hi:[0,1]
    v_pk_add_f32 v[82:83], v[66:67], s[68:69] op_sel_hi:[1,0] neg_lo:[0,1] neg_hi:[0,1]
    v_pk_add_f32 v[84:85], v[68:69], s[68:69] op_sel_hi:[1,0] neg_lo:[0,1] neg_hi:[0,1]
    v_pk_add_f32 v[86:87], v[70:71], s[68:69] op_sel_hi:[1,0] neg_lo:[0,1] neg_hi:[0,1]
    v_pk_add_f32 v[88:89], v[72:73], s[68:69] op_sel_hi:[1,0] neg_lo:[0,1] neg_hi:[0,1]
    v_pk_add_f32 v[90:91], v[74:75], s[68:69] op_sel_hi:[1,0] neg_lo:[0,1] neg_hi:[0,1]
    v_pk_add_f32 v[92:93], v[76:77], s[68:69] op_sel_hi:[1,0] neg_lo:[0,1] neg_hi:[0,1]
    v_pk_add_f32 v[94:95], v[78:79], s[68:69] op_sel_hi:[1,0] neg_lo:[0,1] neg_hi:[0,1]
    v_pk_add_f32 v[128:129], v[112:113], s[70:71] op_sel_hi:[1,0] neg_lo:[0,1] neg_hi:[0,1]
    v_pk_add_f32 v[130:131], v[114:115], s[70:71] op_sel_hi:[1,0] neg_lo:[0,1] neg_hi:[0,1]
    v_pk_add_f32 v[132:133], v[116:117], s[70:71] op_sel_hi:[1,0] neg_lo:[0,1] neg_hi:[0,1]
    v_pk_add_f32 v[134:135], v[118:119], s[70:71] op_sel_hi:[1,0] neg_lo:[0,1] neg_hi:[0,1]
    v_pk_add_f32 v[136:137], v[120:121], s[70:71] op_sel_hi:[1,0] neg_lo:[0,1] neg_hi:[0,1]
    v_pk_add_f32 v[138:139], v[122:123], s[70:71] op_sel_hi:[1,0] neg_lo:[0,1] neg_hi:[0,1]
    v_pk_add_f32 v[140:141], v[124:125], s[70:71] op_sel_hi:[1,0] neg_lo:[0,1] neg_hi:[0,1]
    v_pk_add_f32 v[142:143], v[126:127], s[70:71] op_sel_hi:[1,0] neg_lo:[0,1] neg_hi:[0,1]
    v_pk_add_f32 v[96:97], v[80:81], v[82:83]
    v_pk_mul_f32 v[98:99], v[80:81], v[80:81]
    v_pk_add_f32 v[144:145], v[128:129], v[130:131]
    v_pk_mul_f32 v[146:147], v[128:129], v[128:129]
    v_pk_fma_f32 v[98:99], v[82:83], v[82:83], v[98:99]
    v_pk_fma_f32 v[146:147], v[130:131], v[130:131], v[146:147]
    v_pk_add_f32 v[96:97], v[96:97], v[84:85]
    v_pk_fma_f32 v[98:99], v[84:85], v[84:85], v[98:99]
    v_pk_add_f32 v[144:145], v[144:145], v[132:133]
    v_pk_fma_f32 v[146:147], v[132:133], v[132:133], v[146:147]
    v_pk_add_f32 v[96:97], v[96:97], v[86:87]
    v_pk_fma_f32 v[98:99], v[86:87], v[86:87], v[98:99]
    v_pk_add_f32 v[144:145], v[144:145], v[134:135]
    s_add_u32 m0, m0, 4096
    v_pk_fma_f32 v[146:147], v[134:135], v[134:135], v[146:147]
    buffer_load_dwordx4 v7, s[20:23], s58 offen offset:0 lds
    v_pk_add_f32 v[96:97], v[96:97], v[88:89]
    v_pk_fma_f32 v[98:99], v[88:89], v[88:89], v[98:99]
    v_pk_add_f32 v[144:145], v[144:145], v[136:137]
    v_pk_fma_f32 v[146:147], v[136:137], v[136:137], v[146:147]
    v_pk_add_f32 v[96:97], v[96:97], v[90:91]
    v_pk_fma_f32 v[98:99], v[90:91], v[90:91], v[98:99]
    v_pk_add_f32 v[144:145], v[144:145], v[138:139]
    v_pk_fma_f32 v[146:147], v[138:139], v[138:139], v[146:147]
    v_pk_add_f32 v[96:97], v[96:97], v[92:93]
    v_pk_fma_f32 v[98:99], v[92:93], v[92:93], v[98:99]
    v_pk_add_f32 v[144:145], v[144:145], v[140:141]
    v_pk_fma_f32 v[146:147], v[140:141], v[140:141], v[146:147]
    v_pk_add_f32 v[96:97], v[96:97], v[94:95]
    v_pk_fma_f32 v[98:99], v[94:95], v[94:95], v[98:99]
    v_pk_add_f32 v[144:145], v[144:145], v[142:143]
    v_pk_fma_f32 v[146:147], v[142:143], v[142:143], v[146:147]
    v_add_f32 v96, v96, v97
    v_add_f32 v98, v98, v99
    v_add_f32 v144, v144, v145
    v_add_f32 v146, v146, v147
    s_nop 0
    v_add_f32_dpp v96, v96, v96 row_ror:8 row_mask:0xf bank_mask:0xf
    v_add_f32_dpp v144, v144, v144 row_ror:8 row_mask:0xf bank_mask:0xf
    v_add_f32_dpp v98, v98, v98 row_ror:8 row_mask:0xf bank_mask:0xf
    v_add_f32_dpp v146, v146, v146 row_ror:8 row_mask:0xf bank_mask:0xf
    v_add_f32_dpp v96, v96, v96 row_ror:4 row_mask:0xf bank_mask:0xf
    v_add_f32_dpp v144, v144, v144 row_ror:4 row_mask:0xf bank_mask:0xf
    v_add_f32_dpp v98, v98, v98 row_ror:4 row_mask:0xf bank_mask:0xf
    v_add_f32_dpp v146, v146, v146 row_ror:4 row_mask:0xf bank_mask:0xf
    v_add_f32_dpp v96, v96, v96 row_ror:2 row_mask:0xf bank_mask:0xf
    v_add_f32_dpp v144, v144, v144 row_ror:2 row_mask:0xf bank_mask:0xf
    v_add_f32_dpp v98, v98, v98 row_ror:2 row_mask:0xf bank_mask:0xf
    v_add_f32_dpp v146, v146, v146 row_ror:2 row_mask:0xf bank_mask:0xf
    v_add_f32_dpp v96, v96, v96 row_ror:1 row_mask:0xf bank_mask:0xf
    v_add_f32_dpp v144, v144, v144 row_ror:1 row_mask:0xf bank_mask:0xf
    v_add_f32_dpp v98, v98, v98 row_ror:1 row_mask:0xf bank_mask:0xf
    v_add_f32_dpp v146, v146, v146 row_ror:1 row_mask:0xf bank_mask:0xf
    v_mov_b32 v97, v96
    v_mov_b32 v145, v144
    v_mov_b32 v99, v98
    v_mov_b32 v147, v146
    v_permlane16_swap_b32 v96, v97
    v_permlane16_swap_b32 v144, v145
    v_permlane16_swap_b32 v98, v99
    v_permlane16_swap_b32 v146, v147
    v_add_f32 v96, v96, v97
    v_add_f32 v144, v144, v145
    v_add_f32 v98, v98, v99
    v_add_f32 v146, v146, v147
    v_mov_b32 v97, v96
    v_mov_b32 v145, v144
    v_mov_b32 v99, v98
    v_mov_b32 v147, v146
    v_permlane32_swap_b32 v96, v97
    v_permlane32_swap_b32 v144, v145
    v_permlane32_swap_b32 v98, v99
    v_permlane32_swap_b32 v146, v147
    v_add_f32 v96, v96, v97
    v_add_f32 v144, v144, v145
    v_add_f32 v98, v98, v99
    v_add_f32 v146, v146, v147
    v_mul_f32 v96, 0x3a800000, v96
    v_mul_f32 v98, 0x3a800000, v98
    v_mul_f32 v144, 0x3a800000, v144
    v_mul_f32 v146, 0x3a800000, v146
    buffer_load_dwordx4 v8, s[20:23], s58 offen offset:1024 lds
    v_fma_f32 v98, -v96, v96, v98
    v_add_f32 v96, s68, v96
    v_fma_f32 v146, -v144, v144, v146
    v_add_f32 v144, s70, v144
    v_max_f32 v98, 0, v98
    v_max_f32 v146, 0, v146
    v_cvt_pk_bf16_f32 v98, v98, v98
    v_cvt_pk_bf16_f32 v146, v146, v146
    v_and_b32 v98, 0xffff0000, v98
    v_and_b32 v146, 0xffff0000, v146
    v_add_f32 v98, 0x3727c5ac, v98
    v_add_f32 v146, 0x3727c5ac, v146
    v_cvt_pk_bf16_f32 v98, v98, v98
    v_cvt_pk_bf16_f32 v146, v146, v146
    v_and_b32 v98, 0xffff0000, v98
    v_and_b32 v146, 0xffff0000, v146
    v_sqrt_f32 v98, v98
    v_sqrt_f32 v146, v146
    v_cvt_pk_bf16_f32 v96, v96, v96
    v_cvt_pk_bf16_f32 v144, v144, v144
    v_and_b32 v96, 0xffff0000, v96
    v_and_b32 v144, 0xffff0000, v144
    v_cvt_pk_bf16_f32 v98, v98, v98
    v_cvt_pk_bf16_f32 v146, v146, v146
    v_and_b32 v98, 0xffff0000, v98
    v_and_b32 v146, 0xffff0000, v146
    v_rcp_f32 v98, v98
    v_rcp_f32 v146, v146
    v_pk_add_f32 v[64:65], v[64:65], v[96:97] op_sel_hi:[1,0] neg_lo:[0,1] neg_hi:[0,1]
    v_pk_add_f32 v[66:67], v[66:67], v[96:97] op_sel_hi:[1,0] neg_lo:[0,1] neg_hi:[0,1]
    v_pk_add_f32 v[68:69], v[68:69], v[96:97] op_sel_hi:[1,0] neg_lo:[0,1] neg_hi:[0,1]
    v_pk_add_f32 v[70:71], v[70:71], v[96:97] op_sel_hi:[1,0] neg_lo:[0,1] neg_hi:[0,1]
    v_pk_add_f32 v[72:73], v[72:73], v[96:97] op_sel_hi:[1,0] neg_lo:[0,1] neg_hi:[0,1]
    v_pk_add_f32 v[74:75], v[74:75], v[96:97] op_sel_hi:[1,0] neg_lo:[0,1] neg_hi:[0,1]
    v_pk_add_f32 v[76:77], v[76:77], v[96:97] op_sel_hi:[1,0] neg_lo:[0,1] neg_hi:[0,1]
    v_pk_add_f32 v[78:79], v[78:79], v[96:97] op_sel_hi:[1,0] neg_lo:[0,1] neg_hi:[0,1]
    v_pk_add_f32 v[112:113], v[112:113], v[144:145] op_sel_hi:[1,0] neg_lo:[0,1] neg_hi:[0,1]
    v_pk_add_f32 v[114:115], v[114:115], v[144:145] op_sel_hi:[1,0] neg_lo:[0,1] neg_hi:[0,1]
    v_pk_add_f32 v[116:117], v[116:117], v[144:145] op_sel_hi:[1,0] neg_lo:[0,1] neg_hi:[0,1]
    v_pk_add_f32 v[118:119], v[118:119], v[144:145] op_sel_hi:[1,0] neg_lo:[0,1] neg_hi:[0,1]
    v_pk_add_f32 v[120:121], v[120:121], v[144:145] op_sel_hi:[1,0] neg_lo:[0,1] neg_hi:[0,1]
    v_pk_add_f32 v[122:123], v[122:123], v[144:145] op_sel_hi:[1,0] neg_lo:[0,1] neg_hi:[0,1]
    v_pk_add_f32 v[124:125], v[124:125], v[144:145] op_sel_hi:[1,0] neg_lo:[0,1] neg_hi:[0,1]
    v_pk_add_f32 v[126:127], v[126:127], v[144:145] op_sel_hi:[1,0] neg_lo:[0,1] neg_hi:[0,1]
    v_cvt_pk_bf16_f32 v32, v64, v65
    v_cvt_pk_bf16_f32 v33, v66, v67
    v_cvt_pk_bf16_f32 v34, v68, v69
    v_cvt_pk_bf16_f32 v35, v70, v71
    v_cvt_pk_bf16_f32 v36, v72, v73
    v_cvt_pk_bf16_f32 v37, v74, v75
    v_cvt_pk_bf16_f32 v38, v76, v77
    v_cvt_pk_bf16_f32 v39, v78, v79
    v_cvt_pk_bf16_f32 v40, v112, v113
    v_cvt_pk_bf16_f32 v41, v114, v115
    v_cvt_pk_bf16_f32 v42, v116, v117
    v_cvt_pk_bf16_f32 v43, v118, v119
    v_cvt_pk_bf16_f32 v44, v120, v121
    v_cvt_pk_bf16_f32 v45, v122, v123
    v_cvt_pk_bf16_f32 v46, v124, v125
    v_cvt_pk_bf16_f32 v47, v126, v127
    v_lshlrev_b32 v64, 16, v32
    v_and_b32 v65, 0xffff0000, v32
    v_lshlrev_b32 v66, 16, v33
    v_and_b32 v67, 0xffff0000, v33
    v_lshlrev_b32 v68, 16, v34
    buffer_load_dwordx4 v9, s[20:23], s58 offen offset:2048 lds
    v_and_b32 v69, 0xffff0000, v34
    v_lshlrev_b32 v70, 16, v35
    v_and_b32 v71, 0xffff0000, v35
    v_lshlrev_b32 v72, 16, v36
    v_and_b32 v73, 0xffff0000, v36
    v_lshlrev_b32 v74, 16, v37
    v_and_b32 v75, 0xffff0000, v37
    v_lshlrev_b32 v76, 16, v38
    v_and_b32 v77, 0xffff0000, v38
    v_lshlrev_b32 v78, 16, v39
    v_and_b32 v79, 0xffff0000, v39
    v_lshlrev_b32 v112, 16, v40
    v_and_b32 v113, 0xffff0000, v40
    v_lshlrev_b32 v114, 16, v41
    v_and_b32 v115, 0xffff0000, v41
    v_lshlrev_b32 v116, 16, v42
    v_and_b32 v117, 0xffff0000, v42
    v_lshlrev_b32 v118, 16, v43
    v_and_b32 v119, 0xffff0000, v43
    v_lshlrev_b32 v120, 16, v44
    v_and_b32 v121, 0xffff0000, v44
    v_lshlrev_b32 v122, 16, v45
    v_and_b32 v123, 0xffff0000, v45
    v_lshlrev_b32 v124, 16, v46
    v_and_b32 v125, 0xffff0000, v46
    v_lshlrev_b32 v126, 16, v47
    v_and_b32 v127, 0xffff0000, v47
    v_pk_mul_f32 v[64:65], v[64:65], v[98:99] op_sel_hi:[1,0]
    v_pk_mul_f32 v[66:67], v[66:67], v[98:99] op_sel_hi:[1,0]
    v_pk_mul_f32 v[68:69], v[68:69], v[98:99] op_sel_hi:[1,0]
    v_pk_mul_f32 v[70:71], v[70:71], v[98:99] op_sel_hi:[1,0]
    v_pk_mul_f32 v[72:73], v[72:73], v[98:99] op_sel_hi:[1,0]
    v_pk_mul_f32 v[74:75], v[74:75], v[98:99] op_sel_hi:[1,0]
    v_pk_mul_f32 v[76:77], v[76:77], v[98:99] op_sel_hi:[1,0]
    v_pk_mul_f32 v[78:79], v[78:79], v[98:99] op_sel_hi:[1,0]
    v_pk_mul_f32 v[112:113], v[112:113], v[146:147] op_sel_hi:[1,0]
    v_pk_mul_f32 v[114:115], v[114:115], v[146:147] op_sel_hi:[1,0]
    v_pk_mul_f32 v[116:117], v[116:117], v[146:147] op_sel_hi:[1,0]
    v_pk_mul_f32 v[118:119], v[118:119], v[146:147] op_sel_hi:[1,0]
    v_pk_mul_f32 v[120:121], v[120:121], v[146:147] op_sel_hi:[1,0]
    v_pk_mul_f32 v[122:123], v[122:123], v[146:147] op_sel_hi:[1,0]
    v_pk_mul_f32 v[124:125], v[124:125], v[146:147] op_sel_hi:[1,0]
    v_pk_mul_f32 v[126:127], v[126:127], v[146:147] op_sel_hi:[1,0]
    v_cvt_pk_bf16_f32 v32, v64, v65
    v_cvt_pk_bf16_f32 v33, v66, v67
    v_cvt_pk_bf16_f32 v34, v68, v69
    v_cvt_pk_bf16_f32 v35, v70, v71
    v_cvt_pk_bf16_f32 v36, v72, v73
    v_cvt_pk_bf16_f32 v37, v74, v75
    v_cvt_pk_bf16_f32 v38, v76, v77
    v_cvt_pk_bf16_f32 v39, v78, v79
    v_cvt_pk_bf16_f32 v40, v112, v113
    v_cvt_pk_bf16_f32 v41, v114, v115
    v_cvt_pk_bf16_f32 v42, v116, v117
    v_cvt_pk_bf16_f32 v43, v118, v119
    v_cvt_pk_bf16_f32 v44, v120, v121
    v_cvt_pk_bf16_f32 v45, v122, v123
    v_cvt_pk_bf16_f32 v46, v124, v125
    v_cvt_pk_bf16_f32 v47, v126, v127
    ds_write_b64 v48, v[32:33] offset:0
    ds_write_b64 v48, v[34:35] offset:160
    ds_write_b64 v48, v[36:37] offset:10496
    ds_write_b64 v48, v[38:39] offset:10656
    ds_write_b64 v48, v[40:41] offset:16
    ds_write_b64 v48, v[42:43] offset:176
    ds_write_b64 v48, v[44:45] offset:10512
    ds_write_b64 v48, v[46:47] offset:10672
    s_mov_b32 s49, 40960
    s_mov_b32 s50, 81920
    s_mov_b32 s3, 122880
    v_mov_b32 v26, s54
    v_mov_b32 v27, s55
    s_waitcnt lgkmcnt(0)
    s_barrier
    ds_read_b128 v[32:35], v49 offset:0
    ds_read_b128 v[36:39], v49 offset:5248
    ds_read_b128 v[40:43], v49 offset:10496
    ds_read_b128 v[44:47], v49 offset:15744
    s_waitcnt lgkmcnt(3)
    buffer_store_dwordx4 v[32:35], v50, s[36:39], 0 offen sc1
    s_waitcnt lgkmcnt(2)
    buffer_store_dwordx4 v[36:39], v50, s[36:39], s49 offen sc1
    s_waitcnt lgkmcnt(1)
    buffer_store_dwordx4 v[40:43], v50, s[36:39], s50 offen sc1
    s_waitcnt lgkmcnt(0)
    buffer_store_dwordx4 v[44:47], v50, s[36:39], s3 offen sc1
    v_mov_b32 v20, 0
    v_mov_b32 v21, 0
    v_mov_b32 v22, 0
    v_mov_b32 v23, 0
    s_waitcnt vmcnt(0)
    s_barrier
    s_cmp_eq_u32 s44, 0
    s_cbranch_scc0 L_nf
    s_mov_b32 exec_hi, 0
    buffer_store_dwordx2 v[26:27], v30, s[12:15], 0 offen sc1
    s_mov_b64 exec, -1
L_nf:
    s_add_u32 m0, s64, s62
    s_nop 0
    buffer_load_dwordx4 v10, s[24:27], s59 offen offset:0 lds
    buffer_load_dwordx4 v11, s[24:27], s59 offen offset:1024 lds
    s_add_u32 m0, m0, 8192
    s_nop 0
    buffer_load_dwordx4 v10, s[24:27], s60 offen offset:0 lds
    buffer_load_dwordx4 v11, s[24:27], s60 offen offset:1024 lds
    s_mov_b32 s58, 458752
    s_mov_b32 s59, 524288
    s_mov_b32 s60, 524416
    s_mov_b32 s64, 45056
    s_add_u32 m0, s64, s61
    s_nop 0
    buffer_load_dwordx4 v3, s[20:23], s58 offen offset:0 lds
    buffer_load_dwordx4 v4, s[20:23], s58 offen offset:1024 lds
    buffer_load_dwordx4 v5, s[20:23], s58 offen offset:2048 lds
    buffer_load_dwordx4 v6, s[20:23], s58 offen offset:3072 lds
    s_add_u32 m0, m0, 4096
    s_nop 0
    buffer_load_dwordx4 v7, s[20:23], s58 offen offset:0 lds
    buffer_load_dwordx4 v8, s[20:23], s58 offen offset:1024 lds
    v_mfma_f32_32x32x16_bf16 v[32:47], v[20:23], v[20:23], 0
    v_lshrrev_b32 v28, 2, v0
    v_and_b32 v29, 3, v0
    v_lshlrev_b32 v29, 3, v29
    v_mul_u32_u24 v30, 224, v28
    v_mfma_f32_32x32x16_bf16 v[48:63], v[20:23], v[20:23], 0
    v_add_u32 v30, v30, v29
    s_and_b32 s47, s46, 1
    s_lshl_b32 s49, s47, 5
    v_add_u32 v12, s49, v30
    v_mfma_f32_32x32x16_bf16 v[64:79], v[20:23], v[20:23], 0
    s_cmp_eq_u32 s47, 0
    s_cselect_b32 s49, 192, 0
    v_add_u32 v13, s49, v30
    v_lshl_add_u32 v30, v28, 7, v29
    v_mfma_f32_32x32x16_bf16 v[80:95], v[20:23], v[20:23], 0
    v_add_u32 v30, 28672, v30
    v_bfe_u32 v29, v0, 3, 2
    v_and_b32 v31, 1, v0
    v_mfma_f32_32x32x16_bf16 v[96:111], v[20:23], v[20:23], 0
    v_lshlrev_b32 v30, 7, v28
    v_lshl_add_u32 v30, v31, 4, v30
    v_add_u32 v30, 28672, v30
    v_bfe_u32 v31, v0, 1, 1
    v_mfma_f32_32x32x16_bf16 v[112:127], v[20:23], v[20:23], 0
    v_xor_b32 v29, v29, v31
    v_lshl_add_u32 v14, v29, 5, v30
    v_xor_b32 v29, 2, v29
    v_lshl_add_u32 v15, v29, 5, v30
    v_mfma_f32_32x32x16_bf16 v[128:143], v[20:23], v[20:23], 0
    s_lshl_b32 s51, s44, 12
    s_mul_i32 s49, s48, 163840
    s_add_u32 s49, s49, 192937984
    s_add_u32 s16, s10, s49
    s_addc_u32 s17, s11, 0
    v_mfma_f32_32x32x16_bf16 v[144:159], v[20:23], v[20:23], 0
    s_mov_b32 s18, 163840
    s_mov_b32 s19, 0x20000
    s_mov_b32 s30, 8388608
    v_mfma_f32_32x32x16_bf16 v[160:175], v[20:23], v[20:23], 0
    s_mov_b32 s31, 0x20000
    s_mov_b32 s34, 7340032
    s_mov_b32 s35, 0x20000
    v_lshlrev_b32 v26, 7, v28
    v_mfma_f32_32x32x16_bf16 v[176:191], v[20:23], v[20:23], 0
    s_bfe_u32 s49, s2, 0x30003
    s_lshl_b32 s49, s49, 13
    s_lshr_b32 s50, s51, 1
    s_add_u32 s49, s49, s50
    v_mfma_f32_32x32x16_bf16 v[192:207], v[20:23], v[20:23], 0
    v_add_u32 v26, s49, v26
    v_min_u32 v26, 53120, v26
    v_lshrrev_b32 v29, 3, v0
    v_mfma_f32_32x32x16_bf16 v[208:223], v[20:23], v[20:23], 0
    v_lshlrev_b32 v30, 11, v29
    v_and_b32 v31, 0x7f, v10
    v_add_u32 v24, v30, v31
    v_cmp_eq_u32 vcc, 3, v29
    v_mfma_f32_32x32x16_bf16 v[224:239], v[20:23], v[20:23], 0
    s_lshl_b32 s3, s2, 2
    s_add_u32 s3, s3, s44
    s_and_b32 s49, s3, 7
    s_lshl_b32 s50, s49, 10
    v_mfma_f32_32x32x16_bf16 v[240:255], v[20:23], v[20:23], 0
    s_cmp_ge_u32 s49, 3
    s_addc_u32 s53, s49, 64
    s_lshl_b32 s53, s53, 7
    s_sub_u32 s53, s53, s50
    v_mfma_f32_32x32x16_bf16 a[0:15], v[20:23], v[20:23], 0
    v_and_b32 v30, 0x70, v1
    v_add_u32 v30, s53, v30
    v_cndmask_b32 v25, v1, v30, vcc
    v_mfma_f32_32x32x16_bf16 a[16:31], v[20:23], v[20:23], 0
    s_lshr_b32 s49, s3, 3
    s_mul_i32 s70, s49, 10240
    s_add_u32 s70, s70, s50
    s_add_u32 s71, s70, 1310720
    v_mfma_f32_32x32x16_bf16 a[32:47], v[20:23], v[20:23], 0
    s_and_b32 s68, s3, 511
    s_lshl_b32 s68, s68, 14
    s_lshr_b32 s49, s3, 9
    s_lshl_b32 s49, s49, 10
    v_mfma_f32_32x32x16_bf16 a[48:63], v[20:23], v[20:23], 0
    s_add_u32 s68, s68, s49
    s_add_u32 s68, s68, 384
    s_lshl_b32 s69, s3, 14
    s_add_u32 s69, s69, 384
    v_mfma_f32_32x32x16_bf16 a[64:79], v[20:23], v[20:23], 0
    s_cmp_ge_u32 s3, 448
    s_cselect_b32 s49, 4287628288, 0
    s_add_u32 s69, s69, s49
    v_mfma_f32_32x32x16_bf16 a[80:95], v[20:23], v[20:23], 0
    s_add_u32 s36, s10, 247463936
    s_addc_u32 s37, s11, 0
    s_mov_b32 s38, 2457600
    s_mov_b32 s39, 0x20000
    s_getpc_b64 s[74:75]
L_pc:
    v_mfma_f32_32x32x16_bf16 a[96:111], v[20:23], v[20:23], 0
    s_mov_b32 s56, 0
    s_mov_b32 s57, 4096
    s_mov_b32 s65, 0
    s_mov_b32 s63, 0
    v_mfma_f32_32x32x16_bf16 a[112:127], v[20:23], v[20:23], 0
    s_mov_b32 s52, 7
    s_mov_b32 s66, 4294877184
    s_mov_b32 s67, 45056
    v_and_b32 v30, 0x70, v1
    v_add_u32 v18, 8192, v30
    v_cndmask_b32 v18, v1, v18, vcc
    v_add_u32 v19, 7296, v30
    v_cndmask_b32 v19, v1, v19, vcc
    v_add_u32 v20, 6400, v30
    v_cndmask_b32 v20, v1, v20, vcc
    v_add_u32 v21, 5632, v30
    v_cndmask_b32 v21, v1, v21, vcc
    v_add_u32 v22, 4736, v30
    v_cndmask_b32 v22, v1, v22, vcc
    v_add_u32 v23, 3840, v30
    v_cndmask_b32 v23, v1, v23, vcc
    v_add_u32 v28, 2944, v30
    v_cndmask_b32 v28, v1, v28, vcc
    v_add_u32 v29, 2048, v30
    v_cndmask_b32 v29, v1, v29, vcc
    s_mov_b32 s3, 16384
L_ln_l:
    buffer_load_dwordx2 v[30:31], v2, s[12:15], 0 offen sc1
    s_waitcnt vmcnt(0)
    v_cmp_ne_u64 vcc, s[54:55], v[30:31]
    s_sub_u32 s3, s3, 1
    s_cmp_eq_u32 s3, 0
    s_cbranch_scc1 L_ln_ok
    s_cbranch_vccnz L_ln_l
L_ln_ok:
    buffer_load_dwordx4 a[128:131], v18, s[16:19], s56 offen offset:0 sc1
    buffer_load_dwordx4 a[132:135], v19, s[16:19], s56 offen offset:1024 sc1
    buffer_load_dwordx4 a[136:139], v20, s[16:19], s56 offen offset:2048 sc1
    buffer_load_dwordx4 a[140:143], v21, s[16:19], s56 offen offset:3072 sc1
    buffer_load_dwordx4 a[144:147], v22, s[16:19], s57 offen offset:0 sc1
    buffer_load_dwordx4 a[148:151], v23, s[16:19], s57 offen offset:1024 sc1
    buffer_load_dwordx4 a[152:155], v28, s[16:19], s57 offen offset:2048 sc1
    buffer_load_dwordx4 a[156:159], v29, s[16:19], s57 offen offset:3072 sc1
    s_barrier
    buffer_load_dwordx4 v9, s[20:23], s58 offen offset:2048 lds
    s_add_u32 m0, s64, s62
    s_nop 0
    buffer_load_dwordx4 v10, s[24:27], s59 offen offset:0 lds
    buffer_load_dwordx4 v11, s[24:27], s59 offen offset:1024 lds
    s_add_u32 m0, m0, 8192
    s_nop 0
    buffer_load_dwordx4 v10, s[24:27], s60 offen offset:0 lds
    buffer_load_dwordx4 v11, s[24:27], s60 offen offset:1024 lds
    global_load_dword v31, v26, s[74:75]
    s_mov_b32 s58, 917504
    s_mov_b32 s59, 1048576
    s_mov_b32 s60, 1048704
    s_mov_b32 s64, 90112
    s_mov_b32 s56, 10240
    s_mov_b32 s57, 14336
    ds_read_b64_tr_b16 a[192:193], v12 offset:0
    ds_read_b64_tr_b16 a[194:195], v12 offset:3584
    ds_read_b64_tr_b16 a[196:197], v12 offset:7168
    ds_read_b64_tr_b16 a[198:199], v12 offset:10752
    ds_read_b64_tr_b16 a[200:201], v12 offset:14336
    ds_read_b64_tr_b16 a[202:203], v12 offset:17920
    ds_read_b64_tr_b16 a[204:205], v12 offset:21504
    ds_read_b64_tr_b16 a[206:207], v12 offset:25088
    s_waitcnt vmcnt(6) lgkmcnt(4)
.p2align 6
L_gq_loop:
    v_mfma_f32_16x16x32_bf16 v[32:35], a[192:195], a[128:131], v[32:35]
    ds_read_b64_tr_b16 a[208:209], v12 offset:32
    v_mfma_f32_16x16x32_bf16 v[32:35], a[196:199], a[144:147], v[32:35]
    ds_read_b64_tr_b16 a[210:211], v12 offset:3616
    v_mfma_f32_16x16x32_bf16 v[36:39], a[196:199], a[148:151], v[36:39]
    ds_read_b64_tr_b16 a[212:213], v12 offset:7200
    v_mfma_f32_16x16x32_bf16 v[36:39], a[192:195], a[132:135], v[36:39]
    ds_read_b64_tr_b16 a[214:215], v12 offset:10784
    v_mfma_f32_16x16x32_bf16 v[40:43], a[192:195], a[136:139], v[40:43]
    v_mfma_f32_16x16x32_bf16 v[40:43], a[196:199], a[152:155], v[40:43]
    buffer_load_dwordx4 a[160:163], v18, s[16:19], s56 offen offset:0 sc1
    v_mfma_f32_16x16x32_bf16 v[44:47], a[196:199], a[156:159], v[44:47]
    v_mfma_f32_16x16x32_bf16 v[44:47], a[192:195], a[140:143], v[44:47]
    buffer_load_dwordx4 a[164:167], v19, s[16:19], s56 offen offset:1024 sc1
    s_waitcnt lgkmcnt(4)
    v_mfma_f32_16x16x32_bf16 v[156:159], a[200:203], a[140:143], v[156:159]
    ds_read_b64_tr_b16 a[216:217], v12 offset:14368
    v_mfma_f32_16x16x32_bf16 v[156:159], a[204:207], a[156:159], v[156:159]
    ds_read_b64_tr_b16 a[218:219], v12 offset:17952
    v_mfma_f32_16x16x32_bf16 v[152:155], a[204:207], a[152:155], v[152:155]
    ds_read_b64_tr_b16 a[220:221], v12 offset:21536
    v_mfma_f32_16x16x32_bf16 v[152:155], a[200:203], a[136:139], v[152:155]
    ds_read_b64_tr_b16 a[222:223], v12 offset:25120
    v_mfma_f32_16x16x32_bf16 v[148:151], a[200:203], a[132:135], v[148:151]
    v_mfma_f32_16x16x32_bf16 v[148:151], a[204:207], a[148:151], v[148:151]
    buffer_load_dwordx4 a[168:171], v20, s[16:19], s56 offen offset:2048 sc1
    v_mfma_f32_16x16x32_bf16 v[144:147], a[204:207], a[144:147], v[144:147]
    v_mfma_f32_16x16x32_bf16 v[144:147], a[200:203], a[128:131], v[144:147]
    buffer_load_dwordx4 a[172:175], v21, s[16:19], s56 offen offset:3072 sc1
    s_waitcnt lgkmcnt(4)
    v_mfma_f32_16x16x32_bf16 v[48:51], a[208:211], a[128:131], v[48:51]
    ds_read_b64_tr_b16 a[192:193], v12 offset:64
    v_mfma_f32_16x16x32_bf16 v[48:51], a[212:215], a[144:147], v[48:51]
    ds_read_b64_tr_b16 a[194:195], v12 offset:3648
    v_mfma_f32_16x16x32_bf16 v[52:55], a[212:215], a[148:151], v[52:55]
    ds_read_b64_tr_b16 a[196:197], v12 offset:7232
    v_mfma_f32_16x16x32_bf16 v[52:55], a[208:211], a[132:135], v[52:55]
    ds_read_b64_tr_b16 a[198:199], v12 offset:10816
    v_mfma_f32_16x16x32_bf16 v[56:59], a[208:211], a[136:139], v[56:59]
    v_mfma_f32_16x16x32_bf16 v[56:59], a[212:215], a[152:155], v[56:59]
    buffer_load_dwordx4 a[176:179], v22, s[16:19], s57 offen offset:0 sc1
    v_mfma_f32_16x16x32_bf16 v[60:63], a[212:215], a[156:159], v[60:63]
    v_mfma_f32_16x16x32_bf16 v[60:63], a[208:211], a[140:143], v[60:63]
    buffer_load_dwordx4 a[180:183], v23, s[16:19], s57 offen offset:1024 sc1
    s_waitcnt lgkmcnt(4)
    v_mfma_f32_16x16x32_bf16 v[172:175], a[216:219], a[140:143], v[172:175]
    ds_read_b64_tr_b16 a[200:201], v12 offset:14400
    v_mfma_f32_16x16x32_bf16 v[172:175], a[220:223], a[156:159], v[172:175]
    ds_read_b64_tr_b16 a[202:203], v12 offset:17984
    v_mfma_f32_16x16x32_bf16 v[168:171], a[220:223], a[152:155], v[168:171]
    ds_read_b64_tr_b16 a[204:205], v12 offset:21568
    v_mfma_f32_16x16x32_bf16 v[168:171], a[216:219], a[136:139], v[168:171]
    ds_read_b64_tr_b16 a[206:207], v12 offset:25152
    v_mfma_f32_16x16x32_bf16 v[164:167], a[216:219], a[132:135], v[164:167]
    v_mfma_f32_16x16x32_bf16 v[164:167], a[220:223], a[148:151], v[164:167]
    buffer_load_dwordx4 a[184:187], v28, s[16:19], s57 offen offset:2048 sc1
    v_mfma_f32_16x16x32_bf16 v[160:163], a[220:223], a[144:147], v[160:163]
    v_mfma_f32_16x16x32_bf16 v[160:163], a[216:219], a[128:131], v[160:163]
    buffer_load_dwordx4 a[188:191], v29, s[16:19], s57 offen offset:3072 sc1
    s_waitcnt lgkmcnt(4)
    v_mfma_f32_16x16x32_bf16 v[64:67], a[192:195], a[128:131], v[64:67]
    ds_read_b64_tr_b16 a[208:209], v12 offset:96
    v_mfma_f32_16x16x32_bf16 v[64:67], a[196:199], a[144:147], v[64:67]
    ds_read_b64_tr_b16 a[210:211], v12 offset:3680
    v_mfma_f32_16x16x32_bf16 v[68:71], a[196:199], a[148:151], v[68:71]
    ds_read_b64_tr_b16 a[212:213], v12 offset:7264
    v_mfma_f32_16x16x32_bf16 v[68:71], a[192:195], a[132:135], v[68:71]
    ds_read_b64_tr_b16 a[214:215], v12 offset:10848
    v_mfma_f32_16x16x32_bf16 v[72:75], a[192:195], a[136:139], v[72:75]
    s_add_u32 m0, s64, s61
    v_mfma_f32_16x16x32_bf16 v[72:75], a[196:199], a[152:155], v[72:75]
    buffer_load_dwordx4 v3, s[20:23], s58 offen offset:0 lds
    v_mfma_f32_16x16x32_bf16 v[76:79], a[196:199], a[156:159], v[76:79]
    v_add_u32 v13, s63, v13
    v_add_u32 v14, s63, v14
    v_mfma_f32_16x16x32_bf16 v[76:79], a[192:195], a[140:143], v[76:79]
    s_waitcnt lgkmcnt(4)
    v_mfma_f32_16x16x32_bf16 v[188:191], a[200:203], a[140:143], v[188:191]
    ds_read_b64_tr_b16 a[216:217], v12 offset:14432
    v_mfma_f32_16x16x32_bf16 v[188:191], a[204:207], a[156:159], v[188:191]
    ds_read_b64_tr_b16 a[218:219], v12 offset:18016
    v_mfma_f32_16x16x32_bf16 v[184:187], a[204:207], a[152:155], v[184:187]
    ds_read_b64_tr_b16 a[220:221], v12 offset:21600
    v_mfma_f32_16x16x32_bf16 v[184:187], a[200:203], a[136:139], v[184:187]
    ds_read_b64_tr_b16 a[222:223], v12 offset:25184
    v_mfma_f32_16x16x32_bf16 v[180:183], a[200:203], a[132:135], v[180:183]
    v_mfma_f32_16x16x32_bf16 v[180:183], a[204:207], a[148:151], v[180:183]
    buffer_load_dwordx4 v4, s[20:23], s58 offen offset:1024 lds
    v_mfma_f32_16x16x32_bf16 v[176:179], a[204:207], a[144:147], v[176:179]
    v_add_u32 v15, s63, v15
    v_mfma_f32_16x16x32_bf16 v[176:179], a[200:203], a[128:131], v[176:179]
    s_waitcnt lgkmcnt(4)
    v_mfma_f32_16x16x32_bf16 v[80:83], a[208:211], a[128:131], v[80:83]
    ds_read_b64_tr_b16 a[192:193], v12 offset:128
    v_mfma_f32_16x16x32_bf16 v[80:83], a[212:215], a[144:147], v[80:83]
    ds_read_b64_tr_b16 a[194:195], v12 offset:3712
    v_mfma_f32_16x16x32_bf16 v[84:87], a[212:215], a[148:151], v[84:87]
    ds_read_b64_tr_b16 a[196:197], v12 offset:7296
    v_mfma_f32_16x16x32_bf16 v[84:87], a[208:211], a[132:135], v[84:87]
    ds_read_b64_tr_b16 a[198:199], v12 offset:10880
    v_mfma_f32_16x16x32_bf16 v[88:91], a[208:211], a[136:139], v[88:91]
    v_mfma_f32_16x16x32_bf16 v[88:91], a[212:215], a[152:155], v[88:91]
    buffer_load_dwordx4 v5, s[20:23], s58 offen offset:2048 lds
    v_mfma_f32_16x16x32_bf16 v[92:95], a[212:215], a[156:159], v[92:95]
    v_mfma_f32_16x16x32_bf16 v[92:95], a[208:211], a[140:143], v[92:95]
    s_waitcnt lgkmcnt(4)
    v_mfma_f32_16x16x32_bf16 v[204:207], a[216:219], a[140:143], v[204:207]
    ds_read_b64_tr_b16 a[200:201], v12 offset:14464
    v_mfma_f32_16x16x32_bf16 v[204:207], a[220:223], a[156:159], v[204:207]
    ds_read_b64_tr_b16 a[202:203], v12 offset:18048
    v_mfma_f32_16x16x32_bf16 v[200:203], a[220:223], a[152:155], v[200:203]
    ds_read_b64_tr_b16 a[204:205], v12 offset:21632
    v_mfma_f32_16x16x32_bf16 v[200:203], a[216:219], a[136:139], v[200:203]
    ds_read_b64_tr_b16 a[206:207], v12 offset:25216
    v_mfma_f32_16x16x32_bf16 v[196:199], a[216:219], a[132:135], v[196:199]
    v_mfma_f32_16x16x32_bf16 v[196:199], a[220:223], a[148:151], v[196:199]
    buffer_load_dwordx4 v6, s[20:23], s58 offen offset:3072 lds
    v_mfma_f32_16x16x32_bf16 v[192:195], a[220:223], a[144:147], v[192:195]
    v_mfma_f32_16x16x32_bf16 v[192:195], a[216:219], a[128:131], v[192:195]
    s_waitcnt lgkmcnt(4)
    v_mfma_f32_16x16x32_bf16 v[96:99], a[192:195], a[128:131], v[96:99]
    ds_read_b64_tr_b16 a[208:209], v12 offset:160
    v_mfma_f32_16x16x32_bf16 v[96:99], a[196:199], a[144:147], v[96:99]
    ds_read_b64_tr_b16 a[210:211], v12 offset:3744
    v_mfma_f32_16x16x32_bf16 v[100:103], a[196:199], a[148:151], v[100:103]
    ds_read_b64_tr_b16 a[212:213], v12 offset:7328
    v_mfma_f32_16x16x32_bf16 v[100:103], a[192:195], a[132:135], v[100:103]
    ds_read_b64_tr_b16 a[214:215], v12 offset:10912
    v_mfma_f32_16x16x32_bf16 v[104:107], a[192:195], a[136:139], v[104:107]
    s_add_u32 m0, m0, 4096
    v_mfma_f32_16x16x32_bf16 v[104:107], a[196:199], a[152:155], v[104:107]
    buffer_load_dwordx4 v7, s[20:23], s58 offen offset:0 lds
    v_mfma_f32_16x16x32_bf16 v[108:111], a[196:199], a[156:159], v[108:111]
    v_mfma_f32_16x16x32_bf16 v[108:111], a[192:195], a[140:143], v[108:111]
    s_add_u32 s56, s56, 10240
    s_add_u32 s57, s57, 10240
    s_waitcnt lgkmcnt(4)
    v_mfma_f32_16x16x32_bf16 v[220:223], a[200:203], a[140:143], v[220:223]
    ds_read_b64_tr_b16 a[216:217], v12 offset:14496
    v_mfma_f32_16x16x32_bf16 v[220:223], a[204:207], a[156:159], v[220:223]
    ds_read_b64_tr_b16 a[218:219], v12 offset:18080
    v_mfma_f32_16x16x32_bf16 v[216:219], a[204:207], a[152:155], v[216:219]
    ds_read_b64_tr_b16 a[220:221], v12 offset:21664
    v_mfma_f32_16x16x32_bf16 v[216:219], a[200:203], a[136:139], v[216:219]
    ds_read_b64_tr_b16 a[222:223], v12 offset:25248
    v_mfma_f32_16x16x32_bf16 v[212:215], a[200:203], a[132:135], v[212:215]
    v_mfma_f32_16x16x32_bf16 v[212:215], a[204:207], a[148:151], v[212:215]
    buffer_load_dwordx4 v8, s[20:23], s58 offen offset:1024 lds
    v_mfma_f32_16x16x32_bf16 v[208:211], a[204:207], a[144:147], v[208:211]
    v_mfma_f32_16x16x32_bf16 v[208:211], a[200:203], a[128:131], v[208:211]
    s_waitcnt lgkmcnt(4)
    v_mfma_f32_16x16x32_bf16 v[112:115], a[208:211], a[128:131], v[112:115]
    ds_read_b64_tr_b16 a[192:193], v13 offset:0
    v_mfma_f32_16x16x32_bf16 v[112:115], a[212:215], a[144:147], v[112:115]
    ds_read_b64_tr_b16 a[194:195], v13 offset:3584
    v_mfma_f32_16x16x32_bf16 v[116:119], a[212:215], a[148:151], v[116:119]
    ds_read_b64_tr_b16 a[196:197], v13 offset:7168
    v_mfma_f32_16x16x32_bf16 v[116:119], a[208:211], a[132:135], v[116:119]
    ds_read_b64_tr_b16 a[198:199], v13 offset:10752
    v_mfma_f32_16x16x32_bf16 v[120:123], a[208:211], a[136:139], v[120:123]
    v_mfma_f32_16x16x32_bf16 v[120:123], a[212:215], a[152:155], v[120:123]
    buffer_load_dwordx4 v9, s[20:23], s58 offen offset:2048 lds
    v_mfma_f32_16x16x32_bf16 v[124:127], a[212:215], a[156:159], v[124:127]
    v_mfma_f32_16x16x32_bf16 v[124:127], a[208:211], a[140:143], v[124:127]
    s_waitcnt lgkmcnt(4)
    v_mfma_f32_16x16x32_bf16 v[236:239], a[216:219], a[140:143], v[236:239]
    ds_read_b64_tr_b16 a[200:201], v13 offset:14336
    v_mfma_f32_16x16x32_bf16 v[236:239], a[220:223], a[156:159], v[236:239]
    ds_read_b64_tr_b16 a[202:203], v13 offset:17920
    v_mfma_f32_16x16x32_bf16 v[232:235], a[220:223], a[152:155], v[232:235]
    ds_read_b64_tr_b16 a[204:205], v13 offset:21504
    v_mfma_f32_16x16x32_bf16 v[232:235], a[216:219], a[136:139], v[232:235]
    ds_read_b64_tr_b16 a[206:207], v13 offset:25088
    v_mfma_f32_16x16x32_bf16 v[228:231], a[216:219], a[132:135], v[228:231]
    s_add_u32 m0, s64, s62
    v_mfma_f32_16x16x32_bf16 v[228:231], a[220:223], a[148:151], v[228:231]
    buffer_load_dwordx4 v10, s[24:27], s59 offen offset:0 lds
    v_mfma_f32_16x16x32_bf16 v[224:227], a[220:223], a[144:147], v[224:227]
    v_mfma_f32_16x16x32_bf16 v[224:227], a[216:219], a[128:131], v[224:227]
    s_waitcnt lgkmcnt(4)
    v_mfma_f32_16x16x32_bf16 v[128:131], a[192:195], a[128:131], v[128:131]
    ds_read_b64_tr_b16 a[208:209], v14 offset:0
    v_mfma_f32_16x16x32_bf16 v[128:131], a[196:199], a[144:147], v[128:131]
    ds_read_b64_tr_b16 a[210:211], v14 offset:2048
    v_mfma_f32_16x16x32_bf16 v[132:135], a[196:199], a[148:151], v[132:135]
    ds_read_b64_tr_b16 a[212:213], v14 offset:4096
    v_mfma_f32_16x16x32_bf16 v[132:135], a[192:195], a[132:135], v[132:135]
    ds_read_b64_tr_b16 a[214:215], v14 offset:6144
    v_mfma_f32_16x16x32_bf16 v[136:139], a[192:195], a[136:139], v[136:139]
    v_mfma_f32_16x16x32_bf16 v[136:139], a[196:199], a[152:155], v[136:139]
    buffer_load_dwordx4 v11, s[24:27], s59 offen offset:1024 lds
    v_mfma_f32_16x16x32_bf16 v[140:143], a[196:199], a[156:159], v[140:143]
    v_mfma_f32_16x16x32_bf16 v[140:143], a[192:195], a[140:143], v[140:143]
    s_waitcnt lgkmcnt(4)
    v_mfma_f32_16x16x32_bf16 v[252:255], a[200:203], a[140:143], v[252:255]
    ds_read_b64_tr_b16 a[216:217], v14 offset:8
    v_mfma_f32_16x16x32_bf16 v[252:255], a[204:207], a[156:159], v[252:255]
    ds_read_b64_tr_b16 a[218:219], v14 offset:2056
    v_mfma_f32_16x16x32_bf16 v[248:251], a[204:207], a[152:155], v[248:251]
    ds_read_b64_tr_b16 a[220:221], v14 offset:4104
    v_mfma_f32_16x16x32_bf16 v[248:251], a[200:203], a[136:139], v[248:251]
    ds_read_b64_tr_b16 a[222:223], v14 offset:6152
    v_mfma_f32_16x16x32_bf16 v[244:247], a[200:203], a[132:135], v[244:247]
    s_add_u32 m0, m0, 8192
    v_mfma_f32_16x16x32_bf16 v[244:247], a[204:207], a[148:151], v[244:247]
    buffer_load_dwordx4 v10, s[24:27], s60 offen offset:0 lds
    v_mfma_f32_16x16x32_bf16 v[240:243], a[204:207], a[144:147], v[240:243]
    v_mfma_f32_16x16x32_bf16 v[240:243], a[200:203], a[128:131], v[240:243]
    s_waitcnt lgkmcnt(4)
    v_mfma_f32_16x16x32_bf16 a[0:3], a[208:211], a[128:131], a[0:3]
    ds_read_b64_tr_b16 a[192:193], v15 offset:0
    v_mfma_f32_16x16x32_bf16 a[0:3], a[212:215], a[144:147], a[0:3]
    ds_read_b64_tr_b16 a[194:195], v15 offset:2048
    v_mfma_f32_16x16x32_bf16 a[4:7], a[212:215], a[148:151], a[4:7]
    ds_read_b64_tr_b16 a[196:197], v15 offset:4096
    v_mfma_f32_16x16x32_bf16 a[4:7], a[208:211], a[132:135], a[4:7]
    ds_read_b64_tr_b16 a[198:199], v15 offset:6144
    v_mfma_f32_16x16x32_bf16 a[8:11], a[208:211], a[136:139], a[8:11]
    v_mfma_f32_16x16x32_bf16 a[8:11], a[212:215], a[152:155], a[8:11]
    buffer_load_dwordx4 v11, s[24:27], s60 offen offset:1024 lds
    v_mfma_f32_16x16x32_bf16 a[12:15], a[212:215], a[156:159], a[12:15]
    v_mfma_f32_16x16x32_bf16 a[12:15], a[208:211], a[140:143], a[12:15]
    s_waitcnt lgkmcnt(4)
    v_mfma_f32_16x16x32_bf16 a[28:31], a[216:219], a[140:143], a[28:31]
    ds_read_b64_tr_b16 a[200:201], v15 offset:8
    v_mfma_f32_16x16x32_bf16 a[28:31], a[220:223], a[156:159], a[28:31]
    ds_read_b64_tr_b16 a[202:203], v15 offset:2056
    v_mfma_f32_16x16x32_bf16 a[24:27], a[220:223], a[152:155], a[24:27]
    ds_read_b64_tr_b16 a[204:205], v15 offset:4104
    v_mfma_f32_16x16x32_bf16 a[24:27], a[216:219], a[136:139], a[24:27]
    ds_read_b64_tr_b16 a[206:207], v15 offset:6152
    v_mfma_f32_16x16x32_bf16 a[20:23], a[216:219], a[132:135], a[20:23]
    v_mfma_f32_16x16x32_bf16 a[20:23], a[220:223], a[148:151], a[20:23]
    v_mfma_f32_16x16x32_bf16 a[16:19], a[220:223], a[144:147], a[16:19]
    v_mfma_f32_16x16x32_bf16 a[16:19], a[216:219], a[128:131], a[16:19]
    s_waitcnt lgkmcnt(4)
    v_mfma_f32_16x16x32_bf16 a[32:35], a[192:195], a[128:131], a[32:35]
    ds_read_b64_tr_b16 a[208:209], v14 offset:8192
    v_mfma_f32_16x16x32_bf16 a[32:35], a[196:199], a[144:147], a[32:35]
    ds_read_b64_tr_b16 a[210:211], v14 offset:10240
    v_mfma_f32_16x16x32_bf16 a[36:39], a[196:199], a[148:151], a[36:39]
    ds_read_b64_tr_b16 a[212:213], v14 offset:12288
    v_mfma_f32_16x16x32_bf16 a[36:39], a[192:195], a[132:135], a[36:39]
    ds_read_b64_tr_b16 a[214:215], v14 offset:14336
    v_mfma_f32_16x16x32_bf16 a[40:43], a[192:195], a[136:139], a[40:43]
    v_mfma_f32_16x16x32_bf16 a[40:43], a[196:199], a[152:155], a[40:43]
    v_mfma_f32_16x16x32_bf16 a[44:47], a[196:199], a[156:159], a[44:47]
    v_mfma_f32_16x16x32_bf16 a[44:47], a[192:195], a[140:143], a[44:47]
    s_waitcnt lgkmcnt(4)
    v_mfma_f32_16x16x32_bf16 a[60:63], a[200:203], a[140:143], a[60:63]
    ds_read_b64_tr_b16 a[216:217], v14 offset:8200
    v_mfma_f32_16x16x32_bf16 a[60:63], a[204:207], a[156:159], a[60:63]
    ds_read_b64_tr_b16 a[218:219], v14 offset:10248
    v_mfma_f32_16x16x32_bf16 a[56:59], a[204:207], a[152:155], a[56:59]
    ds_read_b64_tr_b16 a[220:221], v14 offset:12296
    v_mfma_f32_16x16x32_bf16 a[56:59], a[200:203], a[136:139], a[56:59]
    ds_read_b64_tr_b16 a[222:223], v14 offset:14344
    v_mfma_f32_16x16x32_bf16 a[52:55], a[200:203], a[132:135], a[52:55]
    v_mfma_f32_16x16x32_bf16 a[52:55], a[204:207], a[148:151], a[52:55]
    s_add_u32 s58, s58, 458752
    v_mfma_f32_16x16x32_bf16 a[48:51], a[204:207], a[144:147], a[48:51]
    v_mfma_f32_16x16x32_bf16 a[48:51], a[200:203], a[128:131], a[48:51]
    s_waitcnt lgkmcnt(4)
    v_mfma_f32_16x16x32_bf16 a[64:67], a[208:211], a[128:131], a[64:67]
    ds_read_b64_tr_b16 a[192:193], v15 offset:8192
    v_mfma_f32_16x16x32_bf16 a[64:67], a[212:215], a[144:147], a[64:67]
    ds_read_b64_tr_b16 a[194:195], v15 offset:10240
    v_mfma_f32_16x16x32_bf16 a[68:71], a[212:215], a[148:151], a[68:71]
    ds_read_b64_tr_b16 a[196:197], v15 offset:12288
    v_mfma_f32_16x16x32_bf16 a[68:71], a[208:211], a[132:135], a[68:71]
    ds_read_b64_tr_b16 a[198:199], v15 offset:14336
    v_mfma_f32_16x16x32_bf16 a[72:75], a[208:211], a[136:139], a[72:75]
    v_mfma_f32_16x16x32_bf16 a[72:75], a[212:215], a[152:155], a[72:75]
    v_mfma_f32_16x16x32_bf16 a[76:79], a[212:215], a[156:159], a[76:79]
    s_add_u32 s59, s59, 524288
    s_add_u32 s60, s60, 524288
    v_mfma_f32_16x16x32_bf16 a[76:79], a[208:211], a[140:143], a[76:79]
    s_waitcnt lgkmcnt(4)
    v_mfma_f32_16x16x32_bf16 a[92:95], a[216:219], a[140:143], a[92:95]
    ds_read_b64_tr_b16 a[200:201], v15 offset:8200
    v_mfma_f32_16x16x32_bf16 a[92:95], a[220:223], a[156:159], a[92:95]
    ds_read_b64_tr_b16 a[202:203], v15 offset:10248
    v_mfma_f32_16x16x32_bf16 a[88:91], a[220:223], a[152:155], a[88:91]
    ds_read_b64_tr_b16 a[204:205], v15 offset:12296
    v_mfma_f32_16x16x32_bf16 a[88:91], a[216:219], a[136:139], a[88:91]
    ds_read_b64_tr_b16 a[206:207], v15 offset:14344
    v_mfma_f32_16x16x32_bf16 a[84:87], a[216:219], a[132:135], a[84:87]
    v_mfma_f32_16x16x32_bf16 a[84:87], a[220:223], a[148:151], a[84:87]
    s_add_u32 s64, s64, 45056
    v_mfma_f32_16x16x32_bf16 a[80:83], a[220:223], a[144:147], a[80:83]
    s_cmp_eq_u32 s64, 135168
    s_cselect_b32 s64, 0, s64
    v_mfma_f32_16x16x32_bf16 a[80:83], a[216:219], a[128:131], a[80:83]
    s_waitcnt lgkmcnt(4)
    v_mfma_f32_16x16x32_bf16 a[96:99], a[192:195], a[128:131], a[96:99]
    s_add_u32 s65, s65, 45056
    s_cmp_eq_u32 s65, 135168
    v_mfma_f32_16x16x32_bf16 a[96:99], a[196:199], a[144:147], a[96:99]
    s_cselect_b32 s63, s66, s67
    s_cselect_b32 s65, 0, s65
    v_mfma_f32_16x16x32_bf16 a[100:103], a[196:199], a[148:151], a[100:103]
    v_mfma_f32_16x16x32_bf16 a[100:103], a[192:195], a[132:135], a[100:103]
    v_mfma_f32_16x16x32_bf16 a[104:107], a[192:195], a[136:139], a[104:107]
    v_mfma_f32_16x16x32_bf16 a[104:107], a[196:199], a[152:155], a[104:107]
    v_mfma_f32_16x16x32_bf16 a[108:111], a[196:199], a[156:159], a[108:111]
    v_mfma_f32_16x16x32_bf16 a[108:111], a[192:195], a[140:143], a[108:111]
    s_waitcnt vmcnt(11) lgkmcnt(0)
    s_barrier
    v_add_u32 v12, s63, v12
    v_mfma_f32_16x16x32_bf16 a[124:127], a[200:203], a[140:143], a[124:127]
    ds_read_b64_tr_b16 a[208:209], v12 offset:0
    v_mfma_f32_16x16x32_bf16 a[124:127], a[204:207], a[156:159], a[124:127]
    ds_read_b64_tr_b16 a[210:211], v12 offset:3584
    v_mfma_f32_16x16x32_bf16 a[120:123], a[204:207], a[152:155], a[120:123]
    ds_read_b64_tr_b16 a[212:213], v12 offset:7168
    v_mfma_f32_16x16x32_bf16 a[120:123], a[200:203], a[136:139], a[120:123]
    ds_read_b64_tr_b16 a[214:215], v12 offset:10752
    v_mfma_f32_16x16x32_bf16 a[116:119], a[200:203], a[132:135], a[116:119]
    ds_read_b64_tr_b16 a[216:217], v12 offset:14336
    v_mfma_f32_16x16x32_bf16 a[116:119], a[204:207], a[148:151], a[116:119]
    ds_read_b64_tr_b16 a[218:219], v12 offset:17920
    v_mfma_f32_16x16x32_bf16 a[112:115], a[204:207], a[144:147], a[112:115]
    ds_read_b64_tr_b16 a[220:221], v12 offset:21504
    v_mfma_f32_16x16x32_bf16 a[112:115], a[200:203], a[128:131], a[112:115]
    ds_read_b64_tr_b16 a[222:223], v12 offset:25088
    s_waitcnt lgkmcnt(4)
L_gq_mid:
    v_mfma_f32_16x16x32_bf16 v[32:35], a[208:211], a[160:163], v[32:35]
    ds_read_b64_tr_b16 a[192:193], v12 offset:32
    v_mfma_f32_16x16x32_bf16 v[32:35], a[212:215], a[176:179], v[32:35]
    ds_read_b64_tr_b16 a[194:195], v12 offset:3616
    v_mfma_f32_16x16x32_bf16 v[36:39], a[212:215], a[180:183], v[36:39]
    ds_read_b64_tr_b16 a[196:197], v12 offset:7200
    v_mfma_f32_16x16x32_bf16 v[36:39], a[208:211], a[164:167], v[36:39]
    ds_read_b64_tr_b16 a[198:199], v12 offset:10784
    v_mfma_f32_16x16x32_bf16 v[40:43], a[208:211], a[168:171], v[40:43]
    v_mfma_f32_16x16x32_bf16 v[40:43], a[212:215], a[184:187], v[40:43]
    buffer_load_dwordx4 a[128:131], v18, s[16:19], s56 offen offset:0 sc1
    v_mfma_f32_16x16x32_bf16 v[44:47], a[212:215], a[188:191], v[44:47]
    v_mfma_f32_16x16x32_bf16 v[44:47], a[208:211], a[172:175], v[44:47]
    buffer_load_dwordx4 a[132:135], v19, s[16:19], s56 offen offset:1024 sc1
    s_waitcnt lgkmcnt(4)
    v_mfma_f32_16x16x32_bf16 v[156:159], a[216:219], a[172:175], v[156:159]
    ds_read_b64_tr_b16 a[200:201], v12 offset:14368
    v_mfma_f32_16x16x32_bf16 v[156:159], a[220:223], a[188:191], v[156:159]
    ds_read_b64_tr_b16 a[202:203], v12 offset:17952
    v_mfma_f32_16x16x32_bf16 v[152:155], a[220:223], a[184:187], v[152:155]
    ds_read_b64_tr_b16 a[204:205], v12 offset:21536
    v_mfma_f32_16x16x32_bf16 v[152:155], a[216:219], a[168:171], v[152:155]
    ds_read_b64_tr_b16 a[206:207], v12 offset:25120
    v_mfma_f32_16x16x32_bf16 v[148:151], a[216:219], a[164:167], v[148:151]
    v_mfma_f32_16x16x32_bf16 v[148:151], a[220:223], a[180:183], v[148:151]
    buffer_load_dwordx4 a[136:139], v20, s[16:19], s56 offen offset:2048 sc1
    v_mfma_f32_16x16x32_bf16 v[144:147], a[220:223], a[176:179], v[144:147]
    v_mfma_f32_16x16x32_bf16 v[144:147], a[216:219], a[160:163], v[144:147]
    buffer_load_dwordx4 a[140:143], v21, s[16:19], s56 offen offset:3072 sc1
    s_waitcnt lgkmcnt(4)
    v_mfma_f32_16x16x32_bf16 v[48:51], a[192:195], a[160:163], v[48:51]
    ds_read_b64_tr_b16 a[208:209], v12 offset:64
    v_mfma_f32_16x16x32_bf16 v[48:51], a[196:199], a[176:179], v[48:51]
    ds_read_b64_tr_b16 a[210:211], v12 offset:3648
    v_mfma_f32_16x16x32_bf16 v[52:55], a[196:199], a[180:183], v[52:55]
    ds_read_b64_tr_b16 a[212:213], v12 offset:7232
    v_mfma_f32_16x16x32_bf16 v[52:55], a[192:195], a[164:167], v[52:55]
    ds_read_b64_tr_b16 a[214:215], v12 offset:10816
    v_mfma_f32_16x16x32_bf16 v[56:59], a[192:195], a[168:171], v[56:59]
    v_mfma_f32_16x16x32_bf16 v[56:59], a[196:199], a[184:187], v[56:59]
    buffer_load_dwordx4 a[144:147], v22, s[16:19], s57 offen offset:0 sc1
    v_mfma_f32_16x16x32_bf16 v[60:63], a[196:199], a[188:191], v[60:63]
    v_mfma_f32_16x16x32_bf16 v[60:63], a[192:195], a[172:175], v[60:63]
    buffer_load_dwordx4 a[148:151], v23, s[16:19], s57 offen offset:1024 sc1
    s_waitcnt lgkmcnt(4)
    v_mfma_f32_16x16x32_bf16 v[172:175], a[200:203], a[172:175], v[172:175]
    ds_read_b64_tr_b16 a[216:217], v12 offset:14400
    v_mfma_f32_16x16x32_bf16 v[172:175], a[204:207], a[188:191], v[172:175]
    ds_read_b64_tr_b16 a[218:219], v12 offset:17984
    v_mfma_f32_16x16x32_bf16 v[168:171], a[204:207], a[184:187], v[168:171]
    ds_read_b64_tr_b16 a[220:221], v12 offset:21568
    v_mfma_f32_16x16x32_bf16 v[168:171], a[200:203], a[168:171], v[168:171]
    ds_read_b64_tr_b16 a[222:223], v12 offset:25152
    v_mfma_f32_16x16x32_bf16 v[164:167], a[200:203], a[164:167], v[164:167]
    v_mfma_f32_16x16x32_bf16 v[164:167], a[204:207], a[180:183], v[164:167]
    buffer_load_dwordx4 a[152:155], v28, s[16:19], s57 offen offset:2048 sc1
    v_mfma_f32_16x16x32_bf16 v[160:163], a[204:207], a[176:179], v[160:163]
    v_mfma_f32_16x16x32_bf16 v[160:163], a[200:203], a[160:163], v[160:163]
    buffer_load_dwordx4 a[156:159], v29, s[16:19], s57 offen offset:3072 sc1
    s_waitcnt lgkmcnt(4)
    v_mfma_f32_16x16x32_bf16 v[64:67], a[208:211], a[160:163], v[64:67]
    ds_read_b64_tr_b16 a[192:193], v12 offset:96
    v_mfma_f32_16x16x32_bf16 v[64:67], a[212:215], a[176:179], v[64:67]
    ds_read_b64_tr_b16 a[194:195], v12 offset:3680
    v_mfma_f32_16x16x32_bf16 v[68:71], a[212:215], a[180:183], v[68:71]
    ds_read_b64_tr_b16 a[196:197], v12 offset:7264
    v_mfma_f32_16x16x32_bf16 v[68:71], a[208:211], a[164:167], v[68:71]
    ds_read_b64_tr_b16 a[198:199], v12 offset:10848
    v_mfma_f32_16x16x32_bf16 v[72:75], a[208:211], a[168:171], v[72:75]
    s_add_u32 m0, s64, s61
    v_mfma_f32_16x16x32_bf16 v[72:75], a[212:215], a[184:187], v[72:75]
    buffer_load_dwordx4 v3, s[20:23], s58 offen offset:0 lds
    v_mfma_f32_16x16x32_bf16 v[76:79], a[212:215], a[188:191], v[76:79]
    v_add_u32 v13, s63, v13
    v_add_u32 v14, s63, v14
    v_mfma_f32_16x16x32_bf16 v[76:79], a[208:211], a[172:175], v[76:79]
    s_waitcnt lgkmcnt(4)
    v_mfma_f32_16x16x32_bf16 v[188:191], a[216:219], a[172:175], v[188:191]
    ds_read_b64_tr_b16 a[200:201], v12 offset:14432
    v_mfma_f32_16x16x32_bf16 v[188:191], a[220:223], a[188:191], v[188:191]
    ds_read_b64_tr_b16 a[202:203], v12 offset:18016
    v_mfma_f32_16x16x32_bf16 v[184:187], a[220:223], a[184:187], v[184:187]
    ds_read_b64_tr_b16 a[204:205], v12 offset:21600
    v_mfma_f32_16x16x32_bf16 v[184:187], a[216:219], a[168:171], v[184:187]
    ds_read_b64_tr_b16 a[206:207], v12 offset:25184
    v_mfma_f32_16x16x32_bf16 v[180:183], a[216:219], a[164:167], v[180:183]
    v_mfma_f32_16x16x32_bf16 v[180:183], a[220:223], a[180:183], v[180:183]
    buffer_load_dwordx4 v4, s[20:23], s58 offen offset:1024 lds
    v_mfma_f32_16x16x32_bf16 v[176:179], a[220:223], a[176:179], v[176:179]
    v_add_u32 v15, s63, v15
    v_mfma_f32_16x16x32_bf16 v[176:179], a[216:219], a[160:163], v[176:179]
    s_waitcnt lgkmcnt(4)
    v_mfma_f32_16x16x32_bf16 v[80:83], a[192:195], a[160:163], v[80:83]
    ds_read_b64_tr_b16 a[208:209], v12 offset:128
    v_mfma_f32_16x16x32_bf16 v[80:83], a[196:199], a[176:179], v[80:83]
    ds_read_b64_tr_b16 a[210:211], v12 offset:3712
    v_mfma_f32_16x16x32_bf16 v[84:87], a[196:199], a[180:183], v[84:87]
    ds_read_b64_tr_b16 a[212:213], v12 offset:7296
    v_mfma_f32_16x16x32_bf16 v[84:87], a[192:195], a[164:167], v[84:87]
    ds_read_b64_tr_b16 a[214:215], v12 offset:10880
    v_mfma_f32_16x16x32_bf16 v[88:91], a[192:195], a[168:171], v[88:91]
    v_mfma_f32_16x16x32_bf16 v[88:91], a[196:199], a[184:187], v[88:91]
    buffer_load_dwordx4 v5, s[20:23], s58 offen offset:2048 lds
    v_mfma_f32_16x16x32_bf16 v[92:95], a[196:199], a[188:191], v[92:95]
    v_mfma_f32_16x16x32_bf16 v[92:95], a[192:195], a[172:175], v[92:95]
    s_waitcnt lgkmcnt(4)
    v_mfma_f32_16x16x32_bf16 v[204:207], a[200:203], a[172:175], v[204:207]
    ds_read_b64_tr_b16 a[216:217], v12 offset:14464
    v_mfma_f32_16x16x32_bf16 v[204:207], a[204:207], a[188:191], v[204:207]
    ds_read_b64_tr_b16 a[218:219], v12 offset:18048
    v_mfma_f32_16x16x32_bf16 v[200:203], a[204:207], a[184:187], v[200:203]
    ds_read_b64_tr_b16 a[220:221], v12 offset:21632
    v_mfma_f32_16x16x32_bf16 v[200:203], a[200:203], a[168:171], v[200:203]
    ds_read_b64_tr_b16 a[222:223], v12 offset:25216
    v_mfma_f32_16x16x32_bf16 v[196:199], a[200:203], a[164:167], v[196:199]
    v_mfma_f32_16x16x32_bf16 v[196:199], a[204:207], a[180:183], v[196:199]
    buffer_load_dwordx4 v6, s[20:23], s58 offen offset:3072 lds
    v_mfma_f32_16x16x32_bf16 v[192:195], a[204:207], a[176:179], v[192:195]
    v_mfma_f32_16x16x32_bf16 v[192:195], a[200:203], a[160:163], v[192:195]
    s_waitcnt lgkmcnt(4)
    v_mfma_f32_16x16x32_bf16 v[96:99], a[208:211], a[160:163], v[96:99]
    ds_read_b64_tr_b16 a[192:193], v12 offset:160
    v_mfma_f32_16x16x32_bf16 v[96:99], a[212:215], a[176:179], v[96:99]
    ds_read_b64_tr_b16 a[194:195], v12 offset:3744
    v_mfma_f32_16x16x32_bf16 v[100:103], a[212:215], a[180:183], v[100:103]
    ds_read_b64_tr_b16 a[196:197], v12 offset:7328
    v_mfma_f32_16x16x32_bf16 v[100:103], a[208:211], a[164:167], v[100:103]
    ds_read_b64_tr_b16 a[198:199], v12 offset:10912
    v_mfma_f32_16x16x32_bf16 v[104:107], a[208:211], a[168:171], v[104:107]
    s_add_u32 m0, m0, 4096
    v_mfma_f32_16x16x32_bf16 v[104:107], a[212:215], a[184:187], v[104:107]
    buffer_load_dwordx4 v7, s[20:23], s58 offen offset:0 lds
    v_mfma_f32_16x16x32_bf16 v[108:111], a[212:215], a[188:191], v[108:111]
    v_mfma_f32_16x16x32_bf16 v[108:111], a[208:211], a[172:175], v[108:111]
    s_add_u32 s56, s56, 10240
    s_add_u32 s57, s57, 10240
    s_waitcnt lgkmcnt(4)
    v_mfma_f32_16x16x32_bf16 v[220:223], a[216:219], a[172:175], v[220:223]
    ds_read_b64_tr_b16 a[200:201], v12 offset:14496
    v_mfma_f32_16x16x32_bf16 v[220:223], a[220:223], a[188:191], v[220:223]
    ds_read_b64_tr_b16 a[202:203], v12 offset:18080
    v_mfma_f32_16x16x32_bf16 v[216:219], a[220:223], a[184:187], v[216:219]
    ds_read_b64_tr_b16 a[204:205], v12 offset:21664
    v_mfma_f32_16x16x32_bf16 v[216:219], a[216:219], a[168:171], v[216:219]
    ds_read_b64_tr_b16 a[206:207], v12 offset:25248
    v_mfma_f32_16x16x32_bf16 v[212:215], a[216:219], a[164:167], v[212:215]
    v_mfma_f32_16x16x32_bf16 v[212:215], a[220:223], a[180:183], v[212:215]
    buffer_load_dwordx4 v8, s[20:23], s58 offen offset:1024 lds
    v_mfma_f32_16x16x32_bf16 v[208:211], a[220:223], a[176:179], v[208:211]
    v_mfma_f32_16x16x32_bf16 v[208:211], a[216:219], a[160:163], v[208:211]
    s_waitcnt lgkmcnt(4)
    v_mfma_f32_16x16x32_bf16 v[112:115], a[192:195], a[160:163], v[112:115]
    ds_read_b64_tr_b16 a[208:209], v13 offset:0
    v_mfma_f32_16x16x32_bf16 v[112:115], a[196:199], a[176:179], v[112:115]
    ds_read_b64_tr_b16 a[210:211], v13 offset:3584
    v_mfma_f32_16x16x32_bf16 v[116:119], a[196:199], a[180:183], v[116:119]
    ds_read_b64_tr_b16 a[212:213], v13 offset:7168
    v_mfma_f32_16x16x32_bf16 v[116:119], a[192:195], a[164:167], v[116:119]
    ds_read_b64_tr_b16 a[214:215], v13 offset:10752
    v_mfma_f32_16x16x32_bf16 v[120:123], a[192:195], a[168:171], v[120:123]
    v_mfma_f32_16x16x32_bf16 v[120:123], a[196:199], a[184:187], v[120:123]
    buffer_load_dwordx4 v9, s[20:23], s58 offen offset:2048 lds
    v_mfma_f32_16x16x32_bf16 v[124:127], a[196:199], a[188:191], v[124:127]
    v_mfma_f32_16x16x32_bf16 v[124:127], a[192:195], a[172:175], v[124:127]
    s_waitcnt lgkmcnt(4)
    v_mfma_f32_16x16x32_bf16 v[236:239], a[200:203], a[172:175], v[236:239]
    ds_read_b64_tr_b16 a[216:217], v13 offset:14336
    v_mfma_f32_16x16x32_bf16 v[236:239], a[204:207], a[188:191], v[236:239]
    ds_read_b64_tr_b16 a[218:219], v13 offset:17920
    v_mfma_f32_16x16x32_bf16 v[232:235], a[204:207], a[184:187], v[232:235]
    ds_read_b64_tr_b16 a[220:221], v13 offset:21504
    v_mfma_f32_16x16x32_bf16 v[232:235], a[200:203], a[168:171], v[232:235]
    ds_read_b64_tr_b16 a[222:223], v13 offset:25088
    v_mfma_f32_16x16x32_bf16 v[228:231], a[200:203], a[164:167], v[228:231]
    s_add_u32 m0, s64, s62
    v_mfma_f32_16x16x32_bf16 v[228:231], a[204:207], a[180:183], v[228:231]
    buffer_load_dwordx4 v10, s[24:27], s59 offen offset:0 lds
    v_mfma_f32_16x16x32_bf16 v[224:227], a[204:207], a[176:179], v[224:227]
    v_mfma_f32_16x16x32_bf16 v[224:227], a[200:203], a[160:163], v[224:227]
    s_waitcnt lgkmcnt(4)
    v_mfma_f32_16x16x32_bf16 v[128:131], a[208:211], a[160:163], v[128:131]
    ds_read_b64_tr_b16 a[192:193], v14 offset:0
    v_mfma_f32_16x16x32_bf16 v[128:131], a[212:215], a[176:179], v[128:131]
    ds_read_b64_tr_b16 a[194:195], v14 offset:2048
    v_mfma_f32_16x16x32_bf16 v[132:135], a[212:215], a[180:183], v[132:135]
    ds_read_b64_tr_b16 a[196:197], v14 offset:4096
    v_mfma_f32_16x16x32_bf16 v[132:135], a[208:211], a[164:167], v[132:135]
    ds_read_b64_tr_b16 a[198:199], v14 offset:6144
    v_mfma_f32_16x16x32_bf16 v[136:139], a[208:211], a[168:171], v[136:139]
    v_mfma_f32_16x16x32_bf16 v[136:139], a[212:215], a[184:187], v[136:139]
    buffer_load_dwordx4 v11, s[24:27], s59 offen offset:1024 lds
    v_mfma_f32_16x16x32_bf16 v[140:143], a[212:215], a[188:191], v[140:143]
    v_mfma_f32_16x16x32_bf16 v[140:143], a[208:211], a[172:175], v[140:143]
    s_waitcnt lgkmcnt(4)
    v_mfma_f32_16x16x32_bf16 v[252:255], a[216:219], a[172:175], v[252:255]
    ds_read_b64_tr_b16 a[200:201], v14 offset:8
    v_mfma_f32_16x16x32_bf16 v[252:255], a[220:223], a[188:191], v[252:255]
    ds_read_b64_tr_b16 a[202:203], v14 offset:2056
    v_mfma_f32_16x16x32_bf16 v[248:251], a[220:223], a[184:187], v[248:251]
    ds_read_b64_tr_b16 a[204:205], v14 offset:4104
    v_mfma_f32_16x16x32_bf16 v[248:251], a[216:219], a[168:171], v[248:251]
    ds_read_b64_tr_b16 a[206:207], v14 offset:6152
    v_mfma_f32_16x16x32_bf16 v[244:247], a[216:219], a[164:167], v[244:247]
    s_add_u32 m0, m0, 8192
    v_mfma_f32_16x16x32_bf16 v[244:247], a[220:223], a[180:183], v[244:247]
    buffer_load_dwordx4 v10, s[24:27], s60 offen offset:0 lds
    v_mfma_f32_16x16x32_bf16 v[240:243], a[220:223], a[176:179], v[240:243]
    v_mfma_f32_16x16x32_bf16 v[240:243], a[216:219], a[160:163], v[240:243]
    s_waitcnt lgkmcnt(4)
    v_mfma_f32_16x16x32_bf16 a[0:3], a[192:195], a[160:163], a[0:3]
    ds_read_b64_tr_b16 a[208:209], v15 offset:0
    v_mfma_f32_16x16x32_bf16 a[0:3], a[196:199], a[176:179], a[0:3]
    ds_read_b64_tr_b16 a[210:211], v15 offset:2048
    v_mfma_f32_16x16x32_bf16 a[4:7], a[196:199], a[180:183], a[4:7]
    ds_read_b64_tr_b16 a[212:213], v15 offset:4096
    v_mfma_f32_16x16x32_bf16 a[4:7], a[192:195], a[164:167], a[4:7]
    ds_read_b64_tr_b16 a[214:215], v15 offset:6144
    v_mfma_f32_16x16x32_bf16 a[8:11], a[192:195], a[168:171], a[8:11]
    v_mfma_f32_16x16x32_bf16 a[8:11], a[196:199], a[184:187], a[8:11]
    buffer_load_dwordx4 v11, s[24:27], s60 offen offset:1024 lds
    v_mfma_f32_16x16x32_bf16 a[12:15], a[196:199], a[188:191], a[12:15]
    v_mfma_f32_16x16x32_bf16 a[12:15], a[192:195], a[172:175], a[12:15]
    s_waitcnt lgkmcnt(4)
    v_mfma_f32_16x16x32_bf16 a[28:31], a[200:203], a[172:175], a[28:31]
    ds_read_b64_tr_b16 a[216:217], v15 offset:8
    v_mfma_f32_16x16x32_bf16 a[28:31], a[204:207], a[188:191], a[28:31]
    ds_read_b64_tr_b16 a[218:219], v15 offset:2056
    v_mfma_f32_16x16x32_bf16 a[24:27], a[204:207], a[184:187], a[24:27]
    ds_read_b64_tr_b16 a[220:221], v15 offset:4104
    v_mfma_f32_16x16x32_bf16 a[24:27], a[200:203], a[168:171], a[24:27]
    ds_read_b64_tr_b16 a[222:223], v15 offset:6152
    v_mfma_f32_16x16x32_bf16 a[20:23], a[200:203], a[164:167], a[20:23]
    v_mfma_f32_16x16x32_bf16 a[20:23], a[204:207], a[180:183], a[20:23]
    v_mfma_f32_16x16x32_bf16 a[16:19], a[204:207], a[176:179], a[16:19]
    v_mfma_f32_16x16x32_bf16 a[16:19], a[200:203], a[160:163], a[16:19]
    s_waitcnt lgkmcnt(4)
    v_mfma_f32_16x16x32_bf16 a[32:35], a[208:211], a[160:163], a[32:35]
    ds_read_b64_tr_b16 a[192:193], v14 offset:8192
    v_mfma_f32_16x16x32_bf16 a[32:35], a[212:215], a[176:179], a[32:35]
    ds_read_b64_tr_b16 a[194:195], v14 offset:10240
    v_mfma_f32_16x16x32_bf16 a[36:39], a[212:215], a[180:183], a[36:39]
    ds_read_b64_tr_b16 a[196:197], v14 offset:12288
    v_mfma_f32_16x16x32_bf16 a[36:39], a[208:211], a[164:167], a[36:39]
    ds_read_b64_tr_b16 a[198:199], v14 offset:14336
    v_mfma_f32_16x16x32_bf16 a[40:43], a[208:211], a[168:171], a[40:43]
    v_mfma_f32_16x16x32_bf16 a[40:43], a[212:215], a[184:187], a[40:43]
    v_mfma_f32_16x16x32_bf16 a[44:47], a[212:215], a[188:191], a[44:47]
    v_mfma_f32_16x16x32_bf16 a[44:47], a[208:211], a[172:175], a[44:47]
    s_waitcnt lgkmcnt(4)
    v_mfma_f32_16x16x32_bf16 a[60:63], a[216:219], a[172:175], a[60:63]
    ds_read_b64_tr_b16 a[200:201], v14 offset:8200
    v_mfma_f32_16x16x32_bf16 a[60:63], a[220:223], a[188:191], a[60:63]
    ds_read_b64_tr_b16 a[202:203], v14 offset:10248
    v_mfma_f32_16x16x32_bf16 a[56:59], a[220:223], a[184:187], a[56:59]
    ds_read_b64_tr_b16 a[204:205], v14 offset:12296
    v_mfma_f32_16x16x32_bf16 a[56:59], a[216:219], a[168:171], a[56:59]
    ds_read_b64_tr_b16 a[206:207], v14 offset:14344
    v_mfma_f32_16x16x32_bf16 a[52:55], a[216:219], a[164:167], a[52:55]
    v_mfma_f32_16x16x32_bf16 a[52:55], a[220:223], a[180:183], a[52:55]
    s_add_u32 s58, s58, 458752
    v_mfma_f32_16x16x32_bf16 a[48:51], a[220:223], a[176:179], a[48:51]
    v_mfma_f32_16x16x32_bf16 a[48:51], a[216:219], a[160:163], a[48:51]
    s_waitcnt lgkmcnt(4)
    v_mfma_f32_16x16x32_bf16 a[64:67], a[192:195], a[160:163], a[64:67]
    ds_read_b64_tr_b16 a[208:209], v15 offset:8192
    v_mfma_f32_16x16x32_bf16 a[64:67], a[196:199], a[176:179], a[64:67]
    ds_read_b64_tr_b16 a[210:211], v15 offset:10240
    v_mfma_f32_16x16x32_bf16 a[68:71], a[196:199], a[180:183], a[68:71]
    ds_read_b64_tr_b16 a[212:213], v15 offset:12288
    v_mfma_f32_16x16x32_bf16 a[68:71], a[192:195], a[164:167], a[68:71]
    ds_read_b64_tr_b16 a[214:215], v15 offset:14336
    v_mfma_f32_16x16x32_bf16 a[72:75], a[192:195], a[168:171], a[72:75]
    v_mfma_f32_16x16x32_bf16 a[72:75], a[196:199], a[184:187], a[72:75]
    v_mfma_f32_16x16x32_bf16 a[76:79], a[196:199], a[188:191], a[76:79]
    s_add_u32 s59, s59, 524288
    s_add_u32 s60, s60, 524288
    v_mfma_f32_16x16x32_bf16 a[76:79], a[192:195], a[172:175], a[76:79]
    s_waitcnt lgkmcnt(4)
    v_mfma_f32_16x16x32_bf16 a[92:95], a[200:203], a[172:175], a[92:95]
    ds_read_b64_tr_b16 a[216:217], v15 offset:8200
    v_mfma_f32_16x16x32_bf16 a[92:95], a[204:207], a[188:191], a[92:95]
    ds_read_b64_tr_b16 a[218:219], v15 offset:10248
    v_mfma_f32_16x16x32_bf16 a[88:91], a[204:207], a[184:187], a[88:91]
    ds_read_b64_tr_b16 a[220:221], v15 offset:12296
    v_mfma_f32_16x16x32_bf16 a[88:91], a[200:203], a[168:171], a[88:91]
    ds_read_b64_tr_b16 a[222:223], v15 offset:14344
    v_mfma_f32_16x16x32_bf16 a[84:87], a[200:203], a[164:167], a[84:87]
    v_mfma_f32_16x16x32_bf16 a[84:87], a[204:207], a[180:183], a[84:87]
    s_add_u32 s64, s64, 45056
    v_mfma_f32_16x16x32_bf16 a[80:83], a[204:207], a[176:179], a[80:83]
    s_cmp_eq_u32 s64, 135168
    s_cselect_b32 s64, 0, s64
    v_mfma_f32_16x16x32_bf16 a[80:83], a[200:203], a[160:163], a[80:83]
    s_waitcnt lgkmcnt(4)
    v_mfma_f32_16x16x32_bf16 a[96:99], a[208:211], a[160:163], a[96:99]
    s_add_u32 s65, s65, 45056
    s_cmp_eq_u32 s65, 135168
    v_mfma_f32_16x16x32_bf16 a[96:99], a[212:215], a[176:179], a[96:99]
    s_cselect_b32 s63, s66, s67
    s_cselect_b32 s65, 0, s65
    v_mfma_f32_16x16x32_bf16 a[100:103], a[212:215], a[180:183], a[100:103]
    v_mfma_f32_16x16x32_bf16 a[100:103], a[208:211], a[164:167], a[100:103]
    v_mfma_f32_16x16x32_bf16 a[104:107], a[208:211], a[168:171], a[104:107]
    v_mfma_f32_16x16x32_bf16 a[104:107], a[212:215], a[184:187], a[104:107]
    v_mfma_f32_16x16x32_bf16 a[108:111], a[212:215], a[188:191], a[108:111]
    v_mfma_f32_16x16x32_bf16 a[108:111], a[208:211], a[172:175], a[108:111]
    s_waitcnt vmcnt(11) lgkmcnt(0)
    s_barrier
    v_add_u32 v12, s63, v12
    v_mfma_f32_16x16x32_bf16 a[124:127], a[216:219], a[172:175], a[124:127]
    ds_read_b64_tr_b16 a[192:193], v12 offset:0
    v_mfma_f32_16x16x32_bf16 a[124:127], a[220:223], a[188:191], a[124:127]
    ds_read_b64_tr_b16 a[194:195], v12 offset:3584
    v_mfma_f32_16x16x32_bf16 a[120:123], a[220:223], a[184:187], a[120:123]
    ds_read_b64_tr_b16 a[196:197], v12 offset:7168
    v_mfma_f32_16x16x32_bf16 a[120:123], a[216:219], a[168:171], a[120:123]
    ds_read_b64_tr_b16 a[198:199], v12 offset:10752
    v_mfma_f32_16x16x32_bf16 a[116:119], a[216:219], a[164:167], a[116:119]
    ds_read_b64_tr_b16 a[200:201], v12 offset:14336
    v_mfma_f32_16x16x32_bf16 a[116:119], a[220:223], a[180:183], a[116:119]
    ds_read_b64_tr_b16 a[202:203], v12 offset:17920
    v_mfma_f32_16x16x32_bf16 a[112:115], a[220:223], a[176:179], a[112:115]
    ds_read_b64_tr_b16 a[204:205], v12 offset:21504
    s_sub_u32 s52, s52, 1
    s_cmp_lg_u32 s52, 0
    v_mfma_f32_16x16x32_bf16 a[112:115], a[216:219], a[160:163], a[112:115]
    ds_read_b64_tr_b16 a[206:207], v12 offset:25088
    s_waitcnt lgkmcnt(4)
    s_cbranch_scc1 L_gq_loop
    v_mfma_f32_16x16x32_bf16 v[32:35], a[192:195], a[128:131], v[32:35]
    ds_read_b64_tr_b16 a[208:209], v12 offset:32
    v_mfma_f32_16x16x32_bf16 v[32:35], a[196:199], a[144:147], v[32:35]
    ds_read_b64_tr_b16 a[210:211], v12 offset:3616
    v_mfma_f32_16x16x32_bf16 v[36:39], a[196:199], a[148:151], v[36:39]
    ds_read_b64_tr_b16 a[212:213], v12 offset:7200
    v_mfma_f32_16x16x32_bf16 v[36:39], a[192:195], a[132:135], v[36:39]
    ds_read_b64_tr_b16 a[214:215], v12 offset:10784
    v_mfma_f32_16x16x32_bf16 v[40:43], a[192:195], a[136:139], v[40:43]
    v_mfma_f32_16x16x32_bf16 v[40:43], a[196:199], a[152:155], v[40:43]
    buffer_load_dwordx4 a[224:227], v24, s[28:31], s68 offen
    v_mfma_f32_16x16x32_bf16 v[44:47], a[196:199], a[156:159], v[44:47]
    v_mfma_f32_16x16x32_bf16 v[44:47], a[192:195], a[140:143], v[44:47]
    buffer_load_dwordx4 a[228:231], v24, s[32:35], s69 offen
    s_waitcnt lgkmcnt(4)
    v_mfma_f32_16x16x32_bf16 v[156:159], a[200:203], a[140:143], v[156:159]
    ds_read_b64_tr_b16 a[216:217], v12 offset:14368
    v_mfma_f32_16x16x32_bf16 v[156:159], a[204:207], a[156:159], v[156:159]
    ds_read_b64_tr_b16 a[218:219], v12 offset:17952
    v_mfma_f32_16x16x32_bf16 v[152:155], a[204:207], a[152:155], v[152:155]
    ds_read_b64_tr_b16 a[220:221], v12 offset:21536
    v_mfma_f32_16x16x32_bf16 v[152:155], a[200:203], a[136:139], v[152:155]
    ds_read_b64_tr_b16 a[222:223], v12 offset:25120
    v_mfma_f32_16x16x32_bf16 v[148:151], a[200:203], a[132:135], v[148:151]
    s_bitcmp0_b32 s2, 7
    s_cselect_b32 s20, s28, s32
    s_cselect_b32 s21, s29, s33
    v_mfma_f32_16x16x32_bf16 v[148:151], a[204:207], a[148:151], v[148:151]
    buffer_load_dwordx4 a[160:163], v18, s[16:19], s56 offen offset:0 sc1
    v_mfma_f32_16x16x32_bf16 v[144:147], a[204:207], a[144:147], v[144:147]
    s_lshr_b32 s3, s46, 3
    s_lshl_b32 s3, s3, 19
    v_mfma_f32_16x16x32_bf16 v[144:147], a[200:203], a[128:131], v[144:147]
    buffer_load_dwordx4 a[164:167], v19, s[16:19], s56 offen offset:1024 sc1
    s_waitcnt lgkmcnt(4)
    v_mfma_f32_16x16x32_bf16 v[48:51], a[208:211], a[128:131], v[48:51]
    ds_read_b64_tr_b16 a[192:193], v12 offset:64
    v_mfma_f32_16x16x32_bf16 v[48:51], a[212:215], a[144:147], v[48:51]
    ds_read_b64_tr_b16 a[194:195], v12 offset:3648
    v_mfma_f32_16x16x32_bf16 v[52:55], a[212:215], a[148:151], v[52:55]
    ds_read_b64_tr_b16 a[196:197], v12 offset:7232
    v_mfma_f32_16x16x32_bf16 v[52:55], a[208:211], a[132:135], v[52:55]
    ds_read_b64_tr_b16 a[198:199], v12 offset:10816
    v_mfma_f32_16x16x32_bf16 v[56:59], a[208:211], a[136:139], v[56:59]
    s_add_u32 s3, s3, 393216
    v_mfma_f32_16x16x32_bf16 v[56:59], a[212:215], a[152:155], v[56:59]
    buffer_load_dwordx4 a[168:171], v20, s[16:19], s56 offen offset:2048 sc1
    v_mfma_f32_16x16x32_bf16 v[60:63], a[212:215], a[156:159], v[60:63]
    s_add_u32 s28, s4, s3
    s_addc_u32 s29, s5, 0
    v_mfma_f32_16x16x32_bf16 v[60:63], a[208:211], a[140:143], v[60:63]
    buffer_load_dwordx4 a[172:175], v21, s[16:19], s56 offen offset:3072 sc1
    s_waitcnt lgkmcnt(4)
    v_mfma_f32_16x16x32_bf16 v[172:175], a[216:219], a[140:143], v[172:175]
    ds_read_b64_tr_b16 a[200:201], v12 offset:14400
    v_mfma_f32_16x16x32_bf16 v[172:175], a[220:223], a[156:159], v[172:175]
    ds_read_b64_tr_b16 a[202:203], v12 offset:17984
    v_mfma_f32_16x16x32_bf16 v[168:171], a[220:223], a[152:155], v[168:171]
    ds_read_b64_tr_b16 a[204:205], v12 offset:21568
    v_mfma_f32_16x16x32_bf16 v[168:171], a[216:219], a[136:139], v[168:171]
    ds_read_b64_tr_b16 a[206:207], v12 offset:25152
    v_mfma_f32_16x16x32_bf16 v[164:167], a[216:219], a[132:135], v[164:167]
    s_mov_b32 s30, 131072
    s_mov_b32 s31, 0x20000
    v_mfma_f32_16x16x32_bf16 v[164:167], a[220:223], a[148:151], v[164:167]
    buffer_load_dwordx4 a[176:179], v22, s[16:19], s57 offen offset:0 sc1
    v_mfma_f32_16x16x32_bf16 v[160:163], a[220:223], a[144:147], v[160:163]
    s_add_u32 s32, s6, s3
    s_addc_u32 s33, s7, 0
    s_mov_b32 s34, 131072
    s_mov_b32 s35, 0x20000
    s_load_dwordx2 s[8:9], s[0:1], 0
    s_load_dwordx2 s[4:5], s[0:1], 72
    v_mfma_f32_16x16x32_bf16 v[160:163], a[216:219], a[128:131], v[160:163]
    buffer_load_dwordx4 a[180:183], v23, s[16:19], s57 offen offset:1024 sc1
    s_waitcnt lgkmcnt(4)
    v_mfma_f32_16x16x32_bf16 v[64:67], a[192:195], a[128:131], v[64:67]
    ds_read_b64_tr_b16 a[208:209], v12 offset:96
    v_mfma_f32_16x16x32_bf16 v[64:67], a[196:199], a[144:147], v[64:67]
    ds_read_b64_tr_b16 a[210:211], v12 offset:3680
    v_mfma_f32_16x16x32_bf16 v[68:71], a[196:199], a[148:151], v[68:71]
    ds_read_b64_tr_b16 a[212:213], v12 offset:7264
    v_mfma_f32_16x16x32_bf16 v[68:71], a[192:195], a[132:135], v[68:71]
    ds_read_b64_tr_b16 a[214:215], v12 offset:10848
    v_mfma_f32_16x16x32_bf16 v[72:75], a[192:195], a[136:139], v[72:75]
    v_mfma_f32_16x16x32_bf16 v[72:75], a[196:199], a[152:155], v[72:75]
    buffer_load_dwordx4 a[184:187], v28, s[16:19], s57 offen offset:2048 sc1
    v_mfma_f32_16x16x32_bf16 v[76:79], a[196:199], a[156:159], v[76:79]
    v_add_u32 v13, s63, v13
    v_add_u32 v14, s63, v14
    v_mfma_f32_16x16x32_bf16 v[76:79], a[192:195], a[140:143], v[76:79]
    buffer_load_dwordx4 a[188:191], v29, s[16:19], s57 offen offset:3072 sc1
    s_waitcnt lgkmcnt(4)
    v_mfma_f32_16x16x32_bf16 v[188:191], a[200:203], a[140:143], v[188:191]
    ds_read_b64_tr_b16 a[216:217], v12 offset:14432
    v_mfma_f32_16x16x32_bf16 v[188:191], a[204:207], a[156:159], v[188:191]
    ds_read_b64_tr_b16 a[218:219], v12 offset:18016
    v_mfma_f32_16x16x32_bf16 v[184:187], a[204:207], a[152:155], v[184:187]
    ds_read_b64_tr_b16 a[220:221], v12 offset:21600
    v_mfma_f32_16x16x32_bf16 v[184:187], a[200:203], a[136:139], v[184:187]
    ds_read_b64_tr_b16 a[222:223], v12 offset:25184
    v_mfma_f32_16x16x32_bf16 v[180:183], a[200:203], a[132:135], v[180:183]
    v_lshrrev_b32 v28, 4, v0
    v_and_b32 v29, 15, v0
    v_mfma_f32_16x16x32_bf16 v[180:183], a[204:207], a[148:151], v[180:183]
    v_lshlrev_b32 v30, 8, v28
    v_add_u32 v31, 0, v28
    v_mfma_f32_16x16x32_bf16 v[176:179], a[204:207], a[144:147], v[176:179]
    v_add_u32 v15, s63, v15
    v_xor_b32 v31, v31, v29
    v_mfma_f32_16x16x32_bf16 v[176:179], a[200:203], a[128:131], v[176:179]
    s_waitcnt lgkmcnt(4)
    v_lshl_add_u32 v18, v31, 4, v30
    v_mfma_f32_16x16x32_bf16 v[80:83], a[208:211], a[128:131], v[80:83]
    ds_read_b64_tr_b16 a[192:193], v12 offset:128
    v_mfma_f32_16x16x32_bf16 v[80:83], a[212:215], a[144:147], v[80:83]
    ds_read_b64_tr_b16 a[194:195], v12 offset:3712
    v_mfma_f32_16x16x32_bf16 v[84:87], a[212:215], a[148:151], v[84:87]
    ds_read_b64_tr_b16 a[196:197], v12 offset:7296
    v_mfma_f32_16x16x32_bf16 v[84:87], a[208:211], a[132:135], v[84:87]
    ds_read_b64_tr_b16 a[198:199], v12 offset:10880
    v_mfma_f32_16x16x32_bf16 v[88:91], a[208:211], a[136:139], v[88:91]
    v_add_u32 v31, 4, v28
    v_xor_b32 v31, v31, v29
    v_mfma_f32_16x16x32_bf16 v[88:91], a[212:215], a[152:155], v[88:91]
    v_lshl_add_u32 v19, v31, 4, v30
    v_add_u32 v31, 8, v28
    v_mfma_f32_16x16x32_bf16 v[92:95], a[212:215], a[156:159], v[92:95]
    v_xor_b32 v31, v31, v29
    v_lshl_add_u32 v20, v31, 4, v30
    v_mfma_f32_16x16x32_bf16 v[92:95], a[208:211], a[140:143], v[92:95]
    s_waitcnt lgkmcnt(4)
    v_add_u32 v31, 12, v28
    v_mfma_f32_16x16x32_bf16 v[204:207], a[216:219], a[140:143], v[204:207]
    ds_read_b64_tr_b16 a[200:201], v12 offset:14464
    v_mfma_f32_16x16x32_bf16 v[204:207], a[220:223], a[156:159], v[204:207]
    ds_read_b64_tr_b16 a[202:203], v12 offset:18048
    v_mfma_f32_16x16x32_bf16 v[200:203], a[220:223], a[152:155], v[200:203]
    ds_read_b64_tr_b16 a[204:205], v12 offset:21632
    v_mfma_f32_16x16x32_bf16 v[200:203], a[216:219], a[136:139], v[200:203]
    ds_read_b64_tr_b16 a[206:207], v12 offset:25216
    v_mfma_f32_16x16x32_bf16 v[196:199], a[216:219], a[132:135], v[196:199]
    v_xor_b32 v31, v31, v29
    v_lshl_add_u32 v21, v31, 4, v30
    v_mfma_f32_16x16x32_bf16 v[196:199], a[220:223], a[148:151], v[196:199]
    v_and_b32 v31, 1, v0
    v_lshl_add_u32 v30, v31, 4, v30
    v_mfma_f32_16x16x32_bf16 v[192:195], a[220:223], a[144:147], v[192:195]
    v_lshrrev_b32 v29, 1, v29
    v_add_u32 v31, 0, v28
    v_mfma_f32_16x16x32_bf16 v[192:195], a[216:219], a[128:131], v[192:195]
    s_waitcnt lgkmcnt(4)
    v_mfma_f32_16x16x32_bf16 v[96:99], a[192:195], a[128:131], v[96:99]
    ds_read_b64_tr_b16 a[208:209], v12 offset:160
    v_mfma_f32_16x16x32_bf16 v[96:99], a[196:199], a[144:147], v[96:99]
    ds_read_b64_tr_b16 a[210:211], v12 offset:3744
    v_mfma_f32_16x16x32_bf16 v[100:103], a[196:199], a[148:151], v[100:103]
    ds_read_b64_tr_b16 a[212:213], v12 offset:7328
    v_mfma_f32_16x16x32_bf16 v[100:103], a[192:195], a[132:135], v[100:103]
    ds_read_b64_tr_b16 a[214:215], v12 offset:10912
    v_mfma_f32_16x16x32_bf16 v[104:107], a[192:195], a[136:139], v[104:107]
    v_xor_b32 v31, v31, v29
    v_lshl_add_u32 v22, v31, 5, v30
    v_mfma_f32_16x16x32_bf16 v[104:107], a[196:199], a[152:155], v[104:107]
    v_add_u32 v31, 4, v28
    v_xor_b32 v31, v31, v29
    v_mfma_f32_16x16x32_bf16 v[108:111], a[196:199], a[156:159], v[108:111]
    v_lshl_add_u32 v23, v31, 5, v30
    v_lshrrev_b32 v30, 2, v0
    v_mfma_f32_16x16x32_bf16 v[108:111], a[192:195], a[140:143], v[108:111]
    s_waitcnt lgkmcnt(4)
    v_lshlrev_b32 v30, 7, v30
    v_mfma_f32_16x16x32_bf16 v[220:223], a[200:203], a[140:143], v[220:223]
    ds_read_b64_tr_b16 a[216:217], v12 offset:14496
    v_mfma_f32_16x16x32_bf16 v[220:223], a[204:207], a[156:159], v[220:223]
    ds_read_b64_tr_b16 a[218:219], v12 offset:18080
    v_mfma_f32_16x16x32_bf16 v[216:219], a[204:207], a[152:155], v[216:219]
    ds_read_b64_tr_b16 a[220:221], v12 offset:21664
    v_mfma_f32_16x16x32_bf16 v[216:219], a[200:203], a[136:139], v[216:219]
    ds_read_b64_tr_b16 a[222:223], v12 offset:25248
    v_mfma_f32_16x16x32_bf16 v[212:215], a[200:203], a[132:135], v[212:215]
    s_bfe_u32 s3, s2, 0x30003
    s_lshl_b32 s3, s3, 2
    v_mfma_f32_16x16x32_bf16 v[212:215], a[204:207], a[148:151], v[212:215]
    s_add_u32 s3, s3, s44
    s_lshl_b32 s3, s3, 11
    v_mfma_f32_16x16x32_bf16 v[208:211], a[204:207], a[144:147], v[208:211]
    v_add_u32 v30, s3, v30
    v_min_u32 v30, 53120, v30
    v_mfma_f32_16x16x32_bf16 v[208:211], a[200:203], a[128:131], v[208:211]
    s_waitcnt lgkmcnt(4)
    v_mfma_f32_16x16x32_bf16 v[112:115], a[208:211], a[128:131], v[112:115]
    ds_read_b64_tr_b16 a[192:193], v13 offset:0
    global_load_dword v30, v30, s[74:75]
    v_mfma_f32_16x16x32_bf16 v[112:115], a[212:215], a[144:147], v[112:115]
    ds_read_b64_tr_b16 a[194:195], v13 offset:3584
    v_mfma_f32_16x16x32_bf16 v[116:119], a[212:215], a[148:151], v[116:119]
    ds_read_b64_tr_b16 a[196:197], v13 offset:7168
    v_mfma_f32_16x16x32_bf16 v[116:119], a[208:211], a[132:135], v[116:119]
    ds_read_b64_tr_b16 a[198:199], v13 offset:10752
    v_mfma_f32_16x16x32_bf16 v[120:123], a[208:211], a[136:139], v[120:123]
    s_add_u32 s49, s51, 0
    s_add_u32 m0, s51, 65536
    v_mfma_f32_16x16x32_bf16 v[120:123], a[212:215], a[152:155], v[120:123]
    buffer_load_dwordx4 v18, s[28:31], s49 offen offset:0 lds
    v_mfma_f32_16x16x32_bf16 v[124:127], a[212:215], a[156:159], v[124:127]
    v_mfma_f32_16x16x32_bf16 v[124:127], a[208:211], a[140:143], v[124:127]
    s_waitcnt lgkmcnt(4)
    v_mfma_f32_16x16x32_bf16 v[236:239], a[216:219], a[140:143], v[236:239]
    ds_read_b64_tr_b16 a[200:201], v13 offset:14336
    v_mfma_f32_16x16x32_bf16 v[236:239], a[220:223], a[156:159], v[236:239]
    ds_read_b64_tr_b16 a[202:203], v13 offset:17920
    v_mfma_f32_16x16x32_bf16 v[232:235], a[220:223], a[152:155], v[232:235]
    ds_read_b64_tr_b16 a[204:205], v13 offset:21504
    v_mfma_f32_16x16x32_bf16 v[232:235], a[216:219], a[136:139], v[232:235]
    ds_read_b64_tr_b16 a[206:207], v13 offset:25088
    v_mfma_f32_16x16x32_bf16 v[228:231], a[216:219], a[132:135], v[228:231]
    v_mfma_f32_16x16x32_bf16 v[228:231], a[220:223], a[148:151], v[228:231]
    buffer_load_dwordx4 v19, s[28:31], s49 offen offset:1024 lds
    v_mfma_f32_16x16x32_bf16 v[224:227], a[220:223], a[144:147], v[224:227]
    v_mfma_f32_16x16x32_bf16 v[224:227], a[216:219], a[128:131], v[224:227]
    s_waitcnt lgkmcnt(4)
    v_mfma_f32_16x16x32_bf16 v[128:131], a[192:195], a[128:131], v[128:131]
    ds_read_b64_tr_b16 a[208:209], v14 offset:0
    v_mfma_f32_16x16x32_bf16 v[128:131], a[196:199], a[144:147], v[128:131]
    ds_read_b64_tr_b16 a[210:211], v14 offset:2048
    v_mfma_f32_16x16x32_bf16 v[132:135], a[196:199], a[148:151], v[132:135]
    ds_read_b64_tr_b16 a[212:213], v14 offset:4096
    v_mfma_f32_16x16x32_bf16 v[132:135], a[192:195], a[132:135], v[132:135]
    ds_read_b64_tr_b16 a[214:215], v14 offset:6144
    v_mfma_f32_16x16x32_bf16 v[136:139], a[192:195], a[136:139], v[136:139]
    v_mfma_f32_16x16x32_bf16 v[136:139], a[196:199], a[152:155], v[136:139]
    buffer_load_dwordx4 v20, s[28:31], s49 offen offset:2048 lds
    v_mfma_f32_16x16x32_bf16 v[140:143], a[196:199], a[156:159], v[140:143]
    v_mfma_f32_16x16x32_bf16 v[140:143], a[192:195], a[140:143], v[140:143]
    s_waitcnt lgkmcnt(4)
    v_mfma_f32_16x16x32_bf16 v[252:255], a[200:203], a[140:143], v[252:255]
    ds_read_b64_tr_b16 a[216:217], v14 offset:8
    v_mfma_f32_16x16x32_bf16 v[252:255], a[204:207], a[156:159], v[252:255]
    ds_read_b64_tr_b16 a[218:219], v14 offset:2056
    v_mfma_f32_16x16x32_bf16 v[248:251], a[204:207], a[152:155], v[248:251]
    ds_read_b64_tr_b16 a[220:221], v14 offset:4104
    v_mfma_f32_16x16x32_bf16 v[248:251], a[200:203], a[136:139], v[248:251]
    ds_read_b64_tr_b16 a[222:223], v14 offset:6152
    v_mfma_f32_16x16x32_bf16 v[244:247], a[200:203], a[132:135], v[244:247]
    v_mfma_f32_16x16x32_bf16 v[244:247], a[204:207], a[148:151], v[244:247]
    buffer_load_dwordx4 v21, s[28:31], s49 offen offset:3072 lds
    v_mfma_f32_16x16x32_bf16 v[240:243], a[204:207], a[144:147], v[240:243]
    v_mfma_f32_16x16x32_bf16 v[240:243], a[200:203], a[128:131], v[240:243]
    s_waitcnt lgkmcnt(4)
    v_mfma_f32_16x16x32_bf16 a[0:3], a[208:211], a[128:131], a[0:3]
    ds_read_b64_tr_b16 a[192:193], v15 offset:0
    v_mfma_f32_16x16x32_bf16 a[0:3], a[212:215], a[144:147], a[0:3]
    ds_read_b64_tr_b16 a[194:195], v15 offset:2048
    v_mfma_f32_16x16x32_bf16 a[4:7], a[212:215], a[148:151], a[4:7]
    ds_read_b64_tr_b16 a[196:197], v15 offset:4096
    v_mfma_f32_16x16x32_bf16 a[4:7], a[208:211], a[132:135], a[4:7]
    ds_read_b64_tr_b16 a[198:199], v15 offset:6144
    v_mfma_f32_16x16x32_bf16 a[8:11], a[208:211], a[136:139], a[8:11]
    s_add_u32 s50, s51, 49152
    s_add_u32 m0, s51, 49152
    v_mfma_f32_16x16x32_bf16 a[8:11], a[212:215], a[152:155], a[8:11]
    buffer_load_dwordx4 v18, s[28:31], s50 offen offset:0 lds
    v_mfma_f32_16x16x32_bf16 a[12:15], a[212:215], a[156:159], a[12:15]
    v_mfma_f32_16x16x32_bf16 a[12:15], a[208:211], a[140:143], a[12:15]
    s_waitcnt lgkmcnt(4)
    v_mfma_f32_16x16x32_bf16 a[28:31], a[216:219], a[140:143], a[28:31]
    ds_read_b64_tr_b16 a[200:201], v15 offset:8
    v_mfma_f32_16x16x32_bf16 a[28:31], a[220:223], a[156:159], a[28:31]
    ds_read_b64_tr_b16 a[202:203], v15 offset:2056
    v_mfma_f32_16x16x32_bf16 a[24:27], a[220:223], a[152:155], a[24:27]
    ds_read_b64_tr_b16 a[204:205], v15 offset:4104
    v_mfma_f32_16x16x32_bf16 a[24:27], a[216:219], a[136:139], a[24:27]
    ds_read_b64_tr_b16 a[206:207], v15 offset:6152
    v_mfma_f32_16x16x32_bf16 a[20:23], a[216:219], a[132:135], a[20:23]
    v_mfma_f32_16x16x32_bf16 a[20:23], a[220:223], a[148:151], a[20:23]
    buffer_load_dwordx4 v19, s[28:31], s50 offen offset:1024 lds
    v_mfma_f32_16x16x32_bf16 a[16:19], a[220:223], a[144:147], a[16:19]
    v_mfma_f32_16x16x32_bf16 a[16:19], a[216:219], a[128:131], a[16:19]
    s_waitcnt lgkmcnt(4)
    v_mfma_f32_16x16x32_bf16 a[32:35], a[192:195], a[128:131], a[32:35]
    ds_read_b64_tr_b16 a[208:209], v14 offset:8192
    v_mfma_f32_16x16x32_bf16 a[32:35], a[196:199], a[144:147], a[32:35]
    ds_read_b64_tr_b16 a[210:211], v14 offset:10240
    v_mfma_f32_16x16x32_bf16 a[36:39], a[196:199], a[148:151], a[36:39]
    ds_read_b64_tr_b16 a[212:213], v14 offset:12288
    v_mfma_f32_16x16x32_bf16 a[36:39], a[192:195], a[132:135], a[36:39]
    ds_read_b64_tr_b16 a[214:215], v14 offset:14336
    v_mfma_f32_16x16x32_bf16 a[40:43], a[192:195], a[136:139], a[40:43]
    v_mfma_f32_16x16x32_bf16 a[40:43], a[196:199], a[152:155], a[40:43]
    buffer_load_dwordx4 v20, s[28:31], s50 offen offset:2048 lds
    v_mfma_f32_16x16x32_bf16 a[44:47], a[196:199], a[156:159], a[44:47]
    v_mfma_f32_16x16x32_bf16 a[44:47], a[192:195], a[140:143], a[44:47]
    s_waitcnt lgkmcnt(4)
    v_mfma_f32_16x16x32_bf16 a[60:63], a[200:203], a[140:143], a[60:63]
    ds_read_b64_tr_b16 a[216:217], v14 offset:8200
    v_mfma_f32_16x16x32_bf16 a[60:63], a[204:207], a[156:159], a[60:63]
    ds_read_b64_tr_b16 a[218:219], v14 offset:10248
    v_mfma_f32_16x16x32_bf16 a[56:59], a[204:207], a[152:155], a[56:59]
    ds_read_b64_tr_b16 a[220:221], v14 offset:12296
    v_mfma_f32_16x16x32_bf16 a[56:59], a[200:203], a[136:139], a[56:59]
    ds_read_b64_tr_b16 a[222:223], v14 offset:14344
    v_mfma_f32_16x16x32_bf16 a[52:55], a[200:203], a[132:135], a[52:55]
    v_mfma_f32_16x16x32_bf16 a[52:55], a[204:207], a[148:151], a[52:55]
    buffer_load_dwordx4 v21, s[28:31], s50 offen offset:3072 lds
    v_mfma_f32_16x16x32_bf16 a[48:51], a[204:207], a[144:147], a[48:51]
    v_mfma_f32_16x16x32_bf16 a[48:51], a[200:203], a[128:131], a[48:51]
    s_waitcnt lgkmcnt(4)
    v_mfma_f32_16x16x32_bf16 a[64:67], a[208:211], a[128:131], a[64:67]
    ds_read_b64_tr_b16 a[192:193], v15 offset:8192
    v_mfma_f32_16x16x32_bf16 a[64:67], a[212:215], a[144:147], a[64:67]
    ds_read_b64_tr_b16 a[194:195], v15 offset:10240
    v_mfma_f32_16x16x32_bf16 a[68:71], a[212:215], a[148:151], a[68:71]
    ds_read_b64_tr_b16 a[196:197], v15 offset:12288
    v_mfma_f32_16x16x32_bf16 a[68:71], a[208:211], a[132:135], a[68:71]
    ds_read_b64_tr_b16 a[198:199], v15 offset:14336
    v_mfma_f32_16x16x32_bf16 a[72:75], a[208:211], a[136:139], a[72:75]
    v_mfma_f32_16x16x32_bf16 a[72:75], a[212:215], a[152:155], a[72:75]
    v_mfma_f32_16x16x32_bf16 a[76:79], a[212:215], a[156:159], a[76:79]
    v_mfma_f32_16x16x32_bf16 a[76:79], a[208:211], a[140:143], a[76:79]
    s_waitcnt lgkmcnt(4)
    v_mfma_f32_16x16x32_bf16 a[92:95], a[216:219], a[140:143], a[92:95]
    ds_read_b64_tr_b16 a[200:201], v15 offset:8200
    v_mfma_f32_16x16x32_bf16 a[92:95], a[220:223], a[156:159], a[92:95]
    ds_read_b64_tr_b16 a[202:203], v15 offset:10248
    v_mfma_f32_16x16x32_bf16 a[88:91], a[220:223], a[152:155], a[88:91]
    ds_read_b64_tr_b16 a[204:205], v15 offset:12296
    v_mfma_f32_16x16x32_bf16 a[88:91], a[216:219], a[136:139], a[88:91]
    ds_read_b64_tr_b16 a[206:207], v15 offset:14344
    v_mfma_f32_16x16x32_bf16 a[84:87], a[216:219], a[132:135], a[84:87]
    v_mfma_f32_16x16x32_bf16 a[84:87], a[220:223], a[148:151], a[84:87]
    v_mfma_f32_16x16x32_bf16 a[80:83], a[220:223], a[144:147], a[80:83]
    v_mfma_f32_16x16x32_bf16 a[80:83], a[216:219], a[128:131], a[80:83]
    s_waitcnt lgkmcnt(4)
    v_mfma_f32_16x16x32_bf16 a[96:99], a[192:195], a[128:131], a[96:99]
    s_add_u32 s65, s65, 45056
    s_cmp_eq_u32 s65, 135168
    v_mfma_f32_16x16x32_bf16 a[96:99], a[196:199], a[144:147], a[96:99]
    s_cselect_b32 s63, s66, s67
    s_cselect_b32 s65, 0, s65
    v_mfma_f32_16x16x32_bf16 a[100:103], a[196:199], a[148:151], a[100:103]
    v_mfma_f32_16x16x32_bf16 a[100:103], a[192:195], a[132:135], a[100:103]
    v_mfma_f32_16x16x32_bf16 a[104:107], a[192:195], a[136:139], a[104:107]
    v_mfma_f32_16x16x32_bf16 a[104:107], a[196:199], a[152:155], a[104:107]
    v_mfma_f32_16x16x32_bf16 a[108:111], a[196:199], a[156:159], a[108:111]
    v_mfma_f32_16x16x32_bf16 a[108:111], a[192:195], a[140:143], a[108:111]
    s_waitcnt vmcnt(8) lgkmcnt(0)
    s_barrier
    v_add_u32 v12, s63, v12
    v_mfma_f32_16x16x32_bf16 a[124:127], a[200:203], a[140:143], a[124:127]
    ds_read_b64_tr_b16 a[208:209], v12 offset:0
    v_mfma_f32_16x16x32_bf16 a[124:127], a[204:207], a[156:159], a[124:127]
    ds_read_b64_tr_b16 a[210:211], v12 offset:3584
    v_mfma_f32_16x16x32_bf16 a[120:123], a[204:207], a[152:155], a[120:123]
    ds_read_b64_tr_b16 a[212:213], v12 offset:7168
    v_mfma_f32_16x16x32_bf16 a[120:123], a[200:203], a[136:139], a[120:123]
    ds_read_b64_tr_b16 a[214:215], v12 offset:10752
    v_mfma_f32_16x16x32_bf16 a[116:119], a[200:203], a[132:135], a[116:119]
    ds_read_b64_tr_b16 a[216:217], v12 offset:14336
    v_mfma_f32_16x16x32_bf16 a[116:119], a[204:207], a[148:151], a[116:119]
    ds_read_b64_tr_b16 a[218:219], v12 offset:17920
    v_mfma_f32_16x16x32_bf16 a[112:115], a[204:207], a[144:147], a[112:115]
    ds_read_b64_tr_b16 a[220:221], v12 offset:21504
    v_mfma_f32_16x16x32_bf16 a[112:115], a[200:203], a[128:131], a[112:115]
    ds_read_b64_tr_b16 a[222:223], v12 offset:25088
    s_waitcnt lgkmcnt(4)
    v_mfma_f32_16x16x32_bf16 v[32:35], a[208:211], a[160:163], v[32:35]
    ds_read_b64_tr_b16 a[192:193], v12 offset:32
    v_mfma_f32_16x16x32_bf16 v[32:35], a[212:215], a[176:179], v[32:35]
    ds_read_b64_tr_b16 a[194:195], v12 offset:3616
    v_mfma_f32_16x16x32_bf16 v[36:39], a[212:215], a[180:183], v[36:39]
    ds_read_b64_tr_b16 a[196:197], v12 offset:7200
    v_mfma_f32_16x16x32_bf16 v[36:39], a[208:211], a[164:167], v[36:39]
    ds_read_b64_tr_b16 a[198:199], v12 offset:10784
    v_mfma_f32_16x16x32_bf16 v[40:43], a[208:211], a[168:171], v[40:43]
    v_mfma_f32_16x16x32_bf16 v[40:43], a[212:215], a[184:187], v[40:43]
    buffer_store_dwordx4 a[224:227], v25, s[36:39], s70 offen sc1
    v_mfma_f32_16x16x32_bf16 v[44:47], a[212:215], a[188:191], v[44:47]
    v_mfma_f32_16x16x32_bf16 v[44:47], a[208:211], a[172:175], v[44:47]
    buffer_store_dwordx4 a[228:231], v25, s[36:39], s71 offen sc1
    s_waitcnt lgkmcnt(4)
    v_mfma_f32_16x16x32_bf16 v[156:159], a[216:219], a[172:175], v[156:159]
    ds_read_b64_tr_b16 a[200:201], v12 offset:14368
    v_mfma_f32_16x16x32_bf16 v[156:159], a[220:223], a[188:191], v[156:159]
    ds_read_b64_tr_b16 a[202:203], v12 offset:17952
    v_mfma_f32_16x16x32_bf16 v[152:155], a[220:223], a[184:187], v[152:155]
    ds_read_b64_tr_b16 a[204:205], v12 offset:21536
    v_mfma_f32_16x16x32_bf16 v[152:155], a[216:219], a[168:171], v[152:155]
    ds_read_b64_tr_b16 a[206:207], v12 offset:25120
    v_mfma_f32_16x16x32_bf16 v[148:151], a[216:219], a[164:167], v[148:151]
    s_add_u32 s49, s51, 16384
    s_add_u32 m0, s51, 81920
    v_mfma_f32_16x16x32_bf16 v[148:151], a[220:223], a[180:183], v[148:151]
    buffer_load_dwordx4 v18, s[28:31], s49 offen offset:0 lds
    v_mfma_f32_16x16x32_bf16 v[144:147], a[220:223], a[176:179], v[144:147]
    v_mfma_f32_16x16x32_bf16 v[144:147], a[216:219], a[160:163], v[144:147]
    buffer_load_dwordx4 v19, s[28:31], s49 offen offset:1024 lds
    s_waitcnt lgkmcnt(4)
    v_mfma_f32_16x16x32_bf16 v[48:51], a[192:195], a[160:163], v[48:51]
    ds_read_b64_tr_b16 a[208:209], v12 offset:64
    v_mfma_f32_16x16x32_bf16 v[48:51], a[196:199], a[176:179], v[48:51]
    ds_read_b64_tr_b16 a[210:211], v12 offset:3648
    v_mfma_f32_16x16x32_bf16 v[52:55], a[196:199], a[180:183], v[52:55]
    ds_read_b64_tr_b16 a[212:213], v12 offset:7232
    v_mfma_f32_16x16x32_bf16 v[52:55], a[192:195], a[164:167], v[52:55]
    ds_read_b64_tr_b16 a[214:215], v12 offset:10816
    v_mfma_f32_16x16x32_bf16 v[56:59], a[192:195], a[168:171], v[56:59]
    v_mfma_f32_16x16x32_bf16 v[56:59], a[196:199], a[184:187], v[56:59]
    buffer_load_dwordx4 v20, s[28:31], s49 offen offset:2048 lds
    v_mfma_f32_16x16x32_bf16 v[60:63], a[196:199], a[188:191], v[60:63]
    v_mfma_f32_16x16x32_bf16 v[60:63], a[192:195], a[172:175], v[60:63]
    buffer_load_dwordx4 v21, s[28:31], s49 offen offset:3072 lds
    s_waitcnt lgkmcnt(4)
    v_mfma_f32_16x16x32_bf16 v[172:175], a[200:203], a[172:175], v[172:175]
    ds_read_b64_tr_b16 a[216:217], v12 offset:14400
    v_mfma_f32_16x16x32_bf16 v[172:175], a[204:207], a[188:191], v[172:175]
    ds_read_b64_tr_b16 a[218:219], v12 offset:17984
    v_mfma_f32_16x16x32_bf16 v[168:171], a[204:207], a[184:187], v[168:171]
    ds_read_b64_tr_b16 a[220:221], v12 offset:21568
    v_mfma_f32_16x16x32_bf16 v[168:171], a[200:203], a[168:171], v[168:171]
    ds_read_b64_tr_b16 a[222:223], v12 offset:25152
    v_mfma_f32_16x16x32_bf16 v[164:167], a[200:203], a[164:167], v[164:167]
    s_add_u32 s50, s51, 0
    s_add_u32 m0, s51, 98304
    v_mfma_f32_16x16x32_bf16 v[164:167], a[204:207], a[180:183], v[164:167]
    buffer_load_dwordx4 v22, s[32:35], s50 offen offset:0 lds
    v_mfma_f32_16x16x32_bf16 v[160:163], a[204:207], a[176:179], v[160:163]
    v_mfma_f32_16x16x32_bf16 v[160:163], a[200:203], a[160:163], v[160:163]
    buffer_load_dwordx4 v23, s[32:35], s50 offen offset:1024 lds
    s_waitcnt lgkmcnt(4)
    v_mfma_f32_16x16x32_bf16 v[64:67], a[208:211], a[160:163], v[64:67]
    ds_read_b64_tr_b16 a[192:193], v12 offset:96
    v_mfma_f32_16x16x32_bf16 v[64:67], a[212:215], a[176:179], v[64:67]
    ds_read_b64_tr_b16 a[194:195], v12 offset:3680
    v_mfma_f32_16x16x32_bf16 v[68:71], a[212:215], a[180:183], v[68:71]
    ds_read_b64_tr_b16 a[196:197], v12 offset:7264
    v_mfma_f32_16x16x32_bf16 v[68:71], a[208:211], a[164:167], v[68:71]
    ds_read_b64_tr_b16 a[198:199], v12 offset:10848
    v_mfma_f32_16x16x32_bf16 v[72:75], a[208:211], a[168:171], v[72:75]
    v_mfma_f32_16x16x32_bf16 v[72:75], a[212:215], a[184:187], v[72:75]
    buffer_load_dwordx4 v22, s[32:35], s50 offen offset:2048 lds
    v_mfma_f32_16x16x32_bf16 v[76:79], a[212:215], a[188:191], v[76:79]
    v_add_u32 v13, s63, v13
    v_add_u32 v14, s63, v14
    v_mfma_f32_16x16x32_bf16 v[76:79], a[208:211], a[172:175], v[76:79]
    s_waitcnt lgkmcnt(4)
    v_mfma_f32_16x16x32_bf16 v[188:191], a[216:219], a[172:175], v[188:191]
    ds_read_b64_tr_b16 a[200:201], v12 offset:14432
    v_mfma_f32_16x16x32_bf16 v[188:191], a[220:223], a[188:191], v[188:191]
    ds_read_b64_tr_b16 a[202:203], v12 offset:18016
    v_mfma_f32_16x16x32_bf16 v[184:187], a[220:223], a[184:187], v[184:187]
    ds_read_b64_tr_b16 a[204:205], v12 offset:21600
    v_mfma_f32_16x16x32_bf16 v[184:187], a[216:219], a[168:171], v[184:187]
    ds_read_b64_tr_b16 a[206:207], v12 offset:25184
    v_mfma_f32_16x16x32_bf16 v[180:183], a[216:219], a[164:167], v[180:183]
    s_bfe_u32 s56, s2, 0x10007
    s_and_b32 s57, s2, 3
    v_mfma_f32_16x16x32_bf16 v[180:183], a[220:223], a[180:183], v[180:183]
    buffer_load_dwordx4 v23, s[32:35], s50 offen offset:3072 lds
    v_mfma_f32_16x16x32_bf16 v[176:179], a[220:223], a[176:179], v[176:179]
    v_add_u32 v15, s63, v15
    s_lshl_b32 s57, s57, 2
    v_mfma_f32_16x16x32_bf16 v[176:179], a[216:219], a[160:163], v[176:179]
    s_waitcnt lgkmcnt(4)
    s_bfe_u32 s3, s2, 0x20003
    v_mfma_f32_16x16x32_bf16 v[80:83], a[192:195], a[160:163], v[80:83]
    ds_read_b64_tr_b16 a[208:209], v12 offset:128
    v_mfma_f32_16x16x32_bf16 v[80:83], a[196:199], a[176:179], v[80:83]
    ds_read_b64_tr_b16 a[210:211], v12 offset:3712
    v_mfma_f32_16x16x32_bf16 v[84:87], a[196:199], a[180:183], v[84:87]
    ds_read_b64_tr_b16 a[212:213], v12 offset:7296
    v_mfma_f32_16x16x32_bf16 v[84:87], a[192:195], a[164:167], v[84:87]
    ds_read_b64_tr_b16 a[214:215], v12 offset:10880
    v_mfma_f32_16x16x32_bf16 v[88:91], a[192:195], a[168:171], v[88:91]
    s_add_u32 s53, s51, 16384
    s_add_u32 m0, s51, 114688
    v_mfma_f32_16x16x32_bf16 v[88:91], a[196:199], a[184:187], v[88:91]
    buffer_load_dwordx4 v22, s[32:35], s53 offen offset:0 lds
    v_mfma_f32_16x16x32_bf16 v[92:95], a[196:199], a[188:191], v[92:95]
    s_add_u32 s57, s57, s3
    s_lshr_b32 s58, s2, 5
    v_mfma_f32_16x16x32_bf16 v[92:95], a[192:195], a[172:175], v[92:95]
    s_waitcnt lgkmcnt(4)
    s_and_b32 s3, s2, 4
    v_mfma_f32_16x16x32_bf16 v[204:207], a[200:203], a[172:175], v[204:207]
    ds_read_b64_tr_b16 a[216:217], v12 offset:14464
    v_mfma_f32_16x16x32_bf16 v[204:207], a[204:207], a[188:191], v[204:207]
    ds_read_b64_tr_b16 a[218:219], v12 offset:18048
    v_mfma_f32_16x16x32_bf16 v[200:203], a[204:207], a[184:187], v[200:203]
    ds_read_b64_tr_b16 a[220:221], v12 offset:21632
    v_mfma_f32_16x16x32_bf16 v[200:203], a[200:203], a[168:171], v[200:203]
    ds_read_b64_tr_b16 a[222:223], v12 offset:25216
    v_mfma_f32_16x16x32_bf16 v[196:199], a[200:203], a[164:167], v[196:199]
    s_xor_b32 s58, s58, s3
    s_and_b32 s59, s44, 1
    v_mfma_f32_16x16x32_bf16 v[196:199], a[204:207], a[180:183], v[196:199]
    buffer_load_dwordx4 v23, s[32:35], s53 offen offset:1024 lds
    v_mfma_f32_16x16x32_bf16 v[192:195], a[204:207], a[176:179], v[192:195]
    s_lshr_b32 s60, s44, 1
    s_lshl_b32 s3, s57, 1
    v_mfma_f32_16x16x32_bf16 v[192:195], a[200:203], a[160:163], v[192:195]
    s_waitcnt lgkmcnt(4)
    s_add_u32 s3, s3, s59
    v_mfma_f32_16x16x32_bf16 v[96:99], a[208:211], a[160:163], v[96:99]
    ds_read_b64_tr_b16 a[192:193], v12 offset:160
    v_mfma_f32_16x16x32_bf16 v[96:99], a[212:215], a[176:179], v[96:99]
    ds_read_b64_tr_b16 a[194:195], v12 offset:3744
    v_mfma_f32_16x16x32_bf16 v[100:103], a[212:215], a[180:183], v[100:103]
    ds_read_b64_tr_b16 a[196:197], v12 offset:7328
    v_mfma_f32_16x16x32_bf16 v[100:103], a[208:211], a[164:167], v[100:103]
    ds_read_b64_tr_b16 a[198:199], v12 offset:10912
    v_mfma_f32_16x16x32_bf16 v[104:107], a[208:211], a[168:171], v[104:107]
    s_mov_b32 s18, 573440
    s_mov_b32 s61, 220200960
    v_mfma_f32_16x16x32_bf16 v[104:107], a[212:215], a[184:187], v[104:107]
    buffer_load_dwordx4 v22, s[32:35], s53 offen offset:2048 lds
    v_mfma_f32_16x16x32_bf16 v[108:111], a[212:215], a[188:191], v[108:111]
    s_cmp_eq_u32 s56, 0
    s_cmov_b32 s18, 655360
    s_cmov_b32 s61, 199229440
    s_cselect_b32 s22, 32, 28
    s_cselect_b32 s66, 6, 5
    v_mfma_f32_16x16x32_bf16 v[108:111], a[208:211], a[172:175], v[108:111]
    s_waitcnt lgkmcnt(4)
    s_mul_i32 s3, s3, s18
    v_mfma_f32_16x16x32_bf16 v[220:223], a[216:219], a[172:175], v[220:223]
    ds_read_b64_tr_b16 a[200:201], v12 offset:14496
    v_mfma_f32_16x16x32_bf16 v[220:223], a[220:223], a[188:191], v[220:223]
    ds_read_b64_tr_b16 a[202:203], v12 offset:18080
    v_mfma_f32_16x16x32_bf16 v[216:219], a[220:223], a[184:187], v[216:219]
    ds_read_b64_tr_b16 a[204:205], v12 offset:21664
    v_mfma_f32_16x16x32_bf16 v[216:219], a[216:219], a[168:171], v[216:219]
    ds_read_b64_tr_b16 a[206:207], v12 offset:25248
    v_mfma_f32_16x16x32_bf16 v[212:215], a[216:219], a[164:167], v[212:215]
    s_add_u32 s3, s3, s61
    s_lshr_b32 s18, s18, 1
    v_mfma_f32_16x16x32_bf16 v[212:215], a[220:223], a[180:183], v[212:215]
    buffer_load_dwordx4 v23, s[32:35], s53 offen offset:3072 lds
    v_mfma_f32_16x16x32_bf16 v[208:211], a[220:223], a[176:179], v[208:211]
    s_mul_i32 s61, s18, s60
    s_add_u32 s3, s3, s61
    v_mfma_f32_16x16x32_bf16 v[208:211], a[216:219], a[160:163], v[208:211]
    s_waitcnt lgkmcnt(4)
    v_mfma_f32_16x16x32_bf16 v[112:115], a[192:195], a[160:163], v[112:115]
    ds_read_b64_tr_b16 a[208:209], v13 offset:0
    v_mfma_f32_16x16x32_bf16 v[112:115], a[196:199], a[176:179], v[112:115]
    ds_read_b64_tr_b16 a[210:211], v13 offset:3584
    v_mfma_f32_16x16x32_bf16 v[116:119], a[196:199], a[180:183], v[116:119]
    ds_read_b64_tr_b16 a[212:213], v13 offset:7168
    v_mfma_f32_16x16x32_bf16 v[116:119], a[192:195], a[164:167], v[116:119]
    ds_read_b64_tr_b16 a[214:215], v13 offset:10752
    v_mfma_f32_16x16x32_bf16 v[120:123], a[192:195], a[168:171], v[120:123]
    s_add_u32 s16, s10, s3
    s_addc_u32 s17, s11, 0
    v_mfma_f32_16x16x32_bf16 v[120:123], a[196:199], a[184:187], v[120:123]
    s_lshl_b32 s22, s22, 17
    s_mul_i32 s3, s22, s60
    v_mfma_f32_16x16x32_bf16 v[124:127], a[196:199], a[188:191], v[124:127]
    s_lshl_b32 s61, s59, 16
    s_lshl_b32 s62, s58, 8
    v_mfma_f32_16x16x32_bf16 v[124:127], a[192:195], a[172:175], v[124:127]
    s_waitcnt lgkmcnt(4)
    s_add_u32 s61, s61, s62
    v_mfma_f32_16x16x32_bf16 v[236:239], a[200:203], a[172:175], v[236:239]
    ds_read_b64_tr_b16 a[216:217], v13 offset:14336
    v_mfma_f32_16x16x32_bf16 v[236:239], a[204:207], a[188:191], v[236:239]
    ds_read_b64_tr_b16 a[218:219], v13 offset:17920
    v_mfma_f32_16x16x32_bf16 v[232:235], a[204:207], a[184:187], v[232:235]
    ds_read_b64_tr_b16 a[220:221], v13 offset:21504
    v_mfma_f32_16x16x32_bf16 v[232:235], a[200:203], a[168:171], v[232:235]
    ds_read_b64_tr_b16 a[222:223], v13 offset:25088
    v_mfma_f32_16x16x32_bf16 v[228:231], a[200:203], a[164:167], v[228:231]
    s_add_u32 s3, s3, s61
    s_sub_u32 s22, s22, s61
    v_mfma_f32_16x16x32_bf16 v[228:231], a[204:207], a[180:183], v[228:231]
    s_add_u32 s20, s20, s3
    s_addc_u32 s21, s21, 0
    v_mfma_f32_16x16x32_bf16 v[224:227], a[204:207], a[176:179], v[224:227]
    s_lshl_b32 s65, s60, 14
    s_lshl_b32 s3, s59, 12
    v_mfma_f32_16x16x32_bf16 v[224:227], a[200:203], a[160:163], v[224:227]
    s_waitcnt lgkmcnt(4)
    s_add_u32 s65, s65, s3
    v_mfma_f32_16x16x32_bf16 v[128:131], a[208:211], a[160:163], v[128:131]
    ds_read_b64_tr_b16 a[192:193], v14 offset:0
    v_mfma_f32_16x16x32_bf16 v[128:131], a[212:215], a[176:179], v[128:131]
    ds_read_b64_tr_b16 a[194:195], v14 offset:2048
    v_mfma_f32_16x16x32_bf16 v[132:135], a[212:215], a[180:183], v[132:135]
    ds_read_b64_tr_b16 a[196:197], v14 offset:4096
    v_mfma_f32_16x16x32_bf16 v[132:135], a[208:211], a[164:167], v[132:135]
    ds_read_b64_tr_b16 a[198:199], v14 offset:6144
    v_mfma_f32_16x16x32_bf16 v[136:139], a[208:211], a[168:171], v[136:139]
    s_mov_b32 s61, 0
    s_mov_b32 s62, 4096
    v_mfma_f32_16x16x32_bf16 v[136:139], a[212:215], a[184:187], v[136:139]
    s_lshl_b32 s67, s44, 13
    s_add_u32 s67, s67, 131072
    v_mfma_f32_16x16x32_bf16 v[140:143], a[212:215], a[188:191], v[140:143]
    s_lshl_b32 s3, s57, 7
    s_lshl_b32 s63, s59, 6
    v_mfma_f32_16x16x32_bf16 v[140:143], a[208:211], a[172:175], v[140:143]
    s_waitcnt lgkmcnt(4)
    s_add_u32 s3, s3, s63
    v_mfma_f32_16x16x32_bf16 v[252:255], a[216:219], a[172:175], v[252:255]
    ds_read_b64_tr_b16 a[200:201], v14 offset:8
    v_mfma_f32_16x16x32_bf16 v[252:255], a[220:223], a[188:191], v[252:255]
    ds_read_b64_tr_b16 a[202:203], v14 offset:2056
    v_mfma_f32_16x16x32_bf16 v[248:251], a[220:223], a[184:187], v[248:251]
    ds_read_b64_tr_b16 a[204:205], v14 offset:4104
    v_mfma_f32_16x16x32_bf16 v[248:251], a[216:219], a[168:171], v[248:251]
    ds_read_b64_tr_b16 a[206:207], v14 offset:6152
    v_mfma_f32_16x16x32_bf16 v[244:247], a[216:219], a[164:167], v[244:247]
    s_lshl_b32 s63, s60, 5
    s_add_u32 s3, s3, s63
    v_mfma_f32_16x16x32_bf16 v[244:247], a[220:223], a[180:183], v[244:247]
    s_lshl_b32 s3, s3, 11
    s_lshl_b32 s63, s58, 8
    v_mfma_f32_16x16x32_bf16 v[240:243], a[220:223], a[176:179], v[240:243]
    s_add_u32 s3, s3, s63
    v_mfma_f32_16x16x32_bf16 v[240:243], a[216:219], a[160:163], v[240:243]
    s_waitcnt lgkmcnt(4)
    v_mfma_f32_16x16x32_bf16 a[0:3], a[192:195], a[160:163], a[0:3]
    ds_read_b64_tr_b16 a[208:209], v15 offset:0
    v_mfma_f32_16x16x32_bf16 a[0:3], a[196:199], a[176:179], a[0:3]
    ds_read_b64_tr_b16 a[210:211], v15 offset:2048
    v_mfma_f32_16x16x32_bf16 a[4:7], a[196:199], a[180:183], a[4:7]
    ds_read_b64_tr_b16 a[212:213], v15 offset:4096
    v_mfma_f32_16x16x32_bf16 a[4:7], a[192:195], a[164:167], a[4:7]
    ds_read_b64_tr_b16 a[214:215], v15 offset:6144
    v_mfma_f32_16x16x32_bf16 a[8:11], a[192:195], a[168:171], a[8:11]
    s_add_u32 s24, s8, s3
    s_addc_u32 s25, s9, 0
    v_mfma_f32_16x16x32_bf16 a[8:11], a[196:199], a[184:187], a[8:11]
    s_mov_b32 s26, 63744
    s_mov_b32 s27, 0x20000
    v_mfma_f32_16x16x32_bf16 a[12:15], a[196:199], a[188:191], a[12:15]
    s_add_u32 s4, s4, s3
    s_addc_u32 s5, s5, 0
    v_mfma_f32_16x16x32_bf16 a[12:15], a[192:195], a[172:175], a[12:15]
    s_waitcnt lgkmcnt(4)
    s_mov_b32 s6, 63744
    v_mfma_f32_16x16x32_bf16 a[28:31], a[200:203], a[172:175], a[28:31]
    ds_read_b64_tr_b16 a[216:217], v15 offset:8
    v_mfma_f32_16x16x32_bf16 a[28:31], a[204:207], a[188:191], a[28:31]
    ds_read_b64_tr_b16 a[218:219], v15 offset:2056
    v_mfma_f32_16x16x32_bf16 a[24:27], a[204:207], a[184:187], a[24:27]
    ds_read_b64_tr_b16 a[220:221], v15 offset:4104
    v_mfma_f32_16x16x32_bf16 a[24:27], a[200:203], a[168:171], a[24:27]
    ds_read_b64_tr_b16 a[222:223], v15 offset:6152
    v_mfma_f32_16x16x32_bf16 a[20:23], a[200:203], a[164:167], a[20:23]
    s_mov_b32 s7, 0x20000
    s_mul_i32 s3, s48, 573440
    v_mfma_f32_16x16x32_bf16 a[20:23], a[204:207], a[180:183], a[20:23]
    s_add_u32 s3, s3, 220200960
    v_mfma_f32_16x16x32_bf16 a[16:19], a[204:207], a[176:179], a[16:19]
    s_add_u32 s36, s10, s3
    s_addc_u32 s37, s11, 0
    v_mfma_f32_16x16x32_bf16 a[16:19], a[200:203], a[160:163], a[16:19]
    s_waitcnt lgkmcnt(4)
    s_mov_b32 s38, 573440
    v_mfma_f32_16x16x32_bf16 a[32:35], a[208:211], a[160:163], a[32:35]
    ds_read_b64_tr_b16 a[192:193], v14 offset:8192
    v_mfma_f32_16x16x32_bf16 a[32:35], a[212:215], a[176:179], a[32:35]
    ds_read_b64_tr_b16 a[194:195], v14 offset:10240
    v_mfma_f32_16x16x32_bf16 a[36:39], a[212:215], a[180:183], a[36:39]
    ds_read_b64_tr_b16 a[196:197], v14 offset:12288
    v_mfma_f32_16x16x32_bf16 a[36:39], a[208:211], a[164:167], a[36:39]
    ds_read_b64_tr_b16 a[198:199], v14 offset:14336
    v_mfma_f32_16x16x32_bf16 a[40:43], a[208:211], a[168:171], a[40:43]
    s_mov_b32 s39, 0x20000
    s_lshr_b32 s3, s46, 1
    v_mfma_f32_16x16x32_bf16 a[40:43], a[212:215], a[184:187], a[40:43]
    s_mul_i32 s3, s3, 7
    s_add_u32 s71, s3, 3
    v_mfma_f32_16x16x32_bf16 a[44:47], a[212:215], a[188:191], a[44:47]
    s_lshl_b32 s68, s47, 2
    s_add_u32 s68, s68, s3
    v_mfma_f32_16x16x32_bf16 a[44:47], a[208:211], a[172:175], a[44:47]
    s_waitcnt lgkmcnt(4)
    s_add_u32 s69, s68, 1
    v_mfma_f32_16x16x32_bf16 a[60:63], a[216:219], a[172:175], a[60:63]
    ds_read_b64_tr_b16 a[200:201], v14 offset:8200
    v_mfma_f32_16x16x32_bf16 a[60:63], a[220:223], a[188:191], a[60:63]
    ds_read_b64_tr_b16 a[202:203], v14 offset:10248
    v_mfma_f32_16x16x32_bf16 a[56:59], a[220:223], a[184:187], a[56:59]
    ds_read_b64_tr_b16 a[204:205], v14 offset:12296
    v_mfma_f32_16x16x32_bf16 a[56:59], a[216:219], a[168:171], a[56:59]
    ds_read_b64_tr_b16 a[206:207], v14 offset:14344
    v_mfma_f32_16x16x32_bf16 a[52:55], a[216:219], a[164:167], a[52:55]
    s_add_u32 s70, s68, 2
    s_and_b32 s45, s68, 1
    v_mfma_f32_16x16x32_bf16 a[52:55], a[220:223], a[180:183], a[52:55]
    s_lshr_b32 s3, s68, 1
    s_mul_i32 s3, s3, 10240
    v_mfma_f32_16x16x32_bf16 a[48:51], a[220:223], a[176:179], a[48:51]
    s_and_b32 s68, s68, 1
    s_lshl_b32 s68, s68, 12
    v_mfma_f32_16x16x32_bf16 a[48:51], a[216:219], a[160:163], a[48:51]
    s_waitcnt lgkmcnt(4)
    s_add_u32 s68, s68, s3
    v_mfma_f32_16x16x32_bf16 a[64:67], a[192:195], a[160:163], a[64:67]
    ds_read_b64_tr_b16 a[208:209], v15 offset:8192
    v_mfma_f32_16x16x32_bf16 a[64:67], a[196:199], a[176:179], a[64:67]
    ds_read_b64_tr_b16 a[210:211], v15 offset:10240
    v_mfma_f32_16x16x32_bf16 a[68:71], a[196:199], a[180:183], a[68:71]
    ds_read_b64_tr_b16 a[212:213], v15 offset:12288
    v_mfma_f32_16x16x32_bf16 a[68:71], a[192:195], a[164:167], a[68:71]
    ds_read_b64_tr_b16 a[214:215], v15 offset:14336
    v_mfma_f32_16x16x32_bf16 a[72:75], a[192:195], a[168:171], a[72:75]
    s_lshr_b32 s3, s69, 1
    s_mul_i32 s3, s3, 10240
    v_mfma_f32_16x16x32_bf16 a[72:75], a[196:199], a[184:187], a[72:75]
    s_and_b32 s69, s69, 1
    s_lshl_b32 s69, s69, 12
    v_mfma_f32_16x16x32_bf16 a[76:79], a[196:199], a[188:191], a[76:79]
    s_add_u32 s69, s69, s3
    s_lshr_b32 s3, s70, 1
    v_mfma_f32_16x16x32_bf16 a[76:79], a[192:195], a[172:175], a[76:79]
    s_waitcnt lgkmcnt(4)
    s_mul_i32 s3, s3, 10240
    v_mfma_f32_16x16x32_bf16 a[92:95], a[200:203], a[172:175], a[92:95]
    ds_read_b64_tr_b16 a[216:217], v15 offset:8200
    v_mfma_f32_16x16x32_bf16 a[92:95], a[204:207], a[188:191], a[92:95]
    ds_read_b64_tr_b16 a[218:219], v15 offset:10248
    v_mfma_f32_16x16x32_bf16 a[88:91], a[204:207], a[184:187], a[88:91]
    ds_read_b64_tr_b16 a[220:221], v15 offset:12296
    v_mfma_f32_16x16x32_bf16 a[88:91], a[200:203], a[168:171], a[88:91]
    ds_read_b64_tr_b16 a[222:223], v15 offset:14344
    v_mfma_f32_16x16x32_bf16 a[84:87], a[200:203], a[164:167], a[84:87]
    s_and_b32 s70, s70, 1
    s_lshl_b32 s70, s70, 12
    v_mfma_f32_16x16x32_bf16 a[84:87], a[204:207], a[180:183], a[84:87]
    s_add_u32 s70, s70, s3
    s_lshr_b32 s3, s71, 1
    v_mfma_f32_16x16x32_bf16 a[80:83], a[204:207], a[176:179], a[80:83]
    s_mul_i32 s3, s3, 10240
    s_and_b32 s71, s71, 1
    v_mfma_f32_16x16x32_bf16 a[80:83], a[200:203], a[160:163], a[80:83]
    s_waitcnt lgkmcnt(4)
    s_lshl_b32 s71, s71, 12
    v_mfma_f32_16x16x32_bf16 a[96:99], a[208:211], a[160:163], a[96:99]
    s_add_u32 s71, s71, s3
    s_lshl_b32 s3, s47, 3
    v_mfma_f32_16x16x32_bf16 a[96:99], a[212:215], a[176:179], a[96:99]
    s_add_u32 s71, s71, s3
    v_lshrrev_b32 v2, 3, v0
    v_mfma_f32_16x16x32_bf16 a[100:103], a[212:215], a[180:183], a[100:103]
    v_cmp_eq_u32 vcc, 3, v2
    v_and_b32 v2, 0x70, v1
    v_mfma_f32_16x16x32_bf16 a[100:103], a[208:211], a[164:167], a[100:103]
    s_cmp_eq_u32 s45, 0
    s_mov_b32 s3, 4736
    s_cmov_b32 s3, 8192
    v_mfma_f32_16x16x32_bf16 a[104:107], a[208:211], a[168:171], a[104:107]
    v_add_u32 v24, s3, v2
    v_cndmask_b32 v24, v1, v24, vcc
    v_mfma_f32_16x16x32_bf16 a[104:107], a[212:215], a[184:187], a[104:107]
    s_cmp_eq_u32 s45, 0
    s_mov_b32 s3, 3840
    s_cmov_b32 s3, 7296
    v_mfma_f32_16x16x32_bf16 a[108:111], a[212:215], a[188:191], a[108:111]
    v_add_u32 v25, s3, v2
    v_cndmask_b32 v25, v1, v25, vcc
    s_cmp_eq_u32 s45, 0
    s_mov_b32 s3, 2944
    s_cmov_b32 s3, 6400
    v_add_u32 v26, s3, v2
    v_cndmask_b32 v26, v1, v26, vcc
    s_cmp_eq_u32 s45, 0
    s_mov_b32 s3, 2048
    s_cmov_b32 s3, 5632
    v_add_u32 v27, s3, v2
    v_cndmask_b32 v27, v1, v27, vcc
    s_cmp_eq_u32 s45, 1
    s_mov_b32 s3, 4736
    s_cmov_b32 s3, 8192
    v_add_u32 v28, s3, v2
    v_cndmask_b32 v28, v1, v28, vcc
    s_cmp_eq_u32 s45, 1
    s_mov_b32 s3, 3840
    s_cmov_b32 s3, 7296
    v_add_u32 v29, s3, v2
    v_cndmask_b32 v29, v1, v29, vcc
    s_cmp_eq_u32 s45, 1
    s_mov_b32 s3, 2944
    s_cmov_b32 s3, 6400
    v_add_u32 v30, s3, v2
    v_cndmask_b32 v30, v1, v30, vcc
    s_cmp_eq_u32 s45, 1
    s_mov_b32 s3, 2048
    s_cmov_b32 s3, 5632
    v_add_u32 v31, s3, v2
    v_cndmask_b32 v31, v1, v31, vcc
    s_mov_b32 s72, 0xbdd2d3e8
    s_mov_b32 s73, 0xc0135761
    s_mov_b32 s74, 0x3e0293ee
    s_mov_b32 s75, 0x3e0293ee
    v_mfma_f32_16x16x32_bf16 a[108:111], a[208:211], a[172:175], a[108:111]
    s_waitcnt lgkmcnt(0)
    s_barrier
    v_mfma_f32_16x16x32_bf16 a[124:127], a[216:219], a[172:175], a[124:127]
    v_mfma_f32_16x16x32_bf16 a[124:127], a[220:223], a[188:191], a[124:127]
    v_mfma_f32_16x16x32_bf16 a[120:123], a[220:223], a[184:187], a[120:123]
    v_mfma_f32_16x16x32_bf16 a[120:123], a[216:219], a[168:171], a[120:123]
    v_mfma_f32_16x16x32_bf16 a[116:119], a[216:219], a[164:167], a[116:119]
    v_mfma_f32_16x16x32_bf16 a[116:119], a[220:223], a[180:183], a[116:119]
    v_mfma_f32_16x16x32_bf16 a[112:115], a[220:223], a[176:179], a[112:115]
    v_mfma_f32_16x16x32_bf16 a[112:115], a[216:219], a[160:163], a[112:115]
    s_add_u32 s49, s51, 32768
    s_add_u32 m0, s51, 32768
    s_nop 0
    buffer_load_dwordx4 v18, s[28:31], s49 offen offset:0 lds
    buffer_load_dwordx4 v19, s[28:31], s49 offen offset:1024 lds
    buffer_load_dwordx4 v20, s[28:31], s49 offen offset:2048 lds
    buffer_load_dwordx4 v21, s[28:31], s49 offen offset:3072 lds
    s_add_u32 s50, s51, 32768
    s_add_u32 m0, s51, 131072
    s_nop 0
    buffer_load_dwordx4 v22, s[32:35], s50 offen offset:0 lds
    buffer_load_dwordx4 v23, s[32:35], s50 offen offset:1024 lds
    buffer_load_dwordx4 v22, s[32:35], s50 offen offset:2048 lds
    buffer_load_dwordx4 v23, s[32:35], s50 offen offset:3072 lds
    v_pk_mul_f32 v[2:3], v[32:33], v[32:33]
    v_pk_mul_f32 v[4:5], v[34:35], v[34:35]
    v_pk_mul_f32 v[6:7], v[48:49], v[48:49]
    v_pk_mul_f32 v[8:9], v[50:51], v[50:51]
    v_pk_mul_f32 v[10:11], v[36:37], v[36:37]
    v_pk_mul_f32 v[12:13], v[38:39], v[38:39]
    v_pk_mul_f32 v[14:15], v[52:53], v[52:53]
    v_pk_mul_f32 v[16:17], v[54:55], v[54:55]
    v_pk_fma_f32 v[2:3], v[2:3], s[72:73], s[72:73] op_sel:[0,0,1] op_sel_hi:[1,0,1]
    v_pk_fma_f32 v[4:5], v[4:5], s[72:73], s[72:73] op_sel:[0,0,1] op_sel_hi:[1,0,1]
    v_pk_fma_f32 v[6:7], v[6:7], s[72:73], s[72:73] op_sel:[0,0,1] op_sel_hi:[1,0,1]
    v_pk_fma_f32 v[8:9], v[8:9], s[72:73], s[72:73] op_sel:[0,0,1] op_sel_hi:[1,0,1]
    v_pk_fma_f32 v[10:11], v[10:11], s[72:73], s[72:73] op_sel:[0,0,1] op_sel_hi:[1,0,1]
    v_pk_fma_f32 v[12:13], v[12:13], s[72:73], s[72:73] op_sel:[0,0,1] op_sel_hi:[1,0,1]
    v_pk_fma_f32 v[14:15], v[14:15], s[72:73], s[72:73] op_sel:[0,0,1] op_sel_hi:[1,0,1]
    v_pk_fma_f32 v[16:17], v[16:17], s[72:73], s[72:73] op_sel:[0,0,1] op_sel_hi:[1,0,1]
    v_pk_mul_f32 v[2:3], v[2:3], v[32:33]
    v_pk_mul_f32 v[4:5], v[4:5], v[34:35]
    v_pk_mul_f32 v[6:7], v[6:7], v[48:49]
    v_pk_mul_f32 v[8:9], v[8:9], v[50:51]
    v_pk_mul_f32 v[10:11], v[10:11], v[36:37]
    v_pk_mul_f32 v[12:13], v[12:13], v[38:39]
    v_pk_mul_f32 v[14:15], v[14:15], v[52:53]
    v_pk_mul_f32 v[16:17], v[16:17], v[54:55]
    v_exp_f32 v2, v2
    v_exp_f32 v3, v3
    v_exp_f32 v4, v4
    v_exp_f32 v5, v5
    v_exp_f32 v6, v6
    v_exp_f32 v7, v7
    v_exp_f32 v8, v8
    v_exp_f32 v9, v9
    v_exp_f32 v10, v10
    v_exp_f32 v11, v11
    v_exp_f32 v12, v12
    v_exp_f32 v13, v13
    v_exp_f32 v14, v14
    v_exp_f32 v15, v15
    v_exp_f32 v16, v16
    v_exp_f32 v17, v17
    v_pk_mul_f32 v[144:145], v[144:145], v[32:33]
    v_pk_mul_f32 v[146:147], v[146:147], v[34:35]
    v_pk_mul_f32 v[160:161], v[160:161], v[48:49]
    v_pk_mul_f32 v[162:163], v[162:163], v[50:51]
    v_pk_mul_f32 v[148:149], v[148:149], v[36:37]
    v_pk_mul_f32 v[150:151], v[150:151], v[38:39]
    v_pk_mul_f32 v[164:165], v[164:165], v[52:53]
    v_pk_mul_f32 v[166:167], v[166:167], v[54:55]
    v_pk_add_f32 v[2:3], v[2:3], 1.0 op_sel_hi:[1,0]
    v_pk_add_f32 v[4:5], v[4:5], 1.0 op_sel_hi:[1,0]
    v_pk_add_f32 v[6:7], v[6:7], 1.0 op_sel_hi:[1,0]
    v_pk_add_f32 v[8:9], v[8:9], 1.0 op_sel_hi:[1,0]
    v_pk_add_f32 v[10:11], v[10:11], 1.0 op_sel_hi:[1,0]
    v_pk_add_f32 v[12:13], v[12:13], 1.0 op_sel_hi:[1,0]
    v_pk_add_f32 v[14:15], v[14:15], 1.0 op_sel_hi:[1,0]
    v_pk_add_f32 v[16:17], v[16:17], 1.0 op_sel_hi:[1,0]
    v_rcp_f32 v2, v2
    v_rcp_f32 v3, v3
    v_rcp_f32 v4, v4
    v_rcp_f32 v5, v5
    v_rcp_f32 v6, v6
    v_rcp_f32 v7, v7
    v_rcp_f32 v8, v8
    v_rcp_f32 v9, v9
    v_rcp_f32 v10, v10
    v_rcp_f32 v11, v11
    v_rcp_f32 v12, v12
    v_rcp_f32 v13, v13
    v_rcp_f32 v14, v14
    v_rcp_f32 v15, v15
    v_rcp_f32 v16, v16
    v_rcp_f32 v17, v17
    s_nop 0
    v_pk_mul_f32 v[144:145], v[144:145], v[2:3]
    v_pk_mul_f32 v[146:147], v[146:147], v[4:5]
    v_pk_mul_f32 v[160:161], v[160:161], v[6:7]
    v_pk_mul_f32 v[162:163], v[162:163], v[8:9]
    v_pk_mul_f32 v[148:149], v[148:149], v[10:11]
    v_pk_mul_f32 v[150:151], v[150:151], v[12:13]
    v_pk_mul_f32 v[164:165], v[164:165], v[14:15]
    v_pk_mul_f32 v[166:167], v[166:167], v[16:17]
    v_cvt_pk_bf16_f32 v32, v144, v145
    v_cvt_pk_bf16_f32 v33, v146, v147
    v_cvt_pk_bf16_f32 v34, v160, v161
    v_cvt_pk_bf16_f32 v35, v162, v163
    v_cvt_pk_bf16_f32 v36, v148, v149
    v_cvt_pk_bf16_f32 v37, v150, v151
    v_cvt_pk_bf16_f32 v38, v164, v165
    v_cvt_pk_bf16_f32 v39, v166, v167
    buffer_store_dwordx4 v[32:35], v24, s[36:39], s68 offen offset:0 sc1
    buffer_store_dwordx4 v[36:39], v25, s[36:39], s68 offen offset:1024 sc1
    v_pk_mul_f32 v[2:3], v[40:41], v[40:41]
    v_pk_mul_f32 v[4:5], v[42:43], v[42:43]
    v_pk_mul_f32 v[6:7], v[56:57], v[56:57]
    v_pk_mul_f32 v[8:9], v[58:59], v[58:59]
    v_pk_mul_f32 v[10:11], v[44:45], v[44:45]
    v_pk_mul_f32 v[12:13], v[46:47], v[46:47]
    v_pk_mul_f32 v[14:15], v[60:61], v[60:61]
    v_pk_mul_f32 v[16:17], v[62:63], v[62:63]
    v_pk_fma_f32 v[2:3], v[2:3], s[72:73], s[72:73] op_sel:[0,0,1] op_sel_hi:[1,0,1]
    v_pk_fma_f32 v[4:5], v[4:5], s[72:73], s[72:73] op_sel:[0,0,1] op_sel_hi:[1,0,1]
    v_pk_fma_f32 v[6:7], v[6:7], s[72:73], s[72:73] op_sel:[0,0,1] op_sel_hi:[1,0,1]
    v_pk_fma_f32 v[8:9], v[8:9], s[72:73], s[72:73] op_sel:[0,0,1] op_sel_hi:[1,0,1]
    v_pk_fma_f32 v[10:11], v[10:11], s[72:73], s[72:73] op_sel:[0,0,1] op_sel_hi:[1,0,1]
    v_pk_fma_f32 v[12:13], v[12:13], s[72:73], s[72:73] op_sel:[0,0,1] op_sel_hi:[1,0,1]
    v_pk_fma_f32 v[14:15], v[14:15], s[72:73], s[72:73] op_sel:[0,0,1] op_sel_hi:[1,0,1]
    v_pk_fma_f32 v[16:17], v[16:17], s[72:73], s[72:73] op_sel:[0,0,1] op_sel_hi:[1,0,1]
    v_pk_mul_f32 v[2:3], v[2:3], v[40:41]
    v_pk_mul_f32 v[4:5], v[4:5], v[42:43]
    v_pk_mul_f32 v[6:7], v[6:7], v[56:57]
    v_pk_mul_f32 v[8:9], v[8:9], v[58:59]
    v_pk_mul_f32 v[10:11], v[10:11], v[44:45]
    v_pk_mul_f32 v[12:13], v[12:13], v[46:47]
    v_pk_mul_f32 v[14:15], v[14:15], v[60:61]
    v_pk_mul_f32 v[16:17], v[16:17], v[62:63]
    v_exp_f32 v2, v2
    v_exp_f32 v3, v3
    v_exp_f32 v4, v4
    v_exp_f32 v5, v5
    v_exp_f32 v6, v6
    v_exp_f32 v7, v7
    v_exp_f32 v8, v8
    v_exp_f32 v9, v9
    v_exp_f32 v10, v10
    v_exp_f32 v11, v11
    v_exp_f32 v12, v12
    v_exp_f32 v13, v13
    v_exp_f32 v14, v14
    v_exp_f32 v15, v15
    v_exp_f32 v16, v16
    v_exp_f32 v17, v17
    v_pk_mul_f32 v[152:153], v[152:153], v[40:41]
    v_pk_mul_f32 v[154:155], v[154:155], v[42:43]
    v_pk_mul_f32 v[168:169], v[168:169], v[56:57]
    v_pk_mul_f32 v[170:171], v[170:171], v[58:59]
    v_pk_mul_f32 v[156:157], v[156:157], v[44:45]
    v_pk_mul_f32 v[158:159], v[158:159], v[46:47]
    v_pk_mul_f32 v[172:173], v[172:173], v[60:61]
    v_pk_mul_f32 v[174:175], v[174:175], v[62:63]
    v_pk_add_f32 v[2:3], v[2:3], 1.0 op_sel_hi:[1,0]
    v_pk_add_f32 v[4:5], v[4:5], 1.0 op_sel_hi:[1,0]
    v_pk_add_f32 v[6:7], v[6:7], 1.0 op_sel_hi:[1,0]
    v_pk_add_f32 v[8:9], v[8:9], 1.0 op_sel_hi:[1,0]
    v_pk_add_f32 v[10:11], v[10:11], 1.0 op_sel_hi:[1,0]
    v_pk_add_f32 v[12:13], v[12:13], 1.0 op_sel_hi:[1,0]
    v_pk_add_f32 v[14:15], v[14:15], 1.0 op_sel_hi:[1,0]
    v_pk_add_f32 v[16:17], v[16:17], 1.0 op_sel_hi:[1,0]
    v_rcp_f32 v2, v2
    v_rcp_f32 v3, v3
    v_rcp_f32 v4, v4
    v_rcp_f32 v5, v5
    v_rcp_f32 v6, v6
    v_rcp_f32 v7, v7
    v_rcp_f32 v8, v8
    v_rcp_f32 v9, v9
    v_rcp_f32 v10, v10
    v_rcp_f32 v11, v11
    v_rcp_f32 v12, v12
    v_rcp_f32 v13, v13
    v_rcp_f32 v14, v14
    v_rcp_f32 v15, v15
    v_rcp_f32 v16, v16
    v_rcp_f32 v17, v17
    s_nop 0
    v_pk_mul_f32 v[152:153], v[152:153], v[2:3]
    v_pk_mul_f32 v[154:155], v[154:155], v[4:5]
    v_pk_mul_f32 v[168:169], v[168:169], v[6:7]
    v_pk_mul_f32 v[170:171], v[170:171], v[8:9]
    v_pk_mul_f32 v[156:157], v[156:157], v[10:11]
    v_pk_mul_f32 v[158:159], v[158:159], v[12:13]
    v_pk_mul_f32 v[172:173], v[172:173], v[14:15]
    v_pk_mul_f32 v[174:175], v[174:175], v[16:17]
    v_cvt_pk_bf16_f32 v40, v152, v153
    v_cvt_pk_bf16_f32 v41, v154, v155
    v_cvt_pk_bf16_f32 v42, v168, v169
    v_cvt_pk_bf16_f32 v43, v170, v171
    v_cvt_pk_bf16_f32 v44, v156, v157
    v_cvt_pk_bf16_f32 v45, v158, v159
    v_cvt_pk_bf16_f32 v46, v172, v173
    v_cvt_pk_bf16_f32 v47, v174, v175
    buffer_store_dwordx4 v[40:43], v26, s[36:39], s68 offen offset:2048 sc1
    buffer_store_dwordx4 v[44:47], v27, s[36:39], s68 offen offset:3072 sc1
    v_pk_mul_f32 v[2:3], v[64:65], v[64:65]
    v_pk_mul_f32 v[4:5], v[66:67], v[66:67]
    v_pk_mul_f32 v[6:7], v[80:81], v[80:81]
    v_pk_mul_f32 v[8:9], v[82:83], v[82:83]
    v_pk_mul_f32 v[10:11], v[68:69], v[68:69]
    v_pk_mul_f32 v[12:13], v[70:71], v[70:71]
    v_pk_mul_f32 v[14:15], v[84:85], v[84:85]
    v_pk_mul_f32 v[16:17], v[86:87], v[86:87]
    v_pk_fma_f32 v[2:3], v[2:3], s[72:73], s[72:73] op_sel:[0,0,1] op_sel_hi:[1,0,1]
    v_pk_fma_f32 v[4:5], v[4:5], s[72:73], s[72:73] op_sel:[0,0,1] op_sel_hi:[1,0,1]
    v_pk_fma_f32 v[6:7], v[6:7], s[72:73], s[72:73] op_sel:[0,0,1] op_sel_hi:[1,0,1]
    v_pk_fma_f32 v[8:9], v[8:9], s[72:73], s[72:73] op_sel:[0,0,1] op_sel_hi:[1,0,1]
    v_pk_fma_f32 v[10:11], v[10:11], s[72:73], s[72:73] op_sel:[0,0,1] op_sel_hi:[1,0,1]
    v_pk_fma_f32 v[12:13], v[12:13], s[72:73], s[72:73] op_sel:[0,0,1] op_sel_hi:[1,0,1]
    v_pk_fma_f32 v[14:15], v[14:15], s[72:73], s[72:73] op_sel:[0,0,1] op_sel_hi:[1,0,1]
    v_pk_fma_f32 v[16:17], v[16:17], s[72:73], s[72:73] op_sel:[0,0,1] op_sel_hi:[1,0,1]
    v_pk_mul_f32 v[2:3], v[2:3], v[64:65]
    v_pk_mul_f32 v[4:5], v[4:5], v[66:67]
    v_pk_mul_f32 v[6:7], v[6:7], v[80:81]
    v_pk_mul_f32 v[8:9], v[8:9], v[82:83]
    v_pk_mul_f32 v[10:11], v[10:11], v[68:69]
    v_pk_mul_f32 v[12:13], v[12:13], v[70:71]
    v_pk_mul_f32 v[14:15], v[14:15], v[84:85]
    v_pk_mul_f32 v[16:17], v[16:17], v[86:87]
    v_exp_f32 v2, v2
    v_exp_f32 v3, v3
    v_exp_f32 v4, v4
    v_exp_f32 v5, v5
    v_exp_f32 v6, v6
    v_exp_f32 v7, v7
    v_exp_f32 v8, v8
    v_exp_f32 v9, v9
    v_exp_f32 v10, v10
    v_exp_f32 v11, v11
    v_exp_f32 v12, v12
    v_exp_f32 v13, v13
    v_exp_f32 v14, v14
    v_exp_f32 v15, v15
    v_exp_f32 v16, v16
    v_exp_f32 v17, v17
    v_pk_mul_f32 v[176:177], v[176:177], v[64:65]
    v_pk_mul_f32 v[178:179], v[178:179], v[66:67]
    v_pk_mul_f32 v[192:193], v[192:193], v[80:81]
    v_pk_mul_f32 v[194:195], v[194:195], v[82:83]
    v_pk_mul_f32 v[180:181], v[180:181], v[68:69]
    v_pk_mul_f32 v[182:183], v[182:183], v[70:71]
    v_pk_mul_f32 v[196:197], v[196:197], v[84:85]
    v_pk_mul_f32 v[198:199], v[198:199], v[86:87]
    v_pk_add_f32 v[2:3], v[2:3], 1.0 op_sel_hi:[1,0]
    v_pk_add_f32 v[4:5], v[4:5], 1.0 op_sel_hi:[1,0]
    v_pk_add_f32 v[6:7], v[6:7], 1.0 op_sel_hi:[1,0]
    v_pk_add_f32 v[8:9], v[8:9], 1.0 op_sel_hi:[1,0]
    v_pk_add_f32 v[10:11], v[10:11], 1.0 op_sel_hi:[1,0]
    v_pk_add_f32 v[12:13], v[12:13], 1.0 op_sel_hi:[1,0]
    v_pk_add_f32 v[14:15], v[14:15], 1.0 op_sel_hi:[1,0]
    v_pk_add_f32 v[16:17], v[16:17], 1.0 op_sel_hi:[1,0]
    v_rcp_f32 v2, v2
    v_rcp_f32 v3, v3
    v_rcp_f32 v4, v4
    v_rcp_f32 v5, v5
    v_rcp_f32 v6, v6
    v_rcp_f32 v7, v7
    v_rcp_f32 v8, v8
    v_rcp_f32 v9, v9
    v_rcp_f32 v10, v10
    v_rcp_f32 v11, v11
    v_rcp_f32 v12, v12
    v_rcp_f32 v13, v13
    v_rcp_f32 v14, v14
    v_rcp_f32 v15, v15
    v_rcp_f32 v16, v16
    v_rcp_f32 v17, v17
    s_nop 0
    v_pk_mul_f32 v[176:177], v[176:177], v[2:3]
    v_pk_mul_f32 v[178:179], v[178:179], v[4:5]
    v_pk_mul_f32 v[192:193], v[192:193], v[6:7]
    v_pk_mul_f32 v[194:195], v[194:195], v[8:9]
    v_pk_mul_f32 v[180:181], v[180:181], v[10:11]
    v_pk_mul_f32 v[182:183], v[182:183], v[12:13]
    v_pk_mul_f32 v[196:197], v[196:197], v[14:15]
    v_pk_mul_f32 v[198:199], v[198:199], v[16:17]
    v_cvt_pk_bf16_f32 v64, v176, v177
    v_cvt_pk_bf16_f32 v65, v178, v179
    v_cvt_pk_bf16_f32 v66, v192, v193
    v_cvt_pk_bf16_f32 v67, v194, v195
    v_cvt_pk_bf16_f32 v68, v180, v181
    v_cvt_pk_bf16_f32 v69, v182, v183
    v_cvt_pk_bf16_f32 v70, v196, v197
    v_cvt_pk_bf16_f32 v71, v198, v199
    buffer_store_dwordx4 v[64:67], v28, s[36:39], s69 offen offset:0 sc1
    buffer_store_dwordx4 v[68:71], v29, s[36:39], s69 offen offset:1024 sc1
    v_pk_mul_f32 v[2:3], v[72:73], v[72:73]
    v_pk_mul_f32 v[4:5], v[74:75], v[74:75]
    v_pk_mul_f32 v[6:7], v[88:89], v[88:89]
    v_pk_mul_f32 v[8:9], v[90:91], v[90:91]
    v_pk_mul_f32 v[10:11], v[76:77], v[76:77]
    v_pk_mul_f32 v[12:13], v[78:79], v[78:79]
    v_pk_mul_f32 v[14:15], v[92:93], v[92:93]
    v_pk_mul_f32 v[16:17], v[94:95], v[94:95]
    v_pk_fma_f32 v[2:3], v[2:3], s[72:73], s[72:73] op_sel:[0,0,1] op_sel_hi:[1,0,1]
    v_pk_fma_f32 v[4:5], v[4:5], s[72:73], s[72:73] op_sel:[0,0,1] op_sel_hi:[1,0,1]
    v_pk_fma_f32 v[6:7], v[6:7], s[72:73], s[72:73] op_sel:[0,0,1] op_sel_hi:[1,0,1]
    v_pk_fma_f32 v[8:9], v[8:9], s[72:73], s[72:73] op_sel:[0,0,1] op_sel_hi:[1,0,1]
    v_pk_fma_f32 v[10:11], v[10:11], s[72:73], s[72:73] op_sel:[0,0,1] op_sel_hi:[1,0,1]
    v_pk_fma_f32 v[12:13], v[12:13], s[72:73], s[72:73] op_sel:[0,0,1] op_sel_hi:[1,0,1]
    v_pk_fma_f32 v[14:15], v[14:15], s[72:73], s[72:73] op_sel:[0,0,1] op_sel_hi:[1,0,1]
    v_pk_fma_f32 v[16:17], v[16:17], s[72:73], s[72:73] op_sel:[0,0,1] op_sel_hi:[1,0,1]
    v_pk_mul_f32 v[2:3], v[2:3], v[72:73]
    v_pk_mul_f32 v[4:5], v[4:5], v[74:75]
    v_pk_mul_f32 v[6:7], v[6:7], v[88:89]
    v_pk_mul_f32 v[8:9], v[8:9], v[90:91]
    v_pk_mul_f32 v[10:11], v[10:11], v[76:77]
    v_pk_mul_f32 v[12:13], v[12:13], v[78:79]
    v_pk_mul_f32 v[14:15], v[14:15], v[92:93]
    v_pk_mul_f32 v[16:17], v[16:17], v[94:95]
    v_exp_f32 v2, v2
    v_exp_f32 v3, v3
    v_exp_f32 v4, v4
    v_exp_f32 v5, v5
    v_exp_f32 v6, v6
    v_exp_f32 v7, v7
    v_exp_f32 v8, v8
    v_exp_f32 v9, v9
    v_exp_f32 v10, v10
    v_exp_f32 v11, v11
    v_exp_f32 v12, v12
    v_exp_f32 v13, v13
    v_exp_f32 v14, v14
    v_exp_f32 v15, v15
    v_exp_f32 v16, v16
    v_exp_f32 v17, v17
    v_pk_mul_f32 v[184:185], v[184:185], v[72:73]
    v_pk_mul_f32 v[186:187], v[186:187], v[74:75]
    v_pk_mul_f32 v[200:201], v[200:201], v[88:89]
    v_pk_mul_f32 v[202:203], v[202:203], v[90:91]
    v_pk_mul_f32 v[188:189], v[188:189], v[76:77]
    v_pk_mul_f32 v[190:191], v[190:191], v[78:79]
    v_pk_mul_f32 v[204:205], v[204:205], v[92:93]
    v_pk_mul_f32 v[206:207], v[206:207], v[94:95]
    v_pk_add_f32 v[2:3], v[2:3], 1.0 op_sel_hi:[1,0]
    v_pk_add_f32 v[4:5], v[4:5], 1.0 op_sel_hi:[1,0]
    v_pk_add_f32 v[6:7], v[6:7], 1.0 op_sel_hi:[1,0]
    v_pk_add_f32 v[8:9], v[8:9], 1.0 op_sel_hi:[1,0]
    v_pk_add_f32 v[10:11], v[10:11], 1.0 op_sel_hi:[1,0]
    v_pk_add_f32 v[12:13], v[12:13], 1.0 op_sel_hi:[1,0]
    v_pk_add_f32 v[14:15], v[14:15], 1.0 op_sel_hi:[1,0]
    v_pk_add_f32 v[16:17], v[16:17], 1.0 op_sel_hi:[1,0]
    v_rcp_f32 v2, v2
    v_rcp_f32 v3, v3
    v_rcp_f32 v4, v4
    v_rcp_f32 v5, v5
    v_rcp_f32 v6, v6
    v_rcp_f32 v7, v7
    v_rcp_f32 v8, v8
    v_rcp_f32 v9, v9
    v_rcp_f32 v10, v10
    v_rcp_f32 v11, v11
    v_rcp_f32 v12, v12
    v_rcp_f32 v13, v13
    v_rcp_f32 v14, v14
    v_rcp_f32 v15, v15
    v_rcp_f32 v16, v16
    v_rcp_f32 v17, v17
    s_nop 0
    v_pk_mul_f32 v[184:185], v[184:185], v[2:3]
    v_pk_mul_f32 v[186:187], v[186:187], v[4:5]
    v_pk_mul_f32 v[200:201], v[200:201], v[6:7]
    v_pk_mul_f32 v[202:203], v[202:203], v[8:9]
    v_pk_mul_f32 v[188:189], v[188:189], v[10:11]
    v_pk_mul_f32 v[190:191], v[190:191], v[12:13]
    v_pk_mul_f32 v[204:205], v[204:205], v[14:15]
    v_pk_mul_f32 v[206:207], v[206:207], v[16:17]
    v_cvt_pk_bf16_f32 v72, v184, v185
    v_cvt_pk_bf16_f32 v73, v186, v187
    v_cvt_pk_bf16_f32 v74, v200, v201
    v_cvt_pk_bf16_f32 v75, v202, v203
    v_cvt_pk_bf16_f32 v76, v188, v189
    v_cvt_pk_bf16_f32 v77, v190, v191
    v_cvt_pk_bf16_f32 v78, v204, v205
    v_cvt_pk_bf16_f32 v79, v206, v207
    buffer_store_dwordx4 v[72:75], v30, s[36:39], s69 offen offset:2048 sc1
    buffer_store_dwordx4 v[76:79], v31, s[36:39], s69 offen offset:3072 sc1
    v_pk_mul_f32 v[2:3], v[96:97], v[96:97]
    v_pk_mul_f32 v[4:5], v[98:99], v[98:99]
    v_pk_mul_f32 v[6:7], v[112:113], v[112:113]
    v_pk_mul_f32 v[8:9], v[114:115], v[114:115]
    v_pk_mul_f32 v[10:11], v[100:101], v[100:101]
    v_pk_mul_f32 v[12:13], v[102:103], v[102:103]
    v_pk_mul_f32 v[14:15], v[116:117], v[116:117]
    v_pk_mul_f32 v[16:17], v[118:119], v[118:119]
    v_pk_fma_f32 v[2:3], v[2:3], s[72:73], s[72:73] op_sel:[0,0,1] op_sel_hi:[1,0,1]
    v_pk_fma_f32 v[4:5], v[4:5], s[72:73], s[72:73] op_sel:[0,0,1] op_sel_hi:[1,0,1]
    v_pk_fma_f32 v[6:7], v[6:7], s[72:73], s[72:73] op_sel:[0,0,1] op_sel_hi:[1,0,1]
    v_pk_fma_f32 v[8:9], v[8:9], s[72:73], s[72:73] op_sel:[0,0,1] op_sel_hi:[1,0,1]
    v_pk_fma_f32 v[10:11], v[10:11], s[72:73], s[72:73] op_sel:[0,0,1] op_sel_hi:[1,0,1]
    v_pk_fma_f32 v[12:13], v[12:13], s[72:73], s[72:73] op_sel:[0,0,1] op_sel_hi:[1,0,1]
    v_pk_fma_f32 v[14:15], v[14:15], s[72:73], s[72:73] op_sel:[0,0,1] op_sel_hi:[1,0,1]
    v_pk_fma_f32 v[16:17], v[16:17], s[72:73], s[72:73] op_sel:[0,0,1] op_sel_hi:[1,0,1]
    v_pk_mul_f32 v[2:3], v[2:3], v[96:97]
    v_pk_mul_f32 v[4:5], v[4:5], v[98:99]
    v_pk_mul_f32 v[6:7], v[6:7], v[112:113]
    v_pk_mul_f32 v[8:9], v[8:9], v[114:115]
    v_pk_mul_f32 v[10:11], v[10:11], v[100:101]
    v_pk_mul_f32 v[12:13], v[12:13], v[102:103]
    v_pk_mul_f32 v[14:15], v[14:15], v[116:117]
    v_pk_mul_f32 v[16:17], v[16:17], v[118:119]
    v_exp_f32 v2, v2
    v_exp_f32 v3, v3
    v_exp_f32 v4, v4
    v_exp_f32 v5, v5
    v_exp_f32 v6, v6
    v_exp_f32 v7, v7
    v_exp_f32 v8, v8
    v_exp_f32 v9, v9
    v_exp_f32 v10, v10
    v_exp_f32 v11, v11
    v_exp_f32 v12, v12
    v_exp_f32 v13, v13
    v_exp_f32 v14, v14
    v_exp_f32 v15, v15
    v_exp_f32 v16, v16
    v_exp_f32 v17, v17
    v_pk_mul_f32 v[208:209], v[208:209], v[96:97]
    v_pk_mul_f32 v[210:211], v[210:211], v[98:99]
    v_pk_mul_f32 v[224:225], v[224:225], v[112:113]
    v_pk_mul_f32 v[226:227], v[226:227], v[114:115]
    v_pk_mul_f32 v[212:213], v[212:213], v[100:101]
    v_pk_mul_f32 v[214:215], v[214:215], v[102:103]
    v_pk_mul_f32 v[228:229], v[228:229], v[116:117]
    v_pk_mul_f32 v[230:231], v[230:231], v[118:119]
    v_pk_add_f32 v[2:3], v[2:3], 1.0 op_sel_hi:[1,0]
    v_pk_add_f32 v[4:5], v[4:5], 1.0 op_sel_hi:[1,0]
    v_pk_add_f32 v[6:7], v[6:7], 1.0 op_sel_hi:[1,0]
    v_pk_add_f32 v[8:9], v[8:9], 1.0 op_sel_hi:[1,0]
    v_pk_add_f32 v[10:11], v[10:11], 1.0 op_sel_hi:[1,0]
    v_pk_add_f32 v[12:13], v[12:13], 1.0 op_sel_hi:[1,0]
    v_pk_add_f32 v[14:15], v[14:15], 1.0 op_sel_hi:[1,0]
    v_pk_add_f32 v[16:17], v[16:17], 1.0 op_sel_hi:[1,0]
    v_rcp_f32 v2, v2
    v_rcp_f32 v3, v3
    v_rcp_f32 v4, v4
    v_rcp_f32 v5, v5
    v_rcp_f32 v6, v6
    v_rcp_f32 v7, v7
    v_rcp_f32 v8, v8
    v_rcp_f32 v9, v9
    v_rcp_f32 v10, v10
    v_rcp_f32 v11, v11
    v_rcp_f32 v12, v12
    v_rcp_f32 v13, v13
    v_rcp_f32 v14, v14
    v_rcp_f32 v15, v15
    v_rcp_f32 v16, v16
    v_rcp_f32 v17, v17
    s_nop 0
    v_pk_mul_f32 v[208:209], v[208:209], v[2:3]
    v_pk_mul_f32 v[210:211], v[210:211], v[4:5]
    v_pk_mul_f32 v[224:225], v[224:225], v[6:7]
    v_pk_mul_f32 v[226:227], v[226:227], v[8:9]
    v_pk_mul_f32 v[212:213], v[212:213], v[10:11]
    v_pk_mul_f32 v[214:215], v[214:215], v[12:13]
    v_pk_mul_f32 v[228:229], v[228:229], v[14:15]
    v_pk_mul_f32 v[230:231], v[230:231], v[16:17]
    v_cvt_pk_bf16_f32 v96, v208, v209
    v_cvt_pk_bf16_f32 v97, v210, v211
    v_cvt_pk_bf16_f32 v98, v224, v225
    v_cvt_pk_bf16_f32 v99, v226, v227
    v_cvt_pk_bf16_f32 v100, v212, v213
    v_cvt_pk_bf16_f32 v101, v214, v215
    v_cvt_pk_bf16_f32 v102, v228, v229
    v_cvt_pk_bf16_f32 v103, v230, v231
    buffer_store_dwordx4 v[96:99], v24, s[36:39], s70 offen offset:0 sc1
    buffer_store_dwordx4 v[100:103], v25, s[36:39], s70 offen offset:1024 sc1
    v_pk_mul_f32 v[2:3], v[104:105], v[104:105]
    v_pk_mul_f32 v[4:5], v[106:107], v[106:107]
    v_pk_mul_f32 v[6:7], v[120:121], v[120:121]
    v_pk_mul_f32 v[8:9], v[122:123], v[122:123]
    v_pk_mul_f32 v[10:11], v[108:109], v[108:109]
    v_pk_mul_f32 v[12:13], v[110:111], v[110:111]
    v_pk_mul_f32 v[14:15], v[124:125], v[124:125]
    v_pk_mul_f32 v[16:17], v[126:127], v[126:127]
    v_pk_fma_f32 v[2:3], v[2:3], s[72:73], s[72:73] op_sel:[0,0,1] op_sel_hi:[1,0,1]
    v_pk_fma_f32 v[4:5], v[4:5], s[72:73], s[72:73] op_sel:[0,0,1] op_sel_hi:[1,0,1]
    v_pk_fma_f32 v[6:7], v[6:7], s[72:73], s[72:73] op_sel:[0,0,1] op_sel_hi:[1,0,1]
    v_pk_fma_f32 v[8:9], v[8:9], s[72:73], s[72:73] op_sel:[0,0,1] op_sel_hi:[1,0,1]
    v_pk_fma_f32 v[10:11], v[10:11], s[72:73], s[72:73] op_sel:[0,0,1] op_sel_hi:[1,0,1]
    v_pk_fma_f32 v[12:13], v[12:13], s[72:73], s[72:73] op_sel:[0,0,1] op_sel_hi:[1,0,1]
    v_pk_fma_f32 v[14:15], v[14:15], s[72:73], s[72:73] op_sel:[0,0,1] op_sel_hi:[1,0,1]
    v_pk_fma_f32 v[16:17], v[16:17], s[72:73], s[72:73] op_sel:[0,0,1] op_sel_hi:[1,0,1]
    v_pk_mul_f32 v[2:3], v[2:3], v[104:105]
    v_pk_mul_f32 v[4:5], v[4:5], v[106:107]
    v_pk_mul_f32 v[6:7], v[6:7], v[120:121]
    v_pk_mul_f32 v[8:9], v[8:9], v[122:123]
    v_pk_mul_f32 v[10:11], v[10:11], v[108:109]
    v_pk_mul_f32 v[12:13], v[12:13], v[110:111]
    v_pk_mul_f32 v[14:15], v[14:15], v[124:125]
    v_pk_mul_f32 v[16:17], v[16:17], v[126:127]
    v_exp_f32 v2, v2
    v_exp_f32 v3, v3
    v_exp_f32 v4, v4
    v_exp_f32 v5, v5
    v_exp_f32 v6, v6
    v_exp_f32 v7, v7
    v_exp_f32 v8, v8
    v_exp_f32 v9, v9
    v_exp_f32 v10, v10
    v_exp_f32 v11, v11
    v_exp_f32 v12, v12
    v_exp_f32 v13, v13
    v_exp_f32 v14, v14
    v_exp_f32 v15, v15
    v_exp_f32 v16, v16
    v_exp_f32 v17, v17
    v_pk_mul_f32 v[216:217], v[216:217], v[104:105]
    v_pk_mul_f32 v[218:219], v[218:219], v[106:107]
    v_pk_mul_f32 v[232:233], v[232:233], v[120:121]
    v_pk_mul_f32 v[234:235], v[234:235], v[122:123]
    v_pk_mul_f32 v[220:221], v[220:221], v[108:109]
    v_pk_mul_f32 v[222:223], v[222:223], v[110:111]
    v_pk_mul_f32 v[236:237], v[236:237], v[124:125]
    v_pk_mul_f32 v[238:239], v[238:239], v[126:127]
    v_pk_add_f32 v[2:3], v[2:3], 1.0 op_sel_hi:[1,0]
    v_pk_add_f32 v[4:5], v[4:5], 1.0 op_sel_hi:[1,0]
    v_pk_add_f32 v[6:7], v[6:7], 1.0 op_sel_hi:[1,0]
    v_pk_add_f32 v[8:9], v[8:9], 1.0 op_sel_hi:[1,0]
    v_pk_add_f32 v[10:11], v[10:11], 1.0 op_sel_hi:[1,0]
    v_pk_add_f32 v[12:13], v[12:13], 1.0 op_sel_hi:[1,0]
    v_pk_add_f32 v[14:15], v[14:15], 1.0 op_sel_hi:[1,0]
    v_pk_add_f32 v[16:17], v[16:17], 1.0 op_sel_hi:[1,0]
    v_rcp_f32 v2, v2
    v_rcp_f32 v3, v3
    v_rcp_f32 v4, v4
    v_rcp_f32 v5, v5
    v_rcp_f32 v6, v6
    v_rcp_f32 v7, v7
    v_rcp_f32 v8, v8
    v_rcp_f32 v9, v9
    v_rcp_f32 v10, v10
    v_rcp_f32 v11, v11
    v_rcp_f32 v12, v12
    v_rcp_f32 v13, v13
    v_rcp_f32 v14, v14
    v_rcp_f32 v15, v15
    v_rcp_f32 v16, v16
    v_rcp_f32 v17, v17
    s_nop 0
    v_pk_mul_f32 v[216:217], v[216:217], v[2:3]
    v_pk_mul_f32 v[218:219], v[218:219], v[4:5]
    v_pk_mul_f32 v[232:233], v[232:233], v[6:7]
    v_pk_mul_f32 v[234:235], v[234:235], v[8:9]
    v_pk_mul_f32 v[220:221], v[220:221], v[10:11]
    v_pk_mul_f32 v[222:223], v[222:223], v[12:13]
    v_pk_mul_f32 v[236:237], v[236:237], v[14:15]
    v_pk_mul_f32 v[238:239], v[238:239], v[16:17]
    v_cvt_pk_bf16_f32 v104, v216, v217
    v_cvt_pk_bf16_f32 v105, v218, v219
    v_cvt_pk_bf16_f32 v106, v232, v233
    v_cvt_pk_bf16_f32 v107, v234, v235
    v_cvt_pk_bf16_f32 v108, v220, v221
    v_cvt_pk_bf16_f32 v109, v222, v223
    v_cvt_pk_bf16_f32 v110, v236, v237
    v_cvt_pk_bf16_f32 v111, v238, v239
    buffer_store_dwordx4 v[104:107], v26, s[36:39], s70 offen offset:2048 sc1
    buffer_store_dwordx4 v[108:111], v27, s[36:39], s70 offen offset:3072 sc1
    v_pk_mul_f32 v[2:3], v[128:129], v[128:129]
    v_pk_mul_f32 v[4:5], v[130:131], v[130:131]
    v_pk_mul_f32 v[6:7], v[132:133], v[132:133]
    v_pk_mul_f32 v[8:9], v[134:135], v[134:135]
    v_pk_mul_f32 v[10:11], v[136:137], v[136:137]
    v_pk_mul_f32 v[12:13], v[138:139], v[138:139]
    v_pk_mul_f32 v[14:15], v[140:141], v[140:141]
    v_pk_mul_f32 v[16:17], v[142:143], v[142:143]
    v_pk_fma_f32 v[2:3], v[2:3], s[72:73], s[72:73] op_sel:[0,0,1] op_sel_hi:[1,0,1]
    v_pk_fma_f32 v[4:5], v[4:5], s[72:73], s[72:73] op_sel:[0,0,1] op_sel_hi:[1,0,1]
    v_pk_fma_f32 v[6:7], v[6:7], s[72:73], s[72:73] op_sel:[0,0,1] op_sel_hi:[1,0,1]
    v_pk_fma_f32 v[8:9], v[8:9], s[72:73], s[72:73] op_sel:[0,0,1] op_sel_hi:[1,0,1]
    v_pk_fma_f32 v[10:11], v[10:11], s[72:73], s[72:73] op_sel:[0,0,1] op_sel_hi:[1,0,1]
    v_pk_fma_f32 v[12:13], v[12:13], s[72:73], s[72:73] op_sel:[0,0,1] op_sel_hi:[1,0,1]
    v_pk_fma_f32 v[14:15], v[14:15], s[72:73], s[72:73] op_sel:[0,0,1] op_sel_hi:[1,0,1]
    v_pk_fma_f32 v[16:17], v[16:17], s[72:73], s[72:73] op_sel:[0,0,1] op_sel_hi:[1,0,1]
    v_pk_mul_f32 v[2:3], v[2:3], v[128:129]
    v_pk_mul_f32 v[4:5], v[4:5], v[130:131]
    v_pk_mul_f32 v[6:7], v[6:7], v[132:133]
    v_pk_mul_f32 v[8:9], v[8:9], v[134:135]
    v_pk_mul_f32 v[10:11], v[10:11], v[136:137]
    v_pk_mul_f32 v[12:13], v[12:13], v[138:139]
    v_pk_mul_f32 v[14:15], v[14:15], v[140:141]
    v_pk_mul_f32 v[16:17], v[16:17], v[142:143]
    v_exp_f32 v2, v2
    v_exp_f32 v3, v3
    v_exp_f32 v4, v4
    v_exp_f32 v5, v5
    v_exp_f32 v6, v6
    v_exp_f32 v7, v7
    v_exp_f32 v8, v8
    v_exp_f32 v9, v9
    v_exp_f32 v10, v10
    v_exp_f32 v11, v11
    v_exp_f32 v12, v12
    v_exp_f32 v13, v13
    v_exp_f32 v14, v14
    v_exp_f32 v15, v15
    v_exp_f32 v16, v16
    v_exp_f32 v17, v17
    v_pk_mul_f32 v[240:241], v[240:241], v[128:129]
    v_pk_mul_f32 v[242:243], v[242:243], v[130:131]
    v_pk_mul_f32 v[244:245], v[244:245], v[132:133]
    v_pk_mul_f32 v[246:247], v[246:247], v[134:135]
    v_pk_mul_f32 v[248:249], v[248:249], v[136:137]
    v_pk_mul_f32 v[250:251], v[250:251], v[138:139]
    v_pk_mul_f32 v[252:253], v[252:253], v[140:141]
    v_pk_mul_f32 v[254:255], v[254:255], v[142:143]
    v_pk_add_f32 v[2:3], v[2:3], 1.0 op_sel_hi:[1,0]
    v_pk_add_f32 v[4:5], v[4:5], 1.0 op_sel_hi:[1,0]
    v_pk_add_f32 v[6:7], v[6:7], 1.0 op_sel_hi:[1,0]
    v_pk_add_f32 v[8:9], v[8:9], 1.0 op_sel_hi:[1,0]
    v_pk_add_f32 v[10:11], v[10:11], 1.0 op_sel_hi:[1,0]
    v_pk_add_f32 v[12:13], v[12:13], 1.0 op_sel_hi:[1,0]
    v_pk_add_f32 v[14:15], v[14:15], 1.0 op_sel_hi:[1,0]
    v_pk_add_f32 v[16:17], v[16:17], 1.0 op_sel_hi:[1,0]
    v_rcp_f32 v2, v2
    v_rcp_f32 v3, v3
    v_rcp_f32 v4, v4
    v_rcp_f32 v5, v5
    v_rcp_f32 v6, v6
    v_rcp_f32 v7, v7
    v_rcp_f32 v8, v8
    v_rcp_f32 v9, v9
    v_rcp_f32 v10, v10
    v_rcp_f32 v11, v11
    v_rcp_f32 v12, v12
    v_rcp_f32 v13, v13
    v_rcp_f32 v14, v14
    v_rcp_f32 v15, v15
    v_rcp_f32 v16, v16
    v_rcp_f32 v17, v17
    s_nop 0
    v_pk_mul_f32 v[240:241], v[240:241], v[2:3]
    v_pk_mul_f32 v[242:243], v[242:243], v[4:5]
    v_pk_mul_f32 v[244:245], v[244:245], v[6:7]
    v_pk_mul_f32 v[246:247], v[246:247], v[8:9]
    v_pk_mul_f32 v[248:249], v[248:249], v[10:11]
    v_pk_mul_f32 v[250:251], v[250:251], v[12:13]
    v_pk_mul_f32 v[252:253], v[252:253], v[14:15]
    v_pk_mul_f32 v[254:255], v[254:255], v[16:17]
    v_cvt_pk_bf16_f32 v128, v240, v241
    v_cvt_pk_bf16_f32 v129, v242, v243
    v_cvt_pk_bf16_f32 v132, v244, v245
    v_cvt_pk_bf16_f32 v133, v246, v247
    v_cvt_pk_bf16_f32 v136, v248, v249
    v_cvt_pk_bf16_f32 v137, v250, v251
    v_cvt_pk_bf16_f32 v140, v252, v253
    v_cvt_pk_bf16_f32 v141, v254, v255
    buffer_store_dwordx2 v[128:129], v28, s[36:39], s71 offen offset:0 sc1
    buffer_store_dwordx2 v[132:133], v29, s[36:39], s71 offen offset:1024 sc1
    buffer_store_dwordx2 v[136:137], v30, s[36:39], s71 offen offset:2048 sc1
    buffer_store_dwordx2 v[140:141], v31, s[36:39], s71 offen offset:3072 sc1
    v_accvgpr_read_b32 v64, a0
    v_accvgpr_read_b32 v65, a1
    v_accvgpr_read_b32 v66, a2
    v_accvgpr_read_b32 v67, a3
    v_accvgpr_read_b32 v68, a16
    v_accvgpr_read_b32 v69, a17
    v_accvgpr_read_b32 v70, a18
    v_accvgpr_read_b32 v71, a19
    v_accvgpr_read_b32 v72, a4
    v_accvgpr_read_b32 v73, a5
    v_accvgpr_read_b32 v74, a6
    v_accvgpr_read_b32 v75, a7
    v_accvgpr_read_b32 v76, a20
    v_accvgpr_read_b32 v77, a21
    v_accvgpr_read_b32 v78, a22
    v_accvgpr_read_b32 v79, a23
    v_accvgpr_read_b32 v80, a8
    v_accvgpr_read_b32 v81, a9
    v_accvgpr_read_b32 v82, a10
    v_accvgpr_read_b32 v83, a11
    v_accvgpr_read_b32 v84, a24
    v_accvgpr_read_b32 v85, a25
    v_accvgpr_read_b32 v86, a26
    v_accvgpr_read_b32 v87, a27
    v_accvgpr_read_b32 v88, a12
    v_accvgpr_read_b32 v89, a13
    v_accvgpr_read_b32 v90, a14
    v_accvgpr_read_b32 v91, a15
    v_accvgpr_read_b32 v92, a28
    v_accvgpr_read_b32 v93, a29
    v_accvgpr_read_b32 v94, a30
    v_accvgpr_read_b32 v95, a31
    v_pk_mul_f32 v[64:65], v[64:65], s[74:75]
    v_pk_mul_f32 v[66:67], v[66:67], s[74:75]
    v_pk_mul_f32 v[68:69], v[68:69], s[74:75]
    v_pk_mul_f32 v[70:71], v[70:71], s[74:75]
    v_pk_mul_f32 v[72:73], v[72:73], s[74:75]
    v_pk_mul_f32 v[74:75], v[74:75], s[74:75]
    v_pk_mul_f32 v[76:77], v[76:77], s[74:75]
    v_pk_mul_f32 v[78:79], v[78:79], s[74:75]
    v_pk_mul_f32 v[80:81], v[80:81], s[74:75]
    v_pk_mul_f32 v[82:83], v[82:83], s[74:75]
    v_pk_mul_f32 v[84:85], v[84:85], s[74:75]
    v_pk_mul_f32 v[86:87], v[86:87], s[74:75]
    v_pk_mul_f32 v[88:89], v[88:89], s[74:75]
    v_pk_mul_f32 v[90:91], v[90:91], s[74:75]
    v_pk_mul_f32 v[92:93], v[92:93], s[74:75]
    v_pk_mul_f32 v[94:95], v[94:95], s[74:75]
    v_cvt_pk_bf16_f32 v96, v64, v65
    v_cvt_pk_bf16_f32 v97, v66, v67
    v_cvt_pk_bf16_f32 v98, v68, v69
    v_cvt_pk_bf16_f32 v99, v70, v71
    v_cvt_pk_bf16_f32 v100, v72, v73
    v_cvt_pk_bf16_f32 v101, v74, v75
    v_cvt_pk_bf16_f32 v102, v76, v77
    v_cvt_pk_bf16_f32 v103, v78, v79
    v_cvt_pk_bf16_f32 v104, v80, v81
    v_cvt_pk_bf16_f32 v105, v82, v83
    v_cvt_pk_bf16_f32 v106, v84, v85
    v_cvt_pk_bf16_f32 v107, v86, v87
    v_cvt_pk_bf16_f32 v108, v88, v89
    v_cvt_pk_bf16_f32 v109, v90, v91
    v_cvt_pk_bf16_f32 v110, v92, v93
    v_cvt_pk_bf16_f32 v111, v94, v95
    v_accvgpr_write_b32 a128, v96
    v_accvgpr_write_b32 a129, v97
    v_accvgpr_write_b32 a130, v98
    v_accvgpr_write_b32 a131, v99
    v_accvgpr_write_b32 a144, v100
    v_accvgpr_write_b32 a145, v101
    v_accvgpr_write_b32 a146, v102
    v_accvgpr_write_b32 a147, v103
    v_accvgpr_write_b32 a160, v104
    v_accvgpr_write_b32 a161, v105
    v_accvgpr_write_b32 a162, v106
    v_accvgpr_write_b32 a163, v107
    v_accvgpr_write_b32 a176, v108
    v_accvgpr_write_b32 a177, v109
    v_accvgpr_write_b32 a178, v110
    v_accvgpr_write_b32 a179, v111
    v_accvgpr_read_b32 v64, a32
    v_accvgpr_read_b32 v65, a33
    v_accvgpr_read_b32 v66, a34
    v_accvgpr_read_b32 v67, a35
    v_accvgpr_read_b32 v68, a48
    v_accvgpr_read_b32 v69, a49
    v_accvgpr_read_b32 v70, a50
    v_accvgpr_read_b32 v71, a51
    v_accvgpr_read_b32 v72, a36
    v_accvgpr_read_b32 v73, a37
    v_accvgpr_read_b32 v74, a38
    v_accvgpr_read_b32 v75, a39
    v_accvgpr_read_b32 v76, a52
    v_accvgpr_read_b32 v77, a53
    v_accvgpr_read_b32 v78, a54
    v_accvgpr_read_b32 v79, a55
    v_accvgpr_read_b32 v80, a40
    v_accvgpr_read_b32 v81, a41
    v_accvgpr_read_b32 v82, a42
    v_accvgpr_read_b32 v83, a43
    v_accvgpr_read_b32 v84, a56
    v_accvgpr_read_b32 v85, a57
    v_accvgpr_read_b32 v86, a58
    v_accvgpr_read_b32 v87, a59
    v_accvgpr_read_b32 v88, a44
    v_accvgpr_read_b32 v89, a45
    v_accvgpr_read_b32 v90, a46
    v_accvgpr_read_b32 v91, a47
    v_accvgpr_read_b32 v92, a60
    v_accvgpr_read_b32 v93, a61
    v_accvgpr_read_b32 v94, a62
    v_accvgpr_read_b32 v95, a63
    v_pk_mul_f32 v[64:65], v[64:65], s[74:75]
    v_pk_mul_f32 v[66:67], v[66:67], s[74:75]
    v_pk_mul_f32 v[68:69], v[68:69], s[74:75]
    v_pk_mul_f32 v[70:71], v[70:71], s[74:75]
    v_pk_mul_f32 v[72:73], v[72:73], s[74:75]
    v_pk_mul_f32 v[74:75], v[74:75], s[74:75]
    v_pk_mul_f32 v[76:77], v[76:77], s[74:75]
    v_pk_mul_f32 v[78:79], v[78:79], s[74:75]
    v_pk_mul_f32 v[80:81], v[80:81], s[74:75]
    v_pk_mul_f32 v[82:83], v[82:83], s[74:75]
    v_pk_mul_f32 v[84:85], v[84:85], s[74:75]
    v_pk_mul_f32 v[86:87], v[86:87], s[74:75]
    v_pk_mul_f32 v[88:89], v[88:89], s[74:75]
    v_pk_mul_f32 v[90:91], v[90:91], s[74:75]
    v_pk_mul_f32 v[92:93], v[92:93], s[74:75]
    v_pk_mul_f32 v[94:95], v[94:95], s[74:75]
    v_cvt_pk_bf16_f32 v96, v64, v65
    v_cvt_pk_bf16_f32 v97, v66, v67
    v_cvt_pk_bf16_f32 v98, v68, v69
    v_cvt_pk_bf16_f32 v99, v70, v71
    v_cvt_pk_bf16_f32 v100, v72, v73
    v_cvt_pk_bf16_f32 v101, v74, v75
    v_cvt_pk_bf16_f32 v102, v76, v77
    v_cvt_pk_bf16_f32 v103, v78, v79
    v_cvt_pk_bf16_f32 v104, v80, v81
    v_cvt_pk_bf16_f32 v105, v82, v83
    v_cvt_pk_bf16_f32 v106, v84, v85
    v_cvt_pk_bf16_f32 v107, v86, v87
    v_cvt_pk_bf16_f32 v108, v88, v89
    v_cvt_pk_bf16_f32 v109, v90, v91
    v_cvt_pk_bf16_f32 v110, v92, v93
    v_cvt_pk_bf16_f32 v111, v94, v95
    v_accvgpr_write_b32 a132, v96
    v_accvgpr_write_b32 a133, v97
    v_accvgpr_write_b32 a134, v98
    v_accvgpr_write_b32 a135, v99
    v_accvgpr_write_b32 a148, v100
    v_accvgpr_write_b32 a149, v101
    v_accvgpr_write_b32 a150, v102
    v_accvgpr_write_b32 a151, v103
    v_accvgpr_write_b32 a164, v104
    v_accvgpr_write_b32 a165, v105
    v_accvgpr_write_b32 a166, v106
    v_accvgpr_write_b32 a167, v107
    v_accvgpr_write_b32 a180, v108
    v_accvgpr_write_b32 a181, v109
    v_accvgpr_write_b32 a182, v110
    v_accvgpr_write_b32 a183, v111
    v_accvgpr_read_b32 v64, a64
    v_accvgpr_read_b32 v65, a65
    v_accvgpr_read_b32 v66, a66
    v_accvgpr_read_b32 v67, a67
    v_accvgpr_read_b32 v68, a80
    v_accvgpr_read_b32 v69, a81
    v_accvgpr_read_b32 v70, a82
    v_accvgpr_read_b32 v71, a83
    v_accvgpr_read_b32 v72, a68
    v_accvgpr_read_b32 v73, a69
    v_accvgpr_read_b32 v74, a70
    v_accvgpr_read_b32 v75, a71
    v_accvgpr_read_b32 v76, a84
    v_accvgpr_read_b32 v77, a85
    v_accvgpr_read_b32 v78, a86
    v_accvgpr_read_b32 v79, a87
    v_accvgpr_read_b32 v80, a72
    v_accvgpr_read_b32 v81, a73
    v_accvgpr_read_b32 v82, a74
    v_accvgpr_read_b32 v83, a75
    v_accvgpr_read_b32 v84, a88
    v_accvgpr_read_b32 v85, a89
    v_accvgpr_read_b32 v86, a90
    v_accvgpr_read_b32 v87, a91
    v_accvgpr_read_b32 v88, a76
    v_accvgpr_read_b32 v89, a77
    v_accvgpr_read_b32 v90, a78
    v_accvgpr_read_b32 v91, a79
    v_accvgpr_read_b32 v92, a92
    v_accvgpr_read_b32 v93, a93
    v_accvgpr_read_b32 v94, a94
    v_accvgpr_read_b32 v95, a95
    v_pk_mul_f32 v[64:65], v[64:65], s[74:75]
    v_pk_mul_f32 v[66:67], v[66:67], s[74:75]
    v_pk_mul_f32 v[68:69], v[68:69], s[74:75]
    v_pk_mul_f32 v[70:71], v[70:71], s[74:75]
    v_pk_mul_f32 v[72:73], v[72:73], s[74:75]
    v_pk_mul_f32 v[74:75], v[74:75], s[74:75]
    v_pk_mul_f32 v[76:77], v[76:77], s[74:75]
    v_pk_mul_f32 v[78:79], v[78:79], s[74:75]
    v_pk_mul_f32 v[80:81], v[80:81], s[74:75]
    v_pk_mul_f32 v[82:83], v[82:83], s[74:75]
    v_pk_mul_f32 v[84:85], v[84:85], s[74:75]
    v_pk_mul_f32 v[86:87], v[86:87], s[74:75]
    v_pk_mul_f32 v[88:89], v[88:89], s[74:75]
    v_pk_mul_f32 v[90:91], v[90:91], s[74:75]
    v_pk_mul_f32 v[92:93], v[92:93], s[74:75]
    v_pk_mul_f32 v[94:95], v[94:95], s[74:75]
    v_cvt_pk_bf16_f32 v96, v64, v65
    v_cvt_pk_bf16_f32 v97, v66, v67
    v_cvt_pk_bf16_f32 v98, v68, v69
    v_cvt_pk_bf16_f32 v99, v70, v71
    v_cvt_pk_bf16_f32 v100, v72, v73
    v_cvt_pk_bf16_f32 v101, v74, v75
    v_cvt_pk_bf16_f32 v102, v76, v77
    v_cvt_pk_bf16_f32 v103, v78, v79
    v_cvt_pk_bf16_f32 v104, v80, v81
    v_cvt_pk_bf16_f32 v105, v82, v83
    v_cvt_pk_bf16_f32 v106, v84, v85
    v_cvt_pk_bf16_f32 v107, v86, v87
    v_cvt_pk_bf16_f32 v108, v88, v89
    v_cvt_pk_bf16_f32 v109, v90, v91
    v_cvt_pk_bf16_f32 v110, v92, v93
    v_cvt_pk_bf16_f32 v111, v94, v95
    v_accvgpr_write_b32 a136, v96
    v_accvgpr_write_b32 a137, v97
    v_accvgpr_write_b32 a138, v98
    v_accvgpr_write_b32 a139, v99
    v_accvgpr_write_b32 a152, v100
    v_accvgpr_write_b32 a153, v101
    v_accvgpr_write_b32 a154, v102
    v_accvgpr_write_b32 a155, v103
    v_accvgpr_write_b32 a168, v104
    v_accvgpr_write_b32 a169, v105
    v_accvgpr_write_b32 a170, v106
    v_accvgpr_write_b32 a171, v107
    v_accvgpr_write_b32 a184, v108
    v_accvgpr_write_b32 a185, v109
    v_accvgpr_write_b32 a186, v110
    v_accvgpr_write_b32 a187, v111
    v_accvgpr_read_b32 v64, a96
    v_accvgpr_read_b32 v65, a97
    v_accvgpr_read_b32 v66, a98
    v_accvgpr_read_b32 v67, a99
    v_accvgpr_read_b32 v68, a112
    v_accvgpr_read_b32 v69, a113
    v_accvgpr_read_b32 v70, a114
    v_accvgpr_read_b32 v71, a115
    v_accvgpr_read_b32 v72, a100
    v_accvgpr_read_b32 v73, a101
    v_accvgpr_read_b32 v74, a102
    v_accvgpr_read_b32 v75, a103
    v_accvgpr_read_b32 v76, a116
    v_accvgpr_read_b32 v77, a117
    v_accvgpr_read_b32 v78, a118
    v_accvgpr_read_b32 v79, a119
    v_accvgpr_read_b32 v80, a104
    v_accvgpr_read_b32 v81, a105
    v_accvgpr_read_b32 v82, a106
    v_accvgpr_read_b32 v83, a107
    v_accvgpr_read_b32 v84, a120
    v_accvgpr_read_b32 v85, a121
    v_accvgpr_read_b32 v86, a122
    v_accvgpr_read_b32 v87, a123
    v_accvgpr_read_b32 v88, a108
    v_accvgpr_read_b32 v89, a109
    v_accvgpr_read_b32 v90, a110
    v_accvgpr_read_b32 v91, a111
    v_accvgpr_read_b32 v92, a124
    v_accvgpr_read_b32 v93, a125
    v_accvgpr_read_b32 v94, a126
    v_accvgpr_read_b32 v95, a127
    v_pk_mul_f32 v[64:65], v[64:65], s[74:75]
    v_pk_mul_f32 v[66:67], v[66:67], s[74:75]
    v_pk_mul_f32 v[68:69], v[68:69], s[74:75]
    v_pk_mul_f32 v[70:71], v[70:71], s[74:75]
    v_pk_mul_f32 v[72:73], v[72:73], s[74:75]
    v_pk_mul_f32 v[74:75], v[74:75], s[74:75]
    v_pk_mul_f32 v[76:77], v[76:77], s[74:75]
    v_pk_mul_f32 v[78:79], v[78:79], s[74:75]
    v_pk_mul_f32 v[80:81], v[80:81], s[74:75]
    v_pk_mul_f32 v[82:83], v[82:83], s[74:75]
    v_pk_mul_f32 v[84:85], v[84:85], s[74:75]
    v_pk_mul_f32 v[86:87], v[86:87], s[74:75]
    v_pk_mul_f32 v[88:89], v[88:89], s[74:75]
    v_pk_mul_f32 v[90:91], v[90:91], s[74:75]
    v_pk_mul_f32 v[92:93], v[92:93], s[74:75]
    v_pk_mul_f32 v[94:95], v[94:95], s[74:75]
    v_cvt_pk_bf16_f32 v96, v64, v65
    v_cvt_pk_bf16_f32 v97, v66, v67
    v_cvt_pk_bf16_f32 v98, v68, v69
    v_cvt_pk_bf16_f32 v99, v70, v71
    v_cvt_pk_bf16_f32 v100, v72, v73
    v_cvt_pk_bf16_f32 v101, v74, v75
    v_cvt_pk_bf16_f32 v102, v76, v77
    v_cvt_pk_bf16_f32 v103, v78, v79
    v_cvt_pk_bf16_f32 v104, v80, v81
    v_cvt_pk_bf16_f32 v105, v82, v83
    v_cvt_pk_bf16_f32 v106, v84, v85
    v_cvt_pk_bf16_f32 v107, v86, v87
    v_cvt_pk_bf16_f32 v108, v88, v89
    v_cvt_pk_bf16_f32 v109, v90, v91
    v_cvt_pk_bf16_f32 v110, v92, v93
    v_cvt_pk_bf16_f32 v111, v94, v95
    v_accvgpr_write_b32 a140, v96
    v_accvgpr_write_b32 a141, v97
    v_accvgpr_write_b32 a142, v98
    v_accvgpr_write_b32 a143, v99
    v_accvgpr_write_b32 a156, v100
    v_accvgpr_write_b32 a157, v101
    v_accvgpr_write_b32 a158, v102
    v_accvgpr_write_b32 a159, v103
    v_accvgpr_write_b32 a172, v104
    v_accvgpr_write_b32 a173, v105
    v_accvgpr_write_b32 a174, v106
    v_accvgpr_write_b32 a175, v107
    v_accvgpr_write_b32 a188, v108
    v_accvgpr_write_b32 a189, v109
    v_accvgpr_write_b32 a190, v110
    v_accvgpr_write_b32 a191, v111
    v_and_b32 v24, 15, v0
    v_lshrrev_b32 v25, 4, v0
    v_lshlrev_b32 v28, 8, v24
    v_add_u32 v28, 32768, v28
    v_add_u32 v29, 0, v25
    v_xor_b32 v29, v29, v24
    v_lshl_add_u32 v240, v29, 4, v28
    v_add_u32 v29, 4, v25
    v_xor_b32 v29, v29, v24
    v_lshl_add_u32 v241, v29, 4, v28
    v_add_u32 v29, 8, v25
    v_xor_b32 v29, v29, v24
    v_lshl_add_u32 v242, v29, 4, v28
    v_add_u32 v29, 12, v25
    v_xor_b32 v29, v29, v24
    v_lshl_add_u32 v243, v29, 4, v28
    s_waitcnt vmcnt(16)
    s_barrier
    ds_read_b128 a[192:195], v240 offset:32768
    ds_read_b128 a[196:199], v241 offset:32768
    ds_read_b128 a[200:203], v242 offset:32768
    ds_read_b128 a[204:207], v243 offset:32768
    s_waitcnt lgkmcnt(0)
    v_mfma_f32_16x16x32_bf16 v[32:35], a[192:195], a[128:131], 0
    ds_read_b128 a[208:211], v240 offset:36864
    v_mfma_f32_16x16x32_bf16 v[32:35], a[196:199], a[132:135], v[32:35]
    ds_read_b128 a[212:215], v241 offset:36864
    v_mfma_f32_16x16x32_bf16 v[32:35], a[200:203], a[136:139], v[32:35]
    ds_read_b128 a[216:219], v242 offset:36864
    v_mfma_f32_16x16x32_bf16 v[32:35], a[204:207], a[140:143], v[32:35]
    ds_read_b128 a[220:223], v243 offset:36864
    v_mfma_f32_16x16x32_bf16 v[36:39], a[204:207], a[156:159], 0
    v_lshrrev_b32 v24, 2, v0
    v_and_b32 v25, 3, v0
    v_mfma_f32_16x16x32_bf16 v[36:39], a[200:203], a[152:155], v[36:39]
    v_lshlrev_b32 v25, 3, v25
    v_lshl_add_u32 v28, v24, 8, v25
    v_mfma_f32_16x16x32_bf16 v[36:39], a[196:199], a[148:151], v[36:39]
    v_add_u32 v28, 65536, v28
    v_and_b32 v29, 7, v24
    v_mfma_f32_16x16x32_bf16 v[36:39], a[192:195], a[144:147], v[36:39]
    v_xor_b32 v30, 0, v29
    v_lshl_add_u32 v244, v30, 5, v28
    v_mfma_f32_16x16x32_bf16 v[40:43], a[192:195], a[160:163], 0
    v_xor_b32 v30, 1, v29
    v_lshl_add_u32 v245, v30, 5, v28
    v_mfma_f32_16x16x32_bf16 v[40:43], a[196:199], a[164:167], v[40:43]
    v_xor_b32 v30, 2, v29
    v_lshl_add_u32 v246, v30, 5, v28
    v_mfma_f32_16x16x32_bf16 v[40:43], a[200:203], a[168:171], v[40:43]
    v_xor_b32 v30, 3, v29
    v_lshl_add_u32 v247, v30, 5, v28
    v_mfma_f32_16x16x32_bf16 v[40:43], a[204:207], a[172:175], v[40:43]
    v_xor_b32 v30, 4, v29
    v_lshl_add_u32 v248, v30, 5, v28
    v_mfma_f32_16x16x32_bf16 v[44:47], a[204:207], a[188:191], 0
    v_xor_b32 v30, 5, v29
    v_lshl_add_u32 v249, v30, 5, v28
    v_mfma_f32_16x16x32_bf16 v[44:47], a[200:203], a[184:187], v[44:47]
    v_xor_b32 v30, 6, v29
    v_lshl_add_u32 v250, v30, 5, v28
    v_mfma_f32_16x16x32_bf16 v[44:47], a[196:199], a[180:183], v[44:47]
    v_xor_b32 v30, 7, v29
    v_lshl_add_u32 v251, v30, 5, v28
    v_mfma_f32_16x16x32_bf16 v[44:47], a[192:195], a[176:179], v[44:47]
    s_waitcnt lgkmcnt(0)
    v_lshl_add_u32 v28, v24, 7, v25
    v_mfma_f32_16x16x32_bf16 v[60:63], a[208:211], a[176:179], 0
    ds_read_b128 a[192:195], v240 offset:40960
    v_mfma_f32_16x16x32_bf16 v[60:63], a[212:215], a[180:183], v[60:63]
    ds_read_b128 a[196:199], v241 offset:40960
    v_mfma_f32_16x16x32_bf16 v[60:63], a[216:219], a[184:187], v[60:63]
    ds_read_b128 a[200:203], v242 offset:40960
    v_mfma_f32_16x16x32_bf16 v[60:63], a[220:223], a[188:191], v[60:63]
    ds_read_b128 a[204:207], v243 offset:40960
    v_mfma_f32_16x16x32_bf16 v[56:59], a[220:223], a[172:175], 0
    s_lshl_b32 s3, s60, 14
    v_add_u32 v28, s3, v28
    v_mfma_f32_16x16x32_bf16 v[56:59], a[216:219], a[168:171], v[56:59]
    v_bfe_u32 v29, v0, 3, 2
    v_xor_b32 v30, 0, v29
    v_mfma_f32_16x16x32_bf16 v[56:59], a[212:215], a[164:167], v[56:59]
    v_lshl_add_u32 v12, v30, 5, v28
    v_add_u32 v16, 65536, v12
    v_mfma_f32_16x16x32_bf16 v[56:59], a[208:211], a[160:163], v[56:59]
    v_xor_b32 v30, 1, v29
    v_lshl_add_u32 v13, v30, 5, v28
    v_mfma_f32_16x16x32_bf16 v[52:55], a[208:211], a[144:147], 0
    v_add_u32 v17, 65536, v13
    v_xor_b32 v30, 2, v29
    v_mfma_f32_16x16x32_bf16 v[52:55], a[212:215], a[148:151], v[52:55]
    v_lshl_add_u32 v14, v30, 5, v28
    v_add_u32 v2, 65536, v14
    v_mfma_f32_16x16x32_bf16 v[52:55], a[216:219], a[152:155], v[52:55]
    v_xor_b32 v30, 3, v29
    v_lshl_add_u32 v15, v30, 5, v28
    v_mfma_f32_16x16x32_bf16 v[52:55], a[220:223], a[156:159], v[52:55]
    v_add_u32 v3, 65536, v15
    v_lshrrev_b32 v24, 3, v0
    v_mfma_f32_16x16x32_bf16 v[48:51], a[220:223], a[140:143], 0
    v_cmp_eq_u32 vcc, 3, v24
    v_and_b32 v24, 0x70, v1
    v_mfma_f32_16x16x32_bf16 v[48:51], a[216:219], a[136:139], v[48:51]
    v_add_u32 v4, 8192, v24
    v_cndmask_b32 v4, v1, v4, vcc
    v_mfma_f32_16x16x32_bf16 v[48:51], a[212:215], a[132:135], v[48:51]
    v_add_u32 v5, 7296, v24
    v_cndmask_b32 v5, v1, v5, vcc
    v_mfma_f32_16x16x32_bf16 v[48:51], a[208:211], a[128:131], v[48:51]
    s_waitcnt lgkmcnt(0)
    v_add_u32 v6, 6400, v24
    v_mfma_f32_16x16x32_bf16 v[64:67], a[192:195], a[128:131], 0
    ds_read_b128 a[208:211], v240 offset:45056
    v_mfma_f32_16x16x32_bf16 v[64:67], a[196:199], a[132:135], v[64:67]
    ds_read_b128 a[212:215], v241 offset:45056
    v_mfma_f32_16x16x32_bf16 v[64:67], a[200:203], a[136:139], v[64:67]
    ds_read_b128 a[216:219], v242 offset:45056
    v_mfma_f32_16x16x32_bf16 v[64:67], a[204:207], a[140:143], v[64:67]
    ds_read_b128 a[220:223], v243 offset:45056
    v_mfma_f32_16x16x32_bf16 v[68:71], a[204:207], a[156:159], 0
    v_cndmask_b32 v6, v1, v6, vcc
    v_add_u32 v7, 5632, v24
    v_mfma_f32_16x16x32_bf16 v[68:71], a[200:203], a[152:155], v[68:71]
    v_cndmask_b32 v7, v1, v7, vcc
    v_add_u32 v8, 4736, v24
    v_mfma_f32_16x16x32_bf16 v[68:71], a[196:199], a[148:151], v[68:71]
    v_cndmask_b32 v8, v1, v8, vcc
    v_add_u32 v9, 3840, v24
    v_mfma_f32_16x16x32_bf16 v[68:71], a[192:195], a[144:147], v[68:71]
    v_cndmask_b32 v9, v1, v9, vcc
    v_add_u32 v10, 2944, v24
    v_mfma_f32_16x16x32_bf16 v[72:75], a[192:195], a[160:163], 0
    v_cndmask_b32 v10, v1, v10, vcc
    v_add_u32 v11, 2048, v24
    v_mfma_f32_16x16x32_bf16 v[72:75], a[196:199], a[164:167], v[72:75]
    v_cndmask_b32 v11, v1, v11, vcc
    s_mul_i32 s3, s48, 655360
    v_mfma_f32_16x16x32_bf16 v[72:75], a[200:203], a[168:171], v[72:75]
    s_mul_i32 s49, s46, 20480
    s_add_u32 s3, s3, s49
    v_mfma_f32_16x16x32_bf16 v[72:75], a[204:207], a[172:175], v[72:75]
    s_add_u32 s3, s3, 199229440
    v_mfma_f32_16x16x32_bf16 v[76:79], a[204:207], a[188:191], 0
    s_add_u32 s40, s10, s3
    s_addc_u32 s41, s11, 0
    v_mfma_f32_16x16x32_bf16 v[76:79], a[200:203], a[184:187], v[76:79]
    s_mov_b32 s42, 20480
    s_mov_b32 s43, 0x20000
    v_mfma_f32_16x16x32_bf16 v[76:79], a[196:199], a[180:183], v[76:79]
    s_lshr_b32 s3, s58, 2
    s_lshl_b32 s3, s3, 1
    v_mfma_f32_16x16x32_bf16 v[76:79], a[192:195], a[176:179], v[76:79]
    s_waitcnt lgkmcnt(0)
    s_add_u32 s3, s3, s60
    v_mfma_f32_16x16x32_bf16 v[92:95], a[208:211], a[176:179], 0
    ds_read_b128 a[192:195], v240 offset:49152
    v_mfma_f32_16x16x32_bf16 v[92:95], a[212:215], a[180:183], v[92:95]
    ds_read_b128 a[196:199], v241 offset:49152
    v_mfma_f32_16x16x32_bf16 v[92:95], a[216:219], a[184:187], v[92:95]
    ds_read_b128 a[200:203], v242 offset:49152
    v_mfma_f32_16x16x32_bf16 v[92:95], a[220:223], a[188:191], v[92:95]
    ds_read_b128 a[204:207], v243 offset:49152
    v_mfma_f32_16x16x32_bf16 v[88:91], a[220:223], a[172:175], 0
    s_mul_i32 s3, s3, s18
    s_lshl_b32 s49, s59, 12
    v_mfma_f32_16x16x32_bf16 v[88:91], a[216:219], a[168:171], v[88:91]
    s_add_u32 s3, s3, s49
    s_mul_i32 s50, s56, 1310720
    v_mfma_f32_16x16x32_bf16 v[88:91], a[212:215], a[164:167], v[88:91]
    s_add_u32 s3, s3, s50
    s_add_u32 s3, s3, 247463936
    v_mfma_f32_16x16x32_bf16 v[88:91], a[208:211], a[160:163], v[88:91]
    s_sub_u32 s49, s18, s49
    v_mfma_f32_16x16x32_bf16 v[84:87], a[208:211], a[144:147], 0
    s_add_u32 s8, s10, s3
    s_addc_u32 s9, s11, 0
    v_mfma_f32_16x16x32_bf16 v[84:87], a[212:215], a[148:151], v[84:87]
    s_add_u32 s36, s20, 128
    s_addc_u32 s37, s21, 0
    v_mfma_f32_16x16x32_bf16 v[84:87], a[216:219], a[152:155], v[84:87]
    s_sub_u32 s38, s22, 128
    s_and_b32 s3, s58, 3
    v_mfma_f32_16x16x32_bf16 v[84:87], a[220:223], a[156:159], v[84:87]
    s_cmp_eq_u32 s3, 1
    s_cmov_b32 s36, s8
    s_cmov_b32 s37, s9
    s_cmov_b32 s38, s49
    s_mov_b32 s47, 131072
    s_cmov_b32 s47, 10240
    s_cselect_b32 s45, 0, 128
    v_mfma_f32_16x16x32_bf16 v[80:83], a[220:223], a[140:143], 0
    v_bfe_u32 v28, v0, 1, 2
    v_lshrrev_b32 v29, 4, v0
    v_mfma_f32_16x16x32_bf16 v[80:83], a[216:219], a[136:139], v[80:83]
    v_xor_b32 v28, v28, v29
    v_lshlrev_b32 v28, 5, v28
    v_mfma_f32_16x16x32_bf16 v[80:83], a[212:215], a[132:135], v[80:83]
    v_and_b32 v29, 1, v0
    v_lshl_add_u32 v28, v29, 4, v28
    v_mfma_f32_16x16x32_bf16 v[80:83], a[208:211], a[128:131], v[80:83]
    v_lshrrev_b32 v29, 3, v0
    v_lshl_add_u32 v252, v29, 11, v28
    v_add_u32 v253, 15360, v252
    v_add_u32 v254, 30720, v252
    v_add_u32 v255, 46080, v252
    v_lshrrev_b32 v28, 2, v0
    v_lshlrev_b32 v28, 11, v28
    v_bfe_u32 v29, v0, 1, 1
    v_mul_u32_u24 v29, s45, v29
    v_add_u32 v25, v28, v29
    s_lshl_b32 s49, s57, 18
    v_mov_b32 v24, 0x3f803f80
    v_accvgpr_write_b32 a240, v24
    v_accvgpr_write_b32 a241, v24
    v_accvgpr_write_b32 a242, v24
    v_accvgpr_write_b32 a243, v24
    s_add_u32 s68, s51, 65536
    s_add_u32 s69, s51, 49152
    s_mov_b32 s70, 32768
    s_mov_b32 s71, 49152
    s_add_u32 s72, s51, 32768
    s_add_u32 s73, s51, 98304
    s_mov_b32 s52, 2
    v_mov_b32 v26, s54
    v_mov_b32 v27, s55
    s_lshl_b32 s3, s2, 3
    s_add_u32 s3, s3, 256
    v_mov_b32 v24, 2130706432
    s_cmp_eq_u32 s44, 0
    s_cselect_b32 s3, s3, 2130706432
    v_writelane_b32 v24, s3, 0
    v_mov_b32 v28, 0
    v_mov_b32 v29, 0
    v_mov_b32 v30, 0
    v_mov_b32 v31, 0
    s_waitcnt lgkmcnt(0)
    v_mfma_f32_16x16x32_bf16 v[96:99], a[192:195], a[128:131], 0
    ds_read_b128 a[208:211], v240 offset:53248
    v_mfma_f32_16x16x32_bf16 v[96:99], a[196:199], a[132:135], v[96:99]
    ds_read_b128 a[212:215], v241 offset:53248
    v_mfma_f32_16x16x32_bf16 v[96:99], a[200:203], a[136:139], v[96:99]
    ds_read_b128 a[216:219], v242 offset:53248
    v_mfma_f32_16x16x32_bf16 v[96:99], a[204:207], a[140:143], v[96:99]
    ds_read_b128 a[220:223], v243 offset:53248
    v_mfma_f32_16x16x32_bf16 v[100:103], a[204:207], a[156:159], 0
    v_exp_f32 v32, v32
    v_mfma_f32_16x16x32_bf16 v[100:103], a[200:203], a[152:155], v[100:103]
    v_exp_f32 v33, v33
    v_mfma_f32_16x16x32_bf16 v[100:103], a[196:199], a[148:151], v[100:103]
    v_exp_f32 v34, v34
    v_mfma_f32_16x16x32_bf16 v[100:103], a[192:195], a[144:147], v[100:103]
    v_exp_f32 v35, v35
    v_mfma_f32_16x16x32_bf16 v[104:107], a[192:195], a[160:163], 0
    v_exp_f32 v36, v36
    v_mfma_f32_16x16x32_bf16 v[104:107], a[196:199], a[164:167], v[104:107]
    v_exp_f32 v37, v37
    v_mfma_f32_16x16x32_bf16 v[104:107], a[200:203], a[168:171], v[104:107]
    v_cvt_pk_bf16_f32 v160, v32, v33
    v_cvt_pk_bf16_f32 v161, v34, v35
    v_mfma_f32_16x16x32_bf16 v[104:107], a[204:207], a[172:175], v[104:107]
    v_exp_f32 v38, v38
    v_mfma_f32_16x16x32_bf16 v[108:111], a[204:207], a[188:191], 0
    v_exp_f32 v39, v39
    v_mfma_f32_16x16x32_bf16 v[108:111], a[200:203], a[184:187], v[108:111]
    v_exp_f32 v40, v40
    v_mfma_f32_16x16x32_bf16 v[108:111], a[196:199], a[180:183], v[108:111]
    v_exp_f32 v41, v41
    v_mfma_f32_16x16x32_bf16 v[108:111], a[192:195], a[176:179], v[108:111]
    s_waitcnt lgkmcnt(0)
    v_cvt_pk_bf16_f32 v164, v36, v37
    v_mfma_f32_16x16x32_bf16 v[124:127], a[208:211], a[176:179], 0
    ds_read_b128 a[192:195], v240 offset:57344
    v_mfma_f32_16x16x32_bf16 v[124:127], a[212:215], a[180:183], v[124:127]
    ds_read_b128 a[196:199], v241 offset:57344
    v_mfma_f32_16x16x32_bf16 v[124:127], a[216:219], a[184:187], v[124:127]
    ds_read_b128 a[200:203], v242 offset:57344
    v_mfma_f32_16x16x32_bf16 v[124:127], a[220:223], a[188:191], v[124:127]
    ds_read_b128 a[204:207], v243 offset:57344
    v_mfma_f32_16x16x32_bf16 v[120:123], a[220:223], a[172:175], 0
    v_cvt_pk_bf16_f32 v165, v38, v39
    v_mfma_f32_16x16x32_bf16 v[120:123], a[216:219], a[168:171], v[120:123]
    v_exp_f32 v42, v42
    v_mfma_f32_16x16x32_bf16 v[120:123], a[212:215], a[164:167], v[120:123]
    v_exp_f32 v43, v43
    v_mfma_f32_16x16x32_bf16 v[120:123], a[208:211], a[160:163], v[120:123]
    v_exp_f32 v44, v44
    v_mfma_f32_16x16x32_bf16 v[116:119], a[208:211], a[144:147], 0
    v_exp_f32 v45, v45
    v_mfma_f32_16x16x32_bf16 v[116:119], a[212:215], a[148:151], v[116:119]
    v_cvt_pk_bf16_f32 v168, v40, v41
    v_cvt_pk_bf16_f32 v169, v42, v43
    v_mfma_f32_16x16x32_bf16 v[116:119], a[216:219], a[152:155], v[116:119]
    v_exp_f32 v46, v46
    v_mfma_f32_16x16x32_bf16 v[116:119], a[220:223], a[156:159], v[116:119]
    v_exp_f32 v47, v47
    v_mfma_f32_16x16x32_bf16 v[112:115], a[220:223], a[140:143], 0
    v_exp_f32 v48, v48
    v_mfma_f32_16x16x32_bf16 v[112:115], a[216:219], a[136:139], v[112:115]
    v_exp_f32 v49, v49
    v_mfma_f32_16x16x32_bf16 v[112:115], a[212:215], a[132:135], v[112:115]
    v_cvt_pk_bf16_f32 v172, v44, v45
    v_cvt_pk_bf16_f32 v173, v46, v47
    v_mfma_f32_16x16x32_bf16 v[112:115], a[208:211], a[128:131], v[112:115]
    s_waitcnt lgkmcnt(0)
    v_mfma_f32_16x16x32_bf16 v[128:131], a[192:195], a[128:131], 0
    ds_read_b128 a[208:211], v240 offset:61440
    v_mfma_f32_16x16x32_bf16 v[128:131], a[196:199], a[132:135], v[128:131]
    ds_read_b128 a[212:215], v241 offset:61440
    v_mfma_f32_16x16x32_bf16 v[128:131], a[200:203], a[136:139], v[128:131]
    ds_read_b128 a[216:219], v242 offset:61440
    v_mfma_f32_16x16x32_bf16 v[128:131], a[204:207], a[140:143], v[128:131]
    ds_read_b128 a[220:223], v243 offset:61440
    v_mfma_f32_16x16x32_bf16 v[132:135], a[204:207], a[156:159], 0
    v_exp_f32 v50, v50
    v_mfma_f32_16x16x32_bf16 v[132:135], a[200:203], a[152:155], v[132:135]
    v_exp_f32 v51, v51
    v_mfma_f32_16x16x32_bf16 v[132:135], a[196:199], a[148:151], v[132:135]
    v_exp_f32 v52, v52
    v_mfma_f32_16x16x32_bf16 v[132:135], a[192:195], a[144:147], v[132:135]
    v_exp_f32 v53, v53
    v_mfma_f32_16x16x32_bf16 v[136:139], a[192:195], a[160:163], 0
    v_cvt_pk_bf16_f32 v162, v48, v49
    v_cvt_pk_bf16_f32 v163, v50, v51
    v_mfma_f32_16x16x32_bf16 v[136:139], a[196:199], a[164:167], v[136:139]
    v_exp_f32 v54, v54
    v_mfma_f32_16x16x32_bf16 v[136:139], a[200:203], a[168:171], v[136:139]
    v_exp_f32 v55, v55
    v_mfma_f32_16x16x32_bf16 v[136:139], a[204:207], a[172:175], v[136:139]
    v_exp_f32 v56, v56
    v_mfma_f32_16x16x32_bf16 v[140:143], a[204:207], a[188:191], 0
    v_exp_f32 v57, v57
    v_mfma_f32_16x16x32_bf16 v[140:143], a[200:203], a[184:187], v[140:143]
    v_cvt_pk_bf16_f32 v166, v52, v53
    v_cvt_pk_bf16_f32 v167, v54, v55
    v_mfma_f32_16x16x32_bf16 v[140:143], a[196:199], a[180:183], v[140:143]
    v_exp_f32 v58, v58
    v_mfma_f32_16x16x32_bf16 v[140:143], a[192:195], a[176:179], v[140:143]
    s_waitcnt lgkmcnt(0)
    s_barrier
    v_mfma_f32_16x16x32_bf16 v[156:159], a[208:211], a[176:179], 0
    v_xor_b32 v240, 0x8000, v240
    v_xor_b32 v241, 0x8000, v241
    v_mfma_f32_16x16x32_bf16 v[156:159], a[212:215], a[180:183], v[156:159]
    v_xor_b32 v242, 0x8000, v242
    v_xor_b32 v243, 0x8000, v243
    v_mfma_f32_16x16x32_bf16 v[156:159], a[216:219], a[184:187], v[156:159]
    ds_read_b128 a[192:195], v240 offset:32768
    v_mfma_f32_16x16x32_bf16 v[156:159], a[220:223], a[188:191], v[156:159]
    ds_read_b128 a[196:199], v241 offset:32768
    v_mfma_f32_16x16x32_bf16 v[152:155], a[220:223], a[172:175], 0
    ds_read_b128 a[200:203], v242 offset:32768
    v_mfma_f32_16x16x32_bf16 v[152:155], a[216:219], a[168:171], v[152:155]
    ds_read_b128 a[204:207], v243 offset:32768
    v_mfma_f32_16x16x32_bf16 v[152:155], a[212:215], a[164:167], v[152:155]
    v_exp_f32 v59, v59
    v_mfma_f32_16x16x32_bf16 v[152:155], a[208:211], a[160:163], v[152:155]
    v_exp_f32 v60, v60
    v_mfma_f32_16x16x32_bf16 v[148:151], a[208:211], a[144:147], 0
    v_exp_f32 v61, v61
    v_mfma_f32_16x16x32_bf16 v[148:151], a[212:215], a[148:151], v[148:151]
    v_cvt_pk_bf16_f32 v170, v56, v57
    v_cvt_pk_bf16_f32 v171, v58, v59
    v_mfma_f32_16x16x32_bf16 v[148:151], a[216:219], a[152:155], v[148:151]
    v_exp_f32 v62, v62
    v_mfma_f32_16x16x32_bf16 v[148:151], a[220:223], a[156:159], v[148:151]
    v_exp_f32 v63, v63
    v_mfma_f32_16x16x32_bf16 v[144:147], a[220:223], a[140:143], 0
    v_exp_f32 v64, v64
    v_mfma_f32_16x16x32_bf16 v[144:147], a[216:219], a[136:139], v[144:147]
    v_exp_f32 v65, v65
    v_mfma_f32_16x16x32_bf16 v[144:147], a[212:215], a[132:135], v[144:147]
    v_cvt_pk_bf16_f32 v174, v60, v61
    v_cvt_pk_bf16_f32 v175, v62, v63
    v_mfma_f32_16x16x32_bf16 v[144:147], a[208:211], a[128:131], v[144:147]
    v_exp_f32 v66, v66
    v_mfma_f32_32x32x16_bf16 a[0:15], v[28:31], v[28:31], 0
    v_exp_f32 v67, v67
    v_mfma_f32_32x32x16_bf16 a[16:31], v[28:31], v[28:31], 0
    v_exp_f32 v68, v68
    v_mfma_f32_32x32x16_bf16 a[32:47], v[28:31], v[28:31], 0
    v_exp_f32 v69, v69
    v_mfma_f32_32x32x16_bf16 a[48:63], v[28:31], v[28:31], 0
    v_cvt_pk_bf16_f32 v176, v64, v65
    v_cvt_pk_bf16_f32 v177, v66, v67
    v_mfma_f32_32x32x16_bf16 a[64:79], v[28:31], v[28:31], 0
    v_exp_f32 v70, v70
    v_mfma_f32_32x32x16_bf16 a[80:95], v[28:31], v[28:31], 0
    v_exp_f32 v71, v71
    v_mfma_f32_32x32x16_bf16 a[96:111], v[28:31], v[28:31], 0
    v_exp_f32 v72, v72
    v_mfma_f32_32x32x16_bf16 a[112:127], v[28:31], v[28:31], 0
    v_exp_f32 v73, v73
    v_mfma_f32_32x32x16_bf16 a[224:239], v[28:31], v[28:31], 0
    v_cvt_pk_bf16_f32 v180, v68, v69
    v_cvt_pk_bf16_f32 v181, v70, v71
    v_exp_f32 v74, v74
    v_exp_f32 v75, v75
    v_exp_f32 v76, v76
    v_exp_f32 v77, v77
    v_cvt_pk_bf16_f32 v184, v72, v73
    v_cvt_pk_bf16_f32 v185, v74, v75
    v_exp_f32 v78, v78
    v_exp_f32 v79, v79
    v_exp_f32 v80, v80
    v_exp_f32 v81, v81
    v_cvt_pk_bf16_f32 v188, v76, v77
    v_cvt_pk_bf16_f32 v189, v78, v79
    v_exp_f32 v82, v82
    v_exp_f32 v83, v83
    v_exp_f32 v84, v84
    v_exp_f32 v85, v85
    v_cvt_pk_bf16_f32 v178, v80, v81
    v_cvt_pk_bf16_f32 v179, v82, v83
    v_exp_f32 v86, v86
    v_exp_f32 v87, v87
    v_exp_f32 v88, v88
    v_exp_f32 v89, v89
    v_cvt_pk_bf16_f32 v182, v84, v85
    v_cvt_pk_bf16_f32 v183, v86, v87
    v_exp_f32 v90, v90
    v_exp_f32 v91, v91
    v_exp_f32 v92, v92
    v_exp_f32 v93, v93
    v_cvt_pk_bf16_f32 v186, v88, v89
    v_cvt_pk_bf16_f32 v187, v90, v91
    v_exp_f32 v94, v94
    v_exp_f32 v95, v95
    s_nop 0
    v_cvt_pk_bf16_f32 v190, v92, v93
    v_cvt_pk_bf16_f32 v191, v94, v95
    s_waitcnt lgkmcnt(0)
    s_nop 7
    s_nop 3
.p2align 6
L_att_loop:
    v_mfma_f32_16x16x32_bf16 v[32:35], a[192:195], a[128:131], 0
    ds_read_b64_tr_b16 a[208:209], v244 offset:32768
    v_mfma_f32_16x16x32_bf16 v[32:35], a[196:199], a[132:135], v[32:35]
    ds_read_b64_tr_b16 a[210:211], v244 offset:36864
    v_mfma_f32_16x16x32_bf16 v[32:35], a[200:203], a[136:139], v[32:35]
    ds_read_b64_tr_b16 a[212:213], v244 offset:40960
    v_mfma_f32_16x16x32_bf16 v[32:35], a[204:207], a[140:143], v[32:35]
    ds_read_b64_tr_b16 a[214:215], v244 offset:45056
    v_mfma_f32_16x16x32_bf16 v[36:39], a[204:207], a[156:159], 0
    ds_read_b64_tr_b16 a[216:217], v245 offset:32768
    v_mfma_f32_16x16x32_bf16 v[36:39], a[200:203], a[152:155], v[36:39]
    ds_read_b64_tr_b16 a[218:219], v245 offset:36864
    s_add_u32 m0, s70, s72
    v_mfma_f32_16x16x32_bf16 v[36:39], a[196:199], a[148:151], v[36:39]
    ds_read_b64_tr_b16 a[220:221], v245 offset:40960
    buffer_load_dwordx4 v18, s[28:31], s68 offen offset:0 lds
    v_mfma_f32_16x16x32_bf16 v[36:39], a[192:195], a[144:147], v[36:39]
    ds_read_b64_tr_b16 a[222:223], v245 offset:45056
    v_mfma_f32_16x16x32_bf16 v[40:43], a[192:195], a[160:163], 0
    v_exp_f32 v96, v96
    v_mfma_f32_16x16x32_bf16 v[40:43], a[196:199], a[164:167], v[40:43]
    v_exp_f32 v97, v97
    v_mfma_f32_16x16x32_bf16 v[40:43], a[200:203], a[168:171], v[40:43]
    v_exp_f32 v98, v98
    v_mfma_f32_16x16x32_bf16 v[40:43], a[204:207], a[172:175], v[40:43]
    v_exp_f32 v99, v99
    v_mfma_f32_16x16x32_bf16 v[44:47], a[204:207], a[188:191], 0
    v_exp_f32 v100, v100
    v_mfma_f32_16x16x32_bf16 v[44:47], a[200:203], a[184:187], v[44:47]
    v_exp_f32 v101, v101
    v_mfma_f32_16x16x32_bf16 v[44:47], a[196:199], a[180:183], v[44:47]
    buffer_load_dwordx4 v19, s[28:31], s68 offen offset:1024 lds
    v_mfma_f32_16x16x32_bf16 v[44:47], a[192:195], a[176:179], v[44:47]
    s_waitcnt lgkmcnt(0)
    v_cvt_pk_bf16_f32 v192, v96, v97
    v_mfma_f32_16x16x32_bf16 a[0:3], a[208:211], v[160:163], a[0:3]
    ds_read_b128 a[192:195], v240 offset:36864
    v_mfma_f32_16x16x32_bf16 a[0:3], a[212:215], v[176:179], a[0:3]
    ds_read_b128 a[196:199], v241 offset:36864
    v_mfma_f32_16x16x32_bf16 a[4:7], a[212:215], v[180:183], a[4:7]
    ds_read_b128 a[200:203], v242 offset:36864
    v_mfma_f32_16x16x32_bf16 a[4:7], a[208:211], v[164:167], a[4:7]
    ds_read_b128 a[204:207], v243 offset:36864
    v_mfma_f32_16x16x32_bf16 a[8:11], a[208:211], v[168:171], a[8:11]
    v_cvt_pk_bf16_f32 v193, v98, v99
    v_mfma_f32_16x16x32_bf16 a[8:11], a[212:215], v[184:187], a[8:11]
    v_exp_f32 v102, v102
    v_mfma_f32_16x16x32_bf16 a[12:15], a[212:215], v[188:191], a[12:15]
    buffer_load_dwordx4 v20, s[28:31], s68 offen offset:2048 lds
    v_mfma_f32_16x16x32_bf16 a[12:15], a[208:211], v[172:175], a[12:15]
    v_exp_f32 v103, v103
    v_mfma_f32_16x16x32_bf16 a[28:31], a[216:219], v[172:175], a[28:31]
    v_exp_f32 v104, v104
    v_mfma_f32_16x16x32_bf16 a[28:31], a[220:223], v[188:191], a[28:31]
    v_exp_f32 v105, v105
    v_mfma_f32_16x16x32_bf16 a[24:27], a[220:223], v[184:187], a[24:27]
    v_cvt_pk_bf16_f32 v196, v100, v101
    v_cvt_pk_bf16_f32 v197, v102, v103
    v_mfma_f32_16x16x32_bf16 a[24:27], a[216:219], v[168:171], a[24:27]
    v_exp_f32 v106, v106
    v_mfma_f32_16x16x32_bf16 a[20:23], a[216:219], v[164:167], a[20:23]
    v_exp_f32 v107, v107
    v_mfma_f32_16x16x32_bf16 a[20:23], a[220:223], v[180:183], a[20:23]
    v_exp_f32 v108, v108
    v_mfma_f32_16x16x32_bf16 a[16:19], a[220:223], v[176:179], a[16:19]
    buffer_load_dwordx4 v21, s[28:31], s68 offen offset:3072 lds
    v_mfma_f32_16x16x32_bf16 a[16:19], a[216:219], v[160:163], a[16:19]
    s_waitcnt lgkmcnt(0)
    v_mfma_f32_16x16x32_bf16 v[60:63], a[192:195], a[176:179], 0
    ds_read_b64_tr_b16 a[208:209], v246 offset:32768
    v_mfma_f32_16x16x32_bf16 v[60:63], a[196:199], a[180:183], v[60:63]
    ds_read_b64_tr_b16 a[210:211], v246 offset:36864
    v_mfma_f32_16x16x32_bf16 v[60:63], a[200:203], a[184:187], v[60:63]
    ds_read_b64_tr_b16 a[212:213], v246 offset:40960
    v_mfma_f32_16x16x32_bf16 v[60:63], a[204:207], a[188:191], v[60:63]
    ds_read_b64_tr_b16 a[214:215], v246 offset:45056
    v_mfma_f32_16x16x32_bf16 v[56:59], a[204:207], a[172:175], 0
    ds_read_b64_tr_b16 a[216:217], v247 offset:32768
    v_mfma_f32_16x16x32_bf16 v[56:59], a[200:203], a[168:171], v[56:59]
    ds_read_b64_tr_b16 a[218:219], v247 offset:36864
    s_add_u32 m0, s71, s73
    v_mfma_f32_16x16x32_bf16 v[56:59], a[196:199], a[164:167], v[56:59]
    ds_read_b64_tr_b16 a[220:221], v247 offset:40960
    buffer_load_dwordx4 v22, s[32:35], s69 offen offset:0 lds
    v_mfma_f32_16x16x32_bf16 v[56:59], a[192:195], a[160:163], v[56:59]
    ds_read_b64_tr_b16 a[222:223], v247 offset:45056
    v_mfma_f32_16x16x32_bf16 v[52:55], a[192:195], a[144:147], 0
    v_exp_f32 v109, v109
    v_mfma_f32_16x16x32_bf16 v[52:55], a[196:199], a[148:151], v[52:55]
    v_cvt_pk_bf16_f32 v200, v104, v105
    v_cvt_pk_bf16_f32 v201, v106, v107
    v_mfma_f32_16x16x32_bf16 v[52:55], a[200:203], a[152:155], v[52:55]
    v_exp_f32 v110, v110
    v_mfma_f32_16x16x32_bf16 v[52:55], a[204:207], a[156:159], v[52:55]
    v_exp_f32 v111, v111
    v_mfma_f32_16x16x32_bf16 v[48:51], a[204:207], a[140:143], 0
    v_exp_f32 v112, v112
    v_mfma_f32_16x16x32_bf16 v[48:51], a[200:203], a[136:139], v[48:51]
    v_exp_f32 v113, v113
    v_mfma_f32_16x16x32_bf16 v[48:51], a[196:199], a[132:135], v[48:51]
    buffer_load_dwordx4 v23, s[32:35], s69 offen offset:1024 lds
    v_mfma_f32_16x16x32_bf16 v[48:51], a[192:195], a[128:131], v[48:51]
    s_waitcnt lgkmcnt(0)
    v_cvt_pk_bf16_f32 v204, v108, v109
    v_mfma_f32_16x16x32_bf16 a[32:35], a[208:211], v[160:163], a[32:35]
    ds_read_b128 a[192:195], v240 offset:40960
    v_mfma_f32_16x16x32_bf16 a[32:35], a[212:215], v[176:179], a[32:35]
    ds_read_b128 a[196:199], v241 offset:40960
    v_mfma_f32_16x16x32_bf16 a[36:39], a[212:215], v[180:183], a[36:39]
    ds_read_b128 a[200:203], v242 offset:40960
    v_mfma_f32_16x16x32_bf16 a[36:39], a[208:211], v[164:167], a[36:39]
    ds_read_b128 a[204:207], v243 offset:40960
    v_mfma_f32_16x16x32_bf16 a[40:43], a[208:211], v[168:171], a[40:43]
    v_cvt_pk_bf16_f32 v205, v110, v111
    v_mfma_f32_16x16x32_bf16 a[40:43], a[212:215], v[184:187], a[40:43]
    v_exp_f32 v114, v114
    v_mfma_f32_16x16x32_bf16 a[44:47], a[212:215], v[188:191], a[44:47]
    buffer_load_dwordx4 v22, s[32:35], s69 offen offset:2048 lds
    v_mfma_f32_16x16x32_bf16 a[44:47], a[208:211], v[172:175], a[44:47]
    v_exp_f32 v115, v115
    v_mfma_f32_16x16x32_bf16 a[60:63], a[216:219], v[172:175], a[60:63]
    v_exp_f32 v116, v116
    v_mfma_f32_16x16x32_bf16 a[60:63], a[220:223], v[188:191], a[60:63]
    v_exp_f32 v117, v117
    v_mfma_f32_16x16x32_bf16 a[56:59], a[220:223], v[184:187], a[56:59]
    v_cvt_pk_bf16_f32 v194, v112, v113
    v_cvt_pk_bf16_f32 v195, v114, v115
    v_mfma_f32_16x16x32_bf16 a[56:59], a[216:219], v[168:171], a[56:59]
    v_exp_f32 v118, v118
    v_mfma_f32_16x16x32_bf16 a[52:55], a[216:219], v[164:167], a[52:55]
    v_exp_f32 v119, v119
    v_mfma_f32_16x16x32_bf16 a[52:55], a[220:223], v[180:183], a[52:55]
    v_exp_f32 v120, v120
    v_mfma_f32_16x16x32_bf16 a[48:51], a[220:223], v[176:179], a[48:51]
    buffer_load_dwordx4 v23, s[32:35], s69 offen offset:3072 lds
    v_mfma_f32_16x16x32_bf16 a[48:51], a[216:219], v[160:163], a[48:51]
    s_waitcnt lgkmcnt(0)
    v_mfma_f32_16x16x32_bf16 v[64:67], a[192:195], a[128:131], 0
    ds_read_b64_tr_b16 a[208:209], v248 offset:32768
    v_mfma_f32_16x16x32_bf16 v[64:67], a[196:199], a[132:135], v[64:67]
    ds_read_b64_tr_b16 a[210:211], v248 offset:36864
    v_mfma_f32_16x16x32_bf16 v[64:67], a[200:203], a[136:139], v[64:67]
    ds_read_b64_tr_b16 a[212:213], v248 offset:40960
    v_mfma_f32_16x16x32_bf16 v[64:67], a[204:207], a[140:143], v[64:67]
    ds_read_b64_tr_b16 a[214:215], v248 offset:45056
    v_mfma_f32_16x16x32_bf16 v[68:71], a[204:207], a[156:159], 0
    ds_read_b64_tr_b16 a[216:217], v249 offset:32768
    v_mfma_f32_16x16x32_bf16 v[68:71], a[200:203], a[152:155], v[68:71]
    ds_read_b64_tr_b16 a[218:219], v249 offset:36864
    v_mfma_f32_16x16x32_bf16 v[68:71], a[196:199], a[148:151], v[68:71]
    ds_read_b64_tr_b16 a[220:221], v249 offset:40960
    buffer_load_dword v31, v25, s[20:23], s49 offen
    v_mfma_f32_16x16x32_bf16 v[68:71], a[192:195], a[144:147], v[68:71]
    ds_read_b64_tr_b16 a[222:223], v249 offset:45056
    v_mfma_f32_16x16x32_bf16 v[72:75], a[192:195], a[160:163], 0
    v_exp_f32 v121, v121
    v_mfma_f32_16x16x32_bf16 v[72:75], a[196:199], a[164:167], v[72:75]
    v_cvt_pk_bf16_f32 v198, v116, v117
    v_cvt_pk_bf16_f32 v199, v118, v119
    v_mfma_f32_16x16x32_bf16 v[72:75], a[200:203], a[168:171], v[72:75]
    v_exp_f32 v122, v122
    v_mfma_f32_16x16x32_bf16 v[72:75], a[204:207], a[172:175], v[72:75]
    v_exp_f32 v123, v123
    v_mfma_f32_16x16x32_bf16 v[76:79], a[204:207], a[188:191], 0
    v_exp_f32 v124, v124
    v_mfma_f32_16x16x32_bf16 v[76:79], a[200:203], a[184:187], v[76:79]
    v_exp_f32 v125, v125
    v_mfma_f32_16x16x32_bf16 v[76:79], a[196:199], a[180:183], v[76:79]
    v_cvt_pk_bf16_f32 v202, v120, v121
    v_cvt_pk_bf16_f32 v203, v122, v123
    v_mfma_f32_16x16x32_bf16 v[76:79], a[192:195], a[176:179], v[76:79]
    s_waitcnt lgkmcnt(0)
    v_mfma_f32_16x16x32_bf16 a[64:67], a[208:211], v[160:163], a[64:67]
    ds_read_b128 a[192:195], v240 offset:45056
    v_mfma_f32_16x16x32_bf16 a[64:67], a[212:215], v[176:179], a[64:67]
    ds_read_b128 a[196:199], v241 offset:45056
    v_mfma_f32_16x16x32_bf16 a[68:71], a[212:215], v[180:183], a[68:71]
    ds_read_b128 a[200:203], v242 offset:45056
    v_mfma_f32_16x16x32_bf16 a[68:71], a[208:211], v[164:167], a[68:71]
    ds_read_b128 a[204:207], v243 offset:45056
    v_mfma_f32_16x16x32_bf16 a[72:75], a[208:211], v[168:171], a[72:75]
    v_exp_f32 v126, v126
    v_mfma_f32_16x16x32_bf16 a[72:75], a[212:215], v[184:187], a[72:75]
    v_exp_f32 v127, v127
    v_mfma_f32_16x16x32_bf16 a[76:79], a[212:215], v[188:191], a[76:79]
    v_exp_f32 v128, v128
    v_mfma_f32_16x16x32_bf16 a[76:79], a[208:211], v[172:175], a[76:79]
    v_exp_f32 v129, v129
    v_mfma_f32_16x16x32_bf16 a[92:95], a[216:219], v[172:175], a[92:95]
    v_cvt_pk_bf16_f32 v206, v124, v125
    v_cvt_pk_bf16_f32 v207, v126, v127
    v_mfma_f32_16x16x32_bf16 a[92:95], a[220:223], v[188:191], a[92:95]
    v_exp_f32 v130, v130
    v_mfma_f32_16x16x32_bf16 a[88:91], a[220:223], v[184:187], a[88:91]
    v_exp_f32 v131, v131
    v_mfma_f32_16x16x32_bf16 a[88:91], a[216:219], v[168:171], a[88:91]
    v_exp_f32 v132, v132
    v_mfma_f32_16x16x32_bf16 a[84:87], a[216:219], v[164:167], a[84:87]
    v_exp_f32 v133, v133
    v_mfma_f32_16x16x32_bf16 a[84:87], a[220:223], v[180:183], a[84:87]
    v_cvt_pk_bf16_f32 v208, v128, v129
    v_cvt_pk_bf16_f32 v209, v130, v131
    v_mfma_f32_16x16x32_bf16 a[80:83], a[220:223], v[176:179], a[80:83]
    v_exp_f32 v134, v134
    v_mfma_f32_16x16x32_bf16 a[80:83], a[216:219], v[160:163], a[80:83]
    s_waitcnt lgkmcnt(0)
    v_mfma_f32_16x16x32_bf16 v[92:95], a[192:195], a[176:179], 0
    ds_read_b64_tr_b16 a[208:209], v250 offset:32768
    v_mfma_f32_16x16x32_bf16 v[92:95], a[196:199], a[180:183], v[92:95]
    ds_read_b64_tr_b16 a[210:211], v250 offset:36864
    v_mfma_f32_16x16x32_bf16 v[92:95], a[200:203], a[184:187], v[92:95]
    ds_read_b64_tr_b16 a[212:213], v250 offset:40960
    v_mfma_f32_16x16x32_bf16 v[92:95], a[204:207], a[188:191], v[92:95]
    ds_read_b64_tr_b16 a[214:215], v250 offset:45056
    v_mfma_f32_16x16x32_bf16 v[88:91], a[204:207], a[172:175], 0
    ds_read_b64_tr_b16 a[216:217], v251 offset:32768
    v_mfma_f32_16x16x32_bf16 v[88:91], a[200:203], a[168:171], v[88:91]
    ds_read_b64_tr_b16 a[218:219], v251 offset:36864
    v_mfma_f32_16x16x32_bf16 v[88:91], a[196:199], a[164:167], v[88:91]
    ds_read_b64_tr_b16 a[220:221], v251 offset:40960
    v_mfma_f32_16x16x32_bf16 v[88:91], a[192:195], a[160:163], v[88:91]
    ds_read_b64_tr_b16 a[222:223], v251 offset:45056
    v_mfma_f32_16x16x32_bf16 v[84:87], a[192:195], a[144:147], 0
    v_exp_f32 v135, v135
    v_mfma_f32_16x16x32_bf16 v[84:87], a[196:199], a[148:151], v[84:87]
    v_exp_f32 v136, v136
    v_mfma_f32_16x16x32_bf16 v[84:87], a[200:203], a[152:155], v[84:87]
    v_exp_f32 v137, v137
    v_mfma_f32_16x16x32_bf16 v[84:87], a[204:207], a[156:159], v[84:87]
    v_cvt_pk_bf16_f32 v212, v132, v133
    v_cvt_pk_bf16_f32 v213, v134, v135
    v_mfma_f32_16x16x32_bf16 v[80:83], a[204:207], a[140:143], 0
    v_exp_f32 v138, v138
    v_mfma_f32_16x16x32_bf16 v[80:83], a[200:203], a[136:139], v[80:83]
    v_exp_f32 v139, v139
    v_mfma_f32_16x16x32_bf16 v[80:83], a[196:199], a[132:135], v[80:83]
    v_exp_f32 v140, v140
    v_mfma_f32_16x16x32_bf16 v[80:83], a[192:195], a[128:131], v[80:83]
    s_waitcnt vmcnt(9) lgkmcnt(0)
    s_barrier
    v_mfma_f32_16x16x32_bf16 a[96:99], a[208:211], v[160:163], a[96:99]
    ds_read_b128 a[192:195], v240 offset:49152
    v_mfma_f32_16x16x32_bf16 a[96:99], a[212:215], v[176:179], a[96:99]
    ds_read_b128 a[196:199], v241 offset:49152
    v_mfma_f32_16x16x32_bf16 a[100:103], a[212:215], v[180:183], a[100:103]
    ds_read_b128 a[200:203], v242 offset:49152
    v_mfma_f32_16x16x32_bf16 a[100:103], a[208:211], v[164:167], a[100:103]
    ds_read_b128 a[204:207], v243 offset:49152
    v_mfma_f32_16x16x32_bf16 a[104:107], a[208:211], v[168:171], a[104:107]
    s_add_u32 s68, s68, 16384
    s_add_u32 s69, s69, 16384
    v_mfma_f32_16x16x32_bf16 a[104:107], a[212:215], v[184:187], a[104:107]
    s_add_u32 s70, s70, 16384
    s_and_b32 s70, s70, 0xffff
    v_mfma_f32_16x16x32_bf16 a[108:111], a[212:215], v[188:191], a[108:111]
    s_add_u32 s71, s71, 16384
    s_and_b32 s71, s71, 0xffff
    v_mfma_f32_16x16x32_bf16 a[108:111], a[208:211], v[172:175], a[108:111]
    s_add_u32 s49, s49, 32768
    v_mfma_f32_16x16x32_bf16 a[124:127], a[216:219], v[172:175], a[124:127]
    buffer_store_dwordx2 v[26:27], v24, s[12:15], 0 offen sc1
    v_mfma_f32_16x16x32_bf16 a[124:127], a[220:223], v[188:191], a[124:127]
    s_nop 0
    v_mov_b32 v24, 2130706432
    v_mfma_f32_16x16x32_bf16 a[120:123], a[220:223], v[184:187], a[120:123]
    v_exp_f32 v141, v141
    v_mfma_f32_16x16x32_bf16 a[120:123], a[216:219], v[168:171], a[120:123]
    v_cvt_pk_bf16_f32 v216, v136, v137
    v_cvt_pk_bf16_f32 v217, v138, v139
    v_mfma_f32_16x16x32_bf16 a[116:119], a[216:219], v[164:167], a[116:119]
    v_exp_f32 v142, v142
    v_mfma_f32_16x16x32_bf16 a[116:119], a[220:223], v[180:183], a[116:119]
    v_exp_f32 v143, v143
    v_mfma_f32_16x16x32_bf16 a[112:115], a[220:223], v[176:179], a[112:115]
    v_exp_f32 v144, v144
    v_mfma_f32_16x16x32_bf16 a[112:115], a[216:219], v[160:163], a[112:115]
    v_exp_f32 v145, v145
    v_mfma_f32_16x16x32_bf16 a[224:227], a[240:243], v[160:163], a[224:227]
    v_cvt_pk_bf16_f32 v220, v140, v141
    v_cvt_pk_bf16_f32 v221, v142, v143
    v_mfma_f32_16x16x32_bf16 a[224:227], a[240:243], v[176:179], a[224:227]
    v_exp_f32 v146, v146
    v_mfma_f32_16x16x32_bf16 a[228:231], a[240:243], v[164:167], a[228:231]
    v_exp_f32 v147, v147
    v_mfma_f32_16x16x32_bf16 a[228:231], a[240:243], v[180:183], a[228:231]
    v_exp_f32 v148, v148
    v_mfma_f32_16x16x32_bf16 a[232:235], a[240:243], v[168:171], a[232:235]
    v_exp_f32 v149, v149
    v_mfma_f32_16x16x32_bf16 a[232:235], a[240:243], v[184:187], a[232:235]
    v_cvt_pk_bf16_f32 v210, v144, v145
    v_cvt_pk_bf16_f32 v211, v146, v147
    v_mfma_f32_16x16x32_bf16 a[236:239], a[240:243], v[172:175], a[236:239]
    v_exp_f32 v150, v150
    v_mfma_f32_16x16x32_bf16 a[236:239], a[240:243], v[188:191], a[236:239]
    v_exp_f32 v151, v151
    v_exp_f32 v152, v152
    v_exp_f32 v153, v153
    v_cvt_pk_bf16_f32 v214, v148, v149
    v_cvt_pk_bf16_f32 v215, v150, v151
    v_exp_f32 v154, v154
    v_exp_f32 v155, v155
    v_exp_f32 v156, v156
    v_exp_f32 v157, v157
    v_cvt_pk_bf16_f32 v218, v152, v153
    v_cvt_pk_bf16_f32 v219, v154, v155
    v_exp_f32 v158, v158
    v_exp_f32 v159, v159
    s_nop 0
    v_cvt_pk_bf16_f32 v222, v156, v157
    v_cvt_pk_bf16_f32 v223, v158, v159
    s_waitcnt lgkmcnt(0)
    v_mfma_f32_16x16x32_bf16 v[96:99], a[192:195], a[128:131], 0
    ds_read_b64_tr_b16 a[208:209], v244 offset:49152
    v_mfma_f32_16x16x32_bf16 v[96:99], a[196:199], a[132:135], v[96:99]
    ds_read_b64_tr_b16 a[210:211], v244 offset:53248
    v_mfma_f32_16x16x32_bf16 v[96:99], a[200:203], a[136:139], v[96:99]
    ds_read_b64_tr_b16 a[212:213], v244 offset:57344
    v_mfma_f32_16x16x32_bf16 v[96:99], a[204:207], a[140:143], v[96:99]
    ds_read_b64_tr_b16 a[214:215], v244 offset:61440
    v_mfma_f32_16x16x32_bf16 v[100:103], a[204:207], a[156:159], 0
    ds_read_b64_tr_b16 a[216:217], v245 offset:49152
    v_mfma_f32_16x16x32_bf16 v[100:103], a[200:203], a[152:155], v[100:103]
    ds_read_b64_tr_b16 a[218:219], v245 offset:53248
    s_add_u32 m0, s70, s72
    v_mfma_f32_16x16x32_bf16 v[100:103], a[196:199], a[148:151], v[100:103]
    ds_read_b64_tr_b16 a[220:221], v245 offset:57344
    buffer_load_dwordx4 v18, s[28:31], s68 offen offset:0 lds
    v_mfma_f32_16x16x32_bf16 v[100:103], a[192:195], a[144:147], v[100:103]
    ds_read_b64_tr_b16 a[222:223], v245 offset:61440
    v_mfma_f32_16x16x32_bf16 v[104:107], a[192:195], a[160:163], 0
    v_exp_f32 v32, v32
    v_mfma_f32_16x16x32_bf16 v[104:107], a[196:199], a[164:167], v[104:107]
    v_exp_f32 v33, v33
    v_mfma_f32_16x16x32_bf16 v[104:107], a[200:203], a[168:171], v[104:107]
    v_exp_f32 v34, v34
    v_mfma_f32_16x16x32_bf16 v[104:107], a[204:207], a[172:175], v[104:107]
    v_exp_f32 v35, v35
    v_mfma_f32_16x16x32_bf16 v[108:111], a[204:207], a[188:191], 0
    v_exp_f32 v36, v36
    v_mfma_f32_16x16x32_bf16 v[108:111], a[200:203], a[184:187], v[108:111]
    v_exp_f32 v37, v37
    v_mfma_f32_16x16x32_bf16 v[108:111], a[196:199], a[180:183], v[108:111]
    buffer_load_dwordx4 v19, s[28:31], s68 offen offset:1024 lds
    v_mfma_f32_16x16x32_bf16 v[108:111], a[192:195], a[176:179], v[108:111]
    s_waitcnt lgkmcnt(0)
    v_cvt_pk_bf16_f32 v160, v32, v33
    v_mfma_f32_16x16x32_bf16 a[0:3], a[208:211], v[192:195], a[0:3]
    ds_read_b128 a[192:195], v240 offset:53248
    v_mfma_f32_16x16x32_bf16 a[0:3], a[212:215], v[208:211], a[0:3]
    ds_read_b128 a[196:199], v241 offset:53248
    v_mfma_f32_16x16x32_bf16 a[4:7], a[212:215], v[212:215], a[4:7]
    ds_read_b128 a[200:203], v242 offset:53248
    v_mfma_f32_16x16x32_bf16 a[4:7], a[208:211], v[196:199], a[4:7]
    ds_read_b128 a[204:207], v243 offset:53248
    v_mfma_f32_16x16x32_bf16 a[8:11], a[208:211], v[200:203], a[8:11]
    v_cvt_pk_bf16_f32 v161, v34, v35
    v_mfma_f32_16x16x32_bf16 a[8:11], a[212:215], v[216:219], a[8:11]
    v_exp_f32 v38, v38
    v_mfma_f32_16x16x32_bf16 a[12:15], a[212:215], v[220:223], a[12:15]
    buffer_load_dwordx4 v20, s[28:31], s68 offen offset:2048 lds
    v_mfma_f32_16x16x32_bf16 a[12:15], a[208:211], v[204:207], a[12:15]
    v_exp_f32 v39, v39
    v_mfma_f32_16x16x32_bf16 a[28:31], a[216:219], v[204:207], a[28:31]
    v_exp_f32 v40, v40
    v_mfma_f32_16x16x32_bf16 a[28:31], a[220:223], v[220:223], a[28:31]
    v_exp_f32 v41, v41
    v_mfma_f32_16x16x32_bf16 a[24:27], a[220:223], v[216:219], a[24:27]
    v_cvt_pk_bf16_f32 v164, v36, v37
    v_cvt_pk_bf16_f32 v165, v38, v39
    v_mfma_f32_16x16x32_bf16 a[24:27], a[216:219], v[200:203], a[24:27]
    v_exp_f32 v42, v42
    v_mfma_f32_16x16x32_bf16 a[20:23], a[216:219], v[196:199], a[20:23]
    v_exp_f32 v43, v43
    v_mfma_f32_16x16x32_bf16 a[20:23], a[220:223], v[212:215], a[20:23]
    v_exp_f32 v44, v44
    v_mfma_f32_16x16x32_bf16 a[16:19], a[220:223], v[208:211], a[16:19]
    buffer_load_dwordx4 v21, s[28:31], s68 offen offset:3072 lds
    v_mfma_f32_16x16x32_bf16 a[16:19], a[216:219], v[192:195], a[16:19]
    s_waitcnt lgkmcnt(0)
    v_mfma_f32_16x16x32_bf16 v[124:127], a[192:195], a[176:179], 0
    ds_read_b64_tr_b16 a[208:209], v246 offset:49152
    v_mfma_f32_16x16x32_bf16 v[124:127], a[196:199], a[180:183], v[124:127]
    ds_read_b64_tr_b16 a[210:211], v246 offset:53248
    v_mfma_f32_16x16x32_bf16 v[124:127], a[200:203], a[184:187], v[124:127]
    ds_read_b64_tr_b16 a[212:213], v246 offset:57344
    v_mfma_f32_16x16x32_bf16 v[124:127], a[204:207], a[188:191], v[124:127]
    ds_read_b64_tr_b16 a[214:215], v246 offset:61440
    v_mfma_f32_16x16x32_bf16 v[120:123], a[204:207], a[172:175], 0
    ds_read_b64_tr_b16 a[216:217], v247 offset:49152
    v_mfma_f32_16x16x32_bf16 v[120:123], a[200:203], a[168:171], v[120:123]
    ds_read_b64_tr_b16 a[218:219], v247 offset:53248
    s_add_u32 m0, s71, s73
    v_mfma_f32_16x16x32_bf16 v[120:123], a[196:199], a[164:167], v[120:123]
    ds_read_b64_tr_b16 a[220:221], v247 offset:57344
    buffer_load_dwordx4 v22, s[32:35], s69 offen offset:0 lds
    v_mfma_f32_16x16x32_bf16 v[120:123], a[192:195], a[160:163], v[120:123]
    ds_read_b64_tr_b16 a[222:223], v247 offset:61440
    v_mfma_f32_16x16x32_bf16 v[116:119], a[192:195], a[144:147], 0
    v_exp_f32 v45, v45
    v_mfma_f32_16x16x32_bf16 v[116:119], a[196:199], a[148:151], v[116:119]
    v_cvt_pk_bf16_f32 v168, v40, v41
    v_cvt_pk_bf16_f32 v169, v42, v43
    v_mfma_f32_16x16x32_bf16 v[116:119], a[200:203], a[152:155], v[116:119]
    v_exp_f32 v46, v46
    v_mfma_f32_16x16x32_bf16 v[116:119], a[204:207], a[156:159], v[116:119]
    v_exp_f32 v47, v47
    v_mfma_f32_16x16x32_bf16 v[112:115], a[204:207], a[140:143], 0
    v_exp_f32 v48, v48
    v_mfma_f32_16x16x32_bf16 v[112:115], a[200:203], a[136:139], v[112:115]
    v_exp_f32 v49, v49
    v_mfma_f32_16x16x32_bf16 v[112:115], a[196:199], a[132:135], v[112:115]
    buffer_load_dwordx4 v23, s[32:35], s69 offen offset:1024 lds
    v_mfma_f32_16x16x32_bf16 v[112:115], a[192:195], a[128:131], v[112:115]
    s_waitcnt lgkmcnt(0)
    v_cvt_pk_bf16_f32 v172, v44, v45
    v_mfma_f32_16x16x32_bf16 a[32:35], a[208:211], v[192:195], a[32:35]
    ds_read_b128 a[192:195], v240 offset:57344
    v_mfma_f32_16x16x32_bf16 a[32:35], a[212:215], v[208:211], a[32:35]
    ds_read_b128 a[196:199], v241 offset:57344
    v_mfma_f32_16x16x32_bf16 a[36:39], a[212:215], v[212:215], a[36:39]
    ds_read_b128 a[200:203], v242 offset:57344
    v_mfma_f32_16x16x32_bf16 a[36:39], a[208:211], v[196:199], a[36:39]
    ds_read_b128 a[204:207], v243 offset:57344
    v_mfma_f32_16x16x32_bf16 a[40:43], a[208:211], v[200:203], a[40:43]
    v_cvt_pk_bf16_f32 v173, v46, v47
    v_mfma_f32_16x16x32_bf16 a[40:43], a[212:215], v[216:219], a[40:43]
    v_exp_f32 v50, v50
    v_mfma_f32_16x16x32_bf16 a[44:47], a[212:215], v[220:223], a[44:47]
    buffer_load_dwordx4 v22, s[32:35], s69 offen offset:2048 lds
    v_mfma_f32_16x16x32_bf16 a[44:47], a[208:211], v[204:207], a[44:47]
    v_exp_f32 v51, v51
    v_mfma_f32_16x16x32_bf16 a[60:63], a[216:219], v[204:207], a[60:63]
    v_exp_f32 v52, v52
    v_mfma_f32_16x16x32_bf16 a[60:63], a[220:223], v[220:223], a[60:63]
    v_exp_f32 v53, v53
    v_mfma_f32_16x16x32_bf16 a[56:59], a[220:223], v[216:219], a[56:59]
    v_cvt_pk_bf16_f32 v162, v48, v49
    v_cvt_pk_bf16_f32 v163, v50, v51
    v_mfma_f32_16x16x32_bf16 a[56:59], a[216:219], v[200:203], a[56:59]
    v_exp_f32 v54, v54
    v_mfma_f32_16x16x32_bf16 a[52:55], a[216:219], v[196:199], a[52:55]
    v_exp_f32 v55, v55
    v_mfma_f32_16x16x32_bf16 a[52:55], a[220:223], v[212:215], a[52:55]
    v_exp_f32 v56, v56
    v_mfma_f32_16x16x32_bf16 a[48:51], a[220:223], v[208:211], a[48:51]
    buffer_load_dwordx4 v23, s[32:35], s69 offen offset:3072 lds
    v_mfma_f32_16x16x32_bf16 a[48:51], a[216:219], v[192:195], a[48:51]
    s_waitcnt lgkmcnt(0)
    v_mfma_f32_16x16x32_bf16 v[128:131], a[192:195], a[128:131], 0
    ds_read_b64_tr_b16 a[208:209], v248 offset:49152
    v_mfma_f32_16x16x32_bf16 v[128:131], a[196:199], a[132:135], v[128:131]
    ds_read_b64_tr_b16 a[210:211], v248 offset:53248
    v_mfma_f32_16x16x32_bf16 v[128:131], a[200:203], a[136:139], v[128:131]
    ds_read_b64_tr_b16 a[212:213], v248 offset:57344
    v_mfma_f32_16x16x32_bf16 v[128:131], a[204:207], a[140:143], v[128:131]
    ds_read_b64_tr_b16 a[214:215], v248 offset:61440
    v_mfma_f32_16x16x32_bf16 v[132:135], a[204:207], a[156:159], 0
    ds_read_b64_tr_b16 a[216:217], v249 offset:49152
    v_mfma_f32_16x16x32_bf16 v[132:135], a[200:203], a[152:155], v[132:135]
    ds_read_b64_tr_b16 a[218:219], v249 offset:53248
    v_mfma_f32_16x16x32_bf16 v[132:135], a[196:199], a[148:151], v[132:135]
    ds_read_b64_tr_b16 a[220:221], v249 offset:57344
    buffer_load_dword v31, v25, s[20:23], s49 offen
    v_mfma_f32_16x16x32_bf16 v[132:135], a[192:195], a[144:147], v[132:135]
    ds_read_b64_tr_b16 a[222:223], v249 offset:61440
    v_mfma_f32_16x16x32_bf16 v[136:139], a[192:195], a[160:163], 0
    v_exp_f32 v57, v57
    v_mfma_f32_16x16x32_bf16 v[136:139], a[196:199], a[164:167], v[136:139]
    v_cvt_pk_bf16_f32 v166, v52, v53
    v_cvt_pk_bf16_f32 v167, v54, v55
    v_mfma_f32_16x16x32_bf16 v[136:139], a[200:203], a[168:171], v[136:139]
    v_exp_f32 v58, v58
    v_mfma_f32_16x16x32_bf16 v[136:139], a[204:207], a[172:175], v[136:139]
    v_exp_f32 v59, v59
    v_mfma_f32_16x16x32_bf16 v[140:143], a[204:207], a[188:191], 0
    v_exp_f32 v60, v60
    v_mfma_f32_16x16x32_bf16 v[140:143], a[200:203], a[184:187], v[140:143]
    v_exp_f32 v61, v61
    v_mfma_f32_16x16x32_bf16 v[140:143], a[196:199], a[180:183], v[140:143]
    v_cvt_pk_bf16_f32 v170, v56, v57
    v_cvt_pk_bf16_f32 v171, v58, v59
    v_mfma_f32_16x16x32_bf16 v[140:143], a[192:195], a[176:179], v[140:143]
    s_waitcnt lgkmcnt(0)
    v_mfma_f32_16x16x32_bf16 a[64:67], a[208:211], v[192:195], a[64:67]
    ds_read_b128 a[192:195], v240 offset:61440
    v_mfma_f32_16x16x32_bf16 a[64:67], a[212:215], v[208:211], a[64:67]
    ds_read_b128 a[196:199], v241 offset:61440
    v_mfma_f32_16x16x32_bf16 a[68:71], a[212:215], v[212:215], a[68:71]
    ds_read_b128 a[200:203], v242 offset:61440
    v_mfma_f32_16x16x32_bf16 a[68:71], a[208:211], v[196:199], a[68:71]
    ds_read_b128 a[204:207], v243 offset:61440
    v_mfma_f32_16x16x32_bf16 a[72:75], a[208:211], v[200:203], a[72:75]
    v_exp_f32 v62, v62
    v_mfma_f32_16x16x32_bf16 a[72:75], a[212:215], v[216:219], a[72:75]
    v_exp_f32 v63, v63
    v_mfma_f32_16x16x32_bf16 a[76:79], a[212:215], v[220:223], a[76:79]
    v_exp_f32 v64, v64
    v_mfma_f32_16x16x32_bf16 a[76:79], a[208:211], v[204:207], a[76:79]
    v_exp_f32 v65, v65
    v_mfma_f32_16x16x32_bf16 a[92:95], a[216:219], v[204:207], a[92:95]
    v_cvt_pk_bf16_f32 v174, v60, v61
    v_cvt_pk_bf16_f32 v175, v62, v63
    v_mfma_f32_16x16x32_bf16 a[92:95], a[220:223], v[220:223], a[92:95]
    v_exp_f32 v66, v66
    v_mfma_f32_16x16x32_bf16 a[88:91], a[220:223], v[216:219], a[88:91]
    v_exp_f32 v67, v67
    v_mfma_f32_16x16x32_bf16 a[88:91], a[216:219], v[200:203], a[88:91]
    v_exp_f32 v68, v68
    v_mfma_f32_16x16x32_bf16 a[84:87], a[216:219], v[196:199], a[84:87]
    v_exp_f32 v69, v69
    v_mfma_f32_16x16x32_bf16 a[84:87], a[220:223], v[212:215], a[84:87]
    v_cvt_pk_bf16_f32 v176, v64, v65
    v_cvt_pk_bf16_f32 v177, v66, v67
    v_mfma_f32_16x16x32_bf16 a[80:83], a[220:223], v[208:211], a[80:83]
    v_exp_f32 v70, v70
    v_mfma_f32_16x16x32_bf16 a[80:83], a[216:219], v[192:195], a[80:83]
    s_waitcnt lgkmcnt(0)
    v_mfma_f32_16x16x32_bf16 v[156:159], a[192:195], a[176:179], 0
    ds_read_b64_tr_b16 a[208:209], v250 offset:49152
    v_mfma_f32_16x16x32_bf16 v[156:159], a[196:199], a[180:183], v[156:159]
    ds_read_b64_tr_b16 a[210:211], v250 offset:53248
    v_mfma_f32_16x16x32_bf16 v[156:159], a[200:203], a[184:187], v[156:159]
    ds_read_b64_tr_b16 a[212:213], v250 offset:57344
    v_mfma_f32_16x16x32_bf16 v[156:159], a[204:207], a[188:191], v[156:159]
    ds_read_b64_tr_b16 a[214:215], v250 offset:61440
    v_mfma_f32_16x16x32_bf16 v[152:155], a[204:207], a[172:175], 0
    ds_read_b64_tr_b16 a[216:217], v251 offset:49152
    v_mfma_f32_16x16x32_bf16 v[152:155], a[200:203], a[168:171], v[152:155]
    ds_read_b64_tr_b16 a[218:219], v251 offset:53248
    v_mfma_f32_16x16x32_bf16 v[152:155], a[196:199], a[164:167], v[152:155]
    ds_read_b64_tr_b16 a[220:221], v251 offset:57344
    v_mfma_f32_16x16x32_bf16 v[152:155], a[192:195], a[160:163], v[152:155]
    ds_read_b64_tr_b16 a[222:223], v251 offset:61440
    v_mfma_f32_16x16x32_bf16 v[148:151], a[192:195], a[144:147], 0
    v_exp_f32 v71, v71
    v_mfma_f32_16x16x32_bf16 v[148:151], a[196:199], a[148:151], v[148:151]
    v_exp_f32 v72, v72
    v_mfma_f32_16x16x32_bf16 v[148:151], a[200:203], a[152:155], v[148:151]
    v_exp_f32 v73, v73
    v_mfma_f32_16x16x32_bf16 v[148:151], a[204:207], a[156:159], v[148:151]
    v_cvt_pk_bf16_f32 v180, v68, v69
    v_cvt_pk_bf16_f32 v181, v70, v71
    v_mfma_f32_16x16x32_bf16 v[144:147], a[204:207], a[140:143], 0
    v_exp_f32 v74, v74
    v_mfma_f32_16x16x32_bf16 v[144:147], a[200:203], a[136:139], v[144:147]
    v_exp_f32 v75, v75
    v_mfma_f32_16x16x32_bf16 v[144:147], a[196:199], a[132:135], v[144:147]
    v_exp_f32 v76, v76
    v_mfma_f32_16x16x32_bf16 v[144:147], a[192:195], a[128:131], v[144:147]
    s_waitcnt vmcnt(9) lgkmcnt(0)
    s_barrier
    v_mfma_f32_16x16x32_bf16 a[96:99], a[208:211], v[192:195], a[96:99]
    v_xor_b32 v240, 0x8000, v240
    v_xor_b32 v241, 0x8000, v241
    v_mfma_f32_16x16x32_bf16 a[96:99], a[212:215], v[208:211], a[96:99]
    v_xor_b32 v242, 0x8000, v242
    v_xor_b32 v243, 0x8000, v243
    v_mfma_f32_16x16x32_bf16 a[100:103], a[212:215], v[212:215], a[100:103]
    ds_read_b128 a[192:195], v240 offset:32768
    v_mfma_f32_16x16x32_bf16 a[100:103], a[208:211], v[196:199], a[100:103]
    ds_read_b128 a[196:199], v241 offset:32768
    v_mfma_f32_16x16x32_bf16 a[104:107], a[208:211], v[200:203], a[104:107]
    ds_read_b128 a[200:203], v242 offset:32768
    v_mfma_f32_16x16x32_bf16 a[104:107], a[212:215], v[216:219], a[104:107]
    ds_read_b128 a[204:207], v243 offset:32768
    v_mfma_f32_16x16x32_bf16 a[108:111], a[212:215], v[220:223], a[108:111]
    v_xor_b32 v244, 0x8000, v244
    v_xor_b32 v245, 0x8000, v245
    v_mfma_f32_16x16x32_bf16 a[108:111], a[208:211], v[204:207], a[108:111]
    v_xor_b32 v246, 0x8000, v246
    v_xor_b32 v247, 0x8000, v247
    v_mfma_f32_16x16x32_bf16 a[124:127], a[216:219], v[204:207], a[124:127]
    v_xor_b32 v248, 0x8000, v248
    v_xor_b32 v249, 0x8000, v249
    v_mfma_f32_16x16x32_bf16 a[124:127], a[220:223], v[220:223], a[124:127]
    v_xor_b32 v250, 0x8000, v250
    v_xor_b32 v251, 0x8000, v251
    v_mfma_f32_16x16x32_bf16 a[120:123], a[220:223], v[216:219], a[120:123]
    s_add_u32 s68, s68, 16384
    s_add_u32 s69, s69, 16384
    v_mfma_f32_16x16x32_bf16 a[120:123], a[216:219], v[200:203], a[120:123]
    s_add_u32 s70, s70, 16384
    s_and_b32 s70, s70, 0xffff
    v_mfma_f32_16x16x32_bf16 a[116:119], a[216:219], v[196:199], a[116:119]
    s_add_u32 s71, s71, 16384
    s_and_b32 s71, s71, 0xffff
    v_mfma_f32_16x16x32_bf16 a[116:119], a[220:223], v[212:215], a[116:119]
    s_add_u32 s49, s49, 98304
    s_sub_u32 s52, s52, 1
    v_mfma_f32_16x16x32_bf16 a[112:115], a[220:223], v[208:211], a[112:115]
    s_cmp_lg_u32 s52, 0
    v_mfma_f32_16x16x32_bf16 a[112:115], a[216:219], v[192:195], a[112:115]
    v_exp_f32 v77, v77
    v_mfma_f32_16x16x32_bf16 a[224:227], a[240:243], v[192:195], a[224:227]
    v_cvt_pk_bf16_f32 v184, v72, v73
    v_cvt_pk_bf16_f32 v185, v74, v75
    v_mfma_f32_16x16x32_bf16 a[224:227], a[240:243], v[208:211], a[224:227]
    v_exp_f32 v78, v78
    v_mfma_f32_16x16x32_bf16 a[228:231], a[240:243], v[196:199], a[228:231]
    v_exp_f32 v79, v79
    v_mfma_f32_16x16x32_bf16 a[228:231], a[240:243], v[212:215], a[228:231]
    v_exp_f32 v80, v80
    v_mfma_f32_16x16x32_bf16 a[232:235], a[240:243], v[200:203], a[232:235]
    v_exp_f32 v81, v81
    v_mfma_f32_16x16x32_bf16 a[232:235], a[240:243], v[216:219], a[232:235]
    v_cvt_pk_bf16_f32 v188, v76, v77
    v_cvt_pk_bf16_f32 v189, v78, v79
    v_mfma_f32_16x16x32_bf16 a[236:239], a[240:243], v[204:207], a[236:239]
    v_exp_f32 v82, v82
    v_mfma_f32_16x16x32_bf16 a[236:239], a[240:243], v[220:223], a[236:239]
    v_exp_f32 v83, v83
    v_exp_f32 v84, v84
    v_exp_f32 v85, v85
    v_cvt_pk_bf16_f32 v178, v80, v81
    v_cvt_pk_bf16_f32 v179, v82, v83
    v_exp_f32 v86, v86
    v_exp_f32 v87, v87
    v_exp_f32 v88, v88
    v_exp_f32 v89, v89
    v_cvt_pk_bf16_f32 v182, v84, v85
    v_cvt_pk_bf16_f32 v183, v86, v87
    v_exp_f32 v90, v90
    v_exp_f32 v91, v91
    v_exp_f32 v92, v92
    v_exp_f32 v93, v93
    v_cvt_pk_bf16_f32 v186, v88, v89
    v_cvt_pk_bf16_f32 v187, v90, v91
    v_exp_f32 v94, v94
    v_exp_f32 v95, v95
    s_nop 0
    v_cvt_pk_bf16_f32 v190, v92, v93
    v_cvt_pk_bf16_f32 v191, v94, v95
    s_waitcnt lgkmcnt(0)
    s_cbranch_scc1 L_att_loop
    buffer_load_dwordx4 v[18:21], v1, s[12:15], 0 offen offset:256 sc1
    buffer_load_dwordx4 v[28:31], v1, s[12:15], 0 offen offset:1280 sc1
    v_mfma_f32_16x16x32_bf16 v[32:35], a[192:195], a[128:131], 0
    ds_read_b64_tr_b16 a[208:209], v244 offset:32768
    v_mfma_f32_16x16x32_bf16 v[32:35], a[196:199], a[132:135], v[32:35]
    ds_read_b64_tr_b16 a[210:211], v244 offset:36864
    v_mfma_f32_16x16x32_bf16 v[32:35], a[200:203], a[136:139], v[32:35]
    ds_read_b64_tr_b16 a[212:213], v244 offset:40960
    v_mfma_f32_16x16x32_bf16 v[32:35], a[204:207], a[140:143], v[32:35]
    ds_read_b64_tr_b16 a[214:215], v244 offset:45056
    v_mfma_f32_16x16x32_bf16 v[36:39], a[204:207], a[156:159], 0
    ds_read_b64_tr_b16 a[216:217], v245 offset:32768
    v_mfma_f32_16x16x32_bf16 v[36:39], a[200:203], a[152:155], v[36:39]
    ds_read_b64_tr_b16 a[218:219], v245 offset:36864
    s_add_u32 m0, s71, s73
    v_mfma_f32_16x16x32_bf16 v[36:39], a[196:199], a[148:151], v[36:39]
    ds_read_b64_tr_b16 a[220:221], v245 offset:40960
    buffer_load_dwordx4 v22, s[32:35], s69 offen offset:0 lds
    v_mfma_f32_16x16x32_bf16 v[36:39], a[192:195], a[144:147], v[36:39]
    ds_read_b64_tr_b16 a[222:223], v245 offset:45056
    v_mfma_f32_16x16x32_bf16 v[40:43], a[192:195], a[160:163], 0
    v_exp_f32 v96, v96
    v_mfma_f32_16x16x32_bf16 v[40:43], a[196:199], a[164:167], v[40:43]
    v_exp_f32 v97, v97
    v_mfma_f32_16x16x32_bf16 v[40:43], a[200:203], a[168:171], v[40:43]
    v_exp_f32 v98, v98
    v_mfma_f32_16x16x32_bf16 v[40:43], a[204:207], a[172:175], v[40:43]
    v_exp_f32 v99, v99
    v_mfma_f32_16x16x32_bf16 v[44:47], a[204:207], a[188:191], 0
    v_exp_f32 v100, v100
    v_mfma_f32_16x16x32_bf16 v[44:47], a[200:203], a[184:187], v[44:47]
    v_exp_f32 v101, v101
    v_mfma_f32_16x16x32_bf16 v[44:47], a[196:199], a[180:183], v[44:47]
    buffer_load_dwordx4 v23, s[32:35], s69 offen offset:1024 lds
    v_mfma_f32_16x16x32_bf16 v[44:47], a[192:195], a[176:179], v[44:47]
    s_waitcnt lgkmcnt(0)
    v_cvt_pk_bf16_f32 v192, v96, v97
    v_mfma_f32_16x16x32_bf16 a[0:3], a[208:211], v[160:163], a[0:3]
    ds_read_b128 a[192:195], v240 offset:36864
    v_mfma_f32_16x16x32_bf16 a[0:3], a[212:215], v[176:179], a[0:3]
    ds_read_b128 a[196:199], v241 offset:36864
    v_mfma_f32_16x16x32_bf16 a[4:7], a[212:215], v[180:183], a[4:7]
    ds_read_b128 a[200:203], v242 offset:36864
    v_mfma_f32_16x16x32_bf16 a[4:7], a[208:211], v[164:167], a[4:7]
    ds_read_b128 a[204:207], v243 offset:36864
    v_mfma_f32_16x16x32_bf16 a[8:11], a[208:211], v[168:171], a[8:11]
    v_cvt_pk_bf16_f32 v193, v98, v99
    v_mfma_f32_16x16x32_bf16 a[8:11], a[212:215], v[184:187], a[8:11]
    v_exp_f32 v102, v102
    v_mfma_f32_16x16x32_bf16 a[12:15], a[212:215], v[188:191], a[12:15]
    buffer_load_dwordx4 v22, s[32:35], s69 offen offset:2048 lds
    v_mfma_f32_16x16x32_bf16 a[12:15], a[208:211], v[172:175], a[12:15]
    v_exp_f32 v103, v103
    v_mfma_f32_16x16x32_bf16 a[28:31], a[216:219], v[172:175], a[28:31]
    v_exp_f32 v104, v104
    v_mfma_f32_16x16x32_bf16 a[28:31], a[220:223], v[188:191], a[28:31]
    v_exp_f32 v105, v105
    v_mfma_f32_16x16x32_bf16 a[24:27], a[220:223], v[184:187], a[24:27]
    v_cvt_pk_bf16_f32 v196, v100, v101
    v_cvt_pk_bf16_f32 v197, v102, v103
    v_mfma_f32_16x16x32_bf16 a[24:27], a[216:219], v[168:171], a[24:27]
    v_exp_f32 v106, v106
    v_mfma_f32_16x16x32_bf16 a[20:23], a[216:219], v[164:167], a[20:23]
    v_exp_f32 v107, v107
    v_mfma_f32_16x16x32_bf16 a[20:23], a[220:223], v[180:183], a[20:23]
    v_exp_f32 v108, v108
    v_mfma_f32_16x16x32_bf16 a[16:19], a[220:223], v[176:179], a[16:19]
    buffer_load_dwordx4 v23, s[32:35], s69 offen offset:3072 lds
    v_mfma_f32_16x16x32_bf16 a[16:19], a[216:219], v[160:163], a[16:19]
    s_waitcnt lgkmcnt(0)
    v_mfma_f32_16x16x32_bf16 v[60:63], a[192:195], a[176:179], 0
    ds_read_b64_tr_b16 a[208:209], v246 offset:32768
    v_mfma_f32_16x16x32_bf16 v[60:63], a[196:199], a[180:183], v[60:63]
    ds_read_b64_tr_b16 a[210:211], v246 offset:36864
    v_mfma_f32_16x16x32_bf16 v[60:63], a[200:203], a[184:187], v[60:63]
    ds_read_b64_tr_b16 a[212:213], v246 offset:40960
    v_mfma_f32_16x16x32_bf16 v[60:63], a[204:207], a[188:191], v[60:63]
    ds_read_b64_tr_b16 a[214:215], v246 offset:45056
    v_mfma_f32_16x16x32_bf16 v[56:59], a[204:207], a[172:175], 0
    ds_read_b64_tr_b16 a[216:217], v247 offset:32768
    v_mfma_f32_16x16x32_bf16 v[56:59], a[200:203], a[168:171], v[56:59]
    ds_read_b64_tr_b16 a[218:219], v247 offset:36864
    v_mfma_f32_16x16x32_bf16 v[56:59], a[196:199], a[164:167], v[56:59]
    ds_read_b64_tr_b16 a[220:221], v247 offset:40960
    s_nop 0
    v_mfma_f32_16x16x32_bf16 v[56:59], a[192:195], a[160:163], v[56:59]
    ds_read_b64_tr_b16 a[222:223], v247 offset:45056
    v_mfma_f32_16x16x32_bf16 v[52:55], a[192:195], a[144:147], 0
    v_exp_f32 v109, v109
    v_mfma_f32_16x16x32_bf16 v[52:55], a[196:199], a[148:151], v[52:55]
    v_cvt_pk_bf16_f32 v200, v104, v105
    v_cvt_pk_bf16_f32 v201, v106, v107
    v_mfma_f32_16x16x32_bf16 v[52:55], a[200:203], a[152:155], v[52:55]
    v_exp_f32 v110, v110
    v_mfma_f32_16x16x32_bf16 v[52:55], a[204:207], a[156:159], v[52:55]
    v_exp_f32 v111, v111
    v_mfma_f32_16x16x32_bf16 v[48:51], a[204:207], a[140:143], 0
    v_exp_f32 v112, v112
    v_mfma_f32_16x16x32_bf16 v[48:51], a[200:203], a[136:139], v[48:51]
    v_exp_f32 v113, v113
    v_mfma_f32_16x16x32_bf16 v[48:51], a[196:199], a[132:135], v[48:51]
    s_nop 0
    v_cvt_pk_bf16_f32 v204, v108, v109
    v_mfma_f32_16x16x32_bf16 v[48:51], a[192:195], a[128:131], v[48:51]
    s_waitcnt lgkmcnt(0)
    v_cvt_pk_bf16_f32 v205, v110, v111
    v_mfma_f32_16x16x32_bf16 a[32:35], a[208:211], v[160:163], a[32:35]
    ds_read_b128 a[192:195], v240 offset:40960
    v_mfma_f32_16x16x32_bf16 a[32:35], a[212:215], v[176:179], a[32:35]
    ds_read_b128 a[196:199], v241 offset:40960
    v_mfma_f32_16x16x32_bf16 a[36:39], a[212:215], v[180:183], a[36:39]
    ds_read_b128 a[200:203], v242 offset:40960
    v_mfma_f32_16x16x32_bf16 a[36:39], a[208:211], v[164:167], a[36:39]
    ds_read_b128 a[204:207], v243 offset:40960
    v_mfma_f32_16x16x32_bf16 a[40:43], a[208:211], v[168:171], a[40:43]
    v_exp_f32 v114, v114
    v_mfma_f32_16x16x32_bf16 a[40:43], a[212:215], v[184:187], a[40:43]
    s_waitcnt vmcnt(4)
    v_cmp_ne_u64 vcc, s[54:55], v[18:19]
    v_cmp_ne_u64 s[8:9], s[54:55], v[20:21]
    v_cmp_ne_u64 s[74:75], s[54:55], v[28:29]
    s_or_b64 s[8:9], s[8:9], vcc
    v_cmp_ne_u64 vcc, s[54:55], v[30:31]
    s_or_b64 s[8:9], s[8:9], s[74:75]
    s_or_b64 vcc, vcc, s[8:9]
    s_cbranch_vccnz L_h
L_h_ok:
    s_mov_b32 s63, 0
    s_mul_i32 s64, s47, 0
    s_add_u32 m0, s65, 0
    v_mfma_f32_16x16x32_bf16 a[44:47], a[212:215], v[188:191], a[44:47]
    buffer_load_dwordx4 v252, s[20:23], s63 offen offset:0 lds
    v_mfma_f32_16x16x32_bf16 a[44:47], a[208:211], v[172:175], a[44:47]
    v_exp_f32 v115, v115
    v_mfma_f32_16x16x32_bf16 a[60:63], a[216:219], v[172:175], a[60:63]
    v_exp_f32 v116, v116
    v_mfma_f32_16x16x32_bf16 a[60:63], a[220:223], v[188:191], a[60:63]
    v_exp_f32 v117, v117
    v_mfma_f32_16x16x32_bf16 a[56:59], a[220:223], v[184:187], a[56:59]
    v_cvt_pk_bf16_f32 v194, v112, v113
    v_cvt_pk_bf16_f32 v195, v114, v115
    v_mfma_f32_16x16x32_bf16 a[56:59], a[216:219], v[168:171], a[56:59]
    v_exp_f32 v118, v118
    v_mfma_f32_16x16x32_bf16 a[52:55], a[216:219], v[164:167], a[52:55]
    v_exp_f32 v119, v119
    v_mfma_f32_16x16x32_bf16 a[52:55], a[220:223], v[180:183], a[52:55]
    s_cmp_eq_u32 s59, 0
    s_cselect_b64 vcc, -1, 0
    s_cmp_eq_u32 s45, 0
    s_cselect_b64 s[8:9], -1, 0
    v_cndmask_b32 v28, v8, v4, vcc
    v_cndmask_b32 v29, v9, v5, vcc
    v_cndmask_b32 v30, v10, v6, vcc
    v_cndmask_b32 v31, v11, v7, vcc
    v_mfma_f32_16x16x32_bf16 a[48:51], a[220:223], v[176:179], a[48:51]
    buffer_load_dwordx4 v253, s[20:23], s63 offen offset:1024 lds
    v_mfma_f32_16x16x32_bf16 a[48:51], a[216:219], v[160:163], a[48:51]
    s_waitcnt lgkmcnt(0)
    v_mfma_f32_16x16x32_bf16 v[64:67], a[192:195], a[128:131], 0
    ds_read_b64_tr_b16 a[208:209], v248 offset:32768
    v_mfma_f32_16x16x32_bf16 v[64:67], a[196:199], a[132:135], v[64:67]
    ds_read_b64_tr_b16 a[210:211], v248 offset:36864
    v_mfma_f32_16x16x32_bf16 v[64:67], a[200:203], a[136:139], v[64:67]
    ds_read_b64_tr_b16 a[212:213], v248 offset:40960
    v_mfma_f32_16x16x32_bf16 v[64:67], a[204:207], a[140:143], v[64:67]
    ds_read_b64_tr_b16 a[214:215], v248 offset:45056
    v_mfma_f32_16x16x32_bf16 v[68:71], a[204:207], a[156:159], 0
    ds_read_b64_tr_b16 a[216:217], v249 offset:32768
    v_mfma_f32_16x16x32_bf16 v[68:71], a[200:203], a[152:155], v[68:71]
    ds_read_b64_tr_b16 a[218:219], v249 offset:36864
    v_cndmask_b32 v28, v252, v28, s[8:9]
    v_cndmask_b32 v29, v253, v29, s[8:9]
    v_cndmask_b32 v30, v254, v30, s[8:9]
    v_cndmask_b32 v31, v255, v31, s[8:9]
    v_mfma_f32_16x16x32_bf16 v[68:71], a[196:199], a[148:151], v[68:71]
    ds_read_b64_tr_b16 a[220:221], v249 offset:40960
    buffer_load_dwordx4 v254, s[20:23], s63 offen offset:2048 lds
    v_mfma_f32_16x16x32_bf16 v[68:71], a[192:195], a[144:147], v[68:71]
    ds_read_b64_tr_b16 a[222:223], v249 offset:45056
    v_mfma_f32_16x16x32_bf16 v[72:75], a[192:195], a[160:163], 0
    v_exp_f32 v120, v120
    v_mfma_f32_16x16x32_bf16 v[72:75], a[196:199], a[164:167], v[72:75]
    v_exp_f32 v121, v121
    v_mfma_f32_16x16x32_bf16 v[72:75], a[200:203], a[168:171], v[72:75]
    v_cvt_pk_bf16_f32 v198, v116, v117
    v_cvt_pk_bf16_f32 v199, v118, v119
    v_mfma_f32_16x16x32_bf16 v[72:75], a[204:207], a[172:175], v[72:75]
    v_exp_f32 v122, v122
    v_mfma_f32_16x16x32_bf16 v[76:79], a[204:207], a[188:191], 0
    v_exp_f32 v123, v123
    v_mfma_f32_16x16x32_bf16 v[76:79], a[200:203], a[184:187], v[76:79]
    v_exp_f32 v124, v124
    v_mfma_f32_16x16x32_bf16 v[76:79], a[196:199], a[180:183], v[76:79]
    buffer_load_dwordx4 v255, s[20:23], s63 offen offset:3072 lds
    v_mfma_f32_16x16x32_bf16 v[76:79], a[192:195], a[176:179], v[76:79]
    s_waitcnt lgkmcnt(0)
    v_mfma_f32_16x16x32_bf16 a[64:67], a[208:211], v[160:163], a[64:67]
    ds_read_b128 a[192:195], v240 offset:45056
    v_mfma_f32_16x16x32_bf16 a[64:67], a[212:215], v[176:179], a[64:67]
    ds_read_b128 a[196:199], v241 offset:45056
    v_mfma_f32_16x16x32_bf16 a[68:71], a[212:215], v[180:183], a[68:71]
    ds_read_b128 a[200:203], v242 offset:45056
    v_mfma_f32_16x16x32_bf16 a[68:71], a[208:211], v[164:167], a[68:71]
    ds_read_b128 a[204:207], v243 offset:45056
    v_mfma_f32_16x16x32_bf16 a[72:75], a[208:211], v[168:171], a[72:75]
    v_exp_f32 v125, v125
    v_mfma_f32_16x16x32_bf16 a[72:75], a[212:215], v[184:187], a[72:75]
    s_add_u32 m0, s65, 8192
    v_cvt_pk_bf16_f32 v202, v120, v121
    v_mfma_f32_16x16x32_bf16 a[76:79], a[212:215], v[188:191], a[76:79]
    buffer_load_dwordx4 v28, s[36:39], s64 offen offset:0 lds
    v_mfma_f32_16x16x32_bf16 a[76:79], a[208:211], v[172:175], a[76:79]
    v_cvt_pk_bf16_f32 v203, v122, v123
    v_mfma_f32_16x16x32_bf16 a[92:95], a[216:219], v[172:175], a[92:95]
    v_exp_f32 v126, v126
    v_mfma_f32_16x16x32_bf16 a[92:95], a[220:223], v[188:191], a[92:95]
    v_exp_f32 v127, v127
    v_mfma_f32_16x16x32_bf16 a[88:91], a[220:223], v[184:187], a[88:91]
    v_exp_f32 v128, v128
    v_mfma_f32_16x16x32_bf16 a[88:91], a[216:219], v[168:171], a[88:91]
    v_exp_f32 v129, v129
    v_mfma_f32_16x16x32_bf16 a[84:87], a[216:219], v[164:167], a[84:87]
    v_cvt_pk_bf16_f32 v206, v124, v125
    v_cvt_pk_bf16_f32 v207, v126, v127
    v_mfma_f32_16x16x32_bf16 a[84:87], a[220:223], v[180:183], a[84:87]
    v_exp_f32 v130, v130
    v_mfma_f32_16x16x32_bf16 a[80:83], a[220:223], v[176:179], a[80:83]
    buffer_load_dwordx4 v29, s[36:39], s64 offen offset:1024 lds
    v_mfma_f32_16x16x32_bf16 a[80:83], a[216:219], v[160:163], a[80:83]
    s_waitcnt lgkmcnt(0)
    v_mfma_f32_16x16x32_bf16 v[92:95], a[192:195], a[176:179], 0
    ds_read_b64_tr_b16 a[208:209], v250 offset:32768
    v_mfma_f32_16x16x32_bf16 v[92:95], a[196:199], a[180:183], v[92:95]
    ds_read_b64_tr_b16 a[210:211], v250 offset:36864
    v_mfma_f32_16x16x32_bf16 v[92:95], a[200:203], a[184:187], v[92:95]
    ds_read_b64_tr_b16 a[212:213], v250 offset:40960
    v_mfma_f32_16x16x32_bf16 v[92:95], a[204:207], a[188:191], v[92:95]
    ds_read_b64_tr_b16 a[214:215], v250 offset:45056
    v_mfma_f32_16x16x32_bf16 v[88:91], a[204:207], a[172:175], 0
    ds_read_b64_tr_b16 a[216:217], v251 offset:32768
    v_mfma_f32_16x16x32_bf16 v[88:91], a[200:203], a[168:171], v[88:91]
    ds_read_b64_tr_b16 a[218:219], v251 offset:36864
    v_mfma_f32_16x16x32_bf16 v[88:91], a[196:199], a[164:167], v[88:91]
    ds_read_b64_tr_b16 a[220:221], v251 offset:40960
    buffer_load_dwordx4 v30, s[36:39], s64 offen offset:2048 lds
    v_mfma_f32_16x16x32_bf16 v[88:91], a[192:195], a[160:163], v[88:91]
    ds_read_b64_tr_b16 a[222:223], v251 offset:45056
    v_mfma_f32_16x16x32_bf16 v[84:87], a[192:195], a[144:147], 0
    v_exp_f32 v131, v131
    v_mfma_f32_16x16x32_bf16 v[84:87], a[196:199], a[148:151], v[84:87]
    v_exp_f32 v132, v132
    v_mfma_f32_16x16x32_bf16 v[84:87], a[200:203], a[152:155], v[84:87]
    v_exp_f32 v133, v133
    v_mfma_f32_16x16x32_bf16 v[84:87], a[204:207], a[156:159], v[84:87]
    v_cvt_pk_bf16_f32 v208, v128, v129
    v_cvt_pk_bf16_f32 v209, v130, v131
    v_mfma_f32_16x16x32_bf16 v[80:83], a[204:207], a[140:143], 0
    v_exp_f32 v134, v134
    v_mfma_f32_16x16x32_bf16 v[80:83], a[200:203], a[136:139], v[80:83]
    v_exp_f32 v135, v135
    v_mfma_f32_16x16x32_bf16 v[80:83], a[196:199], a[132:135], v[80:83]
    buffer_load_dwordx4 v31, s[36:39], s64 offen offset:3072 lds
    v_mfma_f32_16x16x32_bf16 v[80:83], a[192:195], a[128:131], v[80:83]
    s_waitcnt vmcnt(12) lgkmcnt(0)
    s_barrier
    v_mfma_f32_16x16x32_bf16 a[96:99], a[208:211], v[160:163], a[96:99]
    ds_read_b128 a[192:195], v240 offset:49152
    v_mfma_f32_16x16x32_bf16 a[96:99], a[212:215], v[176:179], a[96:99]
    ds_read_b128 a[196:199], v241 offset:49152
    v_mfma_f32_16x16x32_bf16 a[100:103], a[212:215], v[180:183], a[100:103]
    ds_read_b128 a[200:203], v242 offset:49152
    v_mfma_f32_16x16x32_bf16 a[100:103], a[208:211], v[164:167], a[100:103]
    ds_read_b128 a[204:207], v243 offset:49152
    v_mfma_f32_16x16x32_bf16 a[104:107], a[208:211], v[168:171], a[104:107]
    v_exp_f32 v136, v136
    v_mfma_f32_16x16x32_bf16 a[104:107], a[212:215], v[184:187], a[104:107]
    v_exp_f32 v137, v137
    v_mfma_f32_16x16x32_bf16 a[108:111], a[212:215], v[188:191], a[108:111]
    v_cvt_pk_bf16_f32 v212, v132, v133
    v_cvt_pk_bf16_f32 v213, v134, v135
    v_mfma_f32_16x16x32_bf16 a[108:111], a[208:211], v[172:175], a[108:111]
    v_exp_f32 v138, v138
    v_mfma_f32_16x16x32_bf16 a[124:127], a[216:219], v[172:175], a[124:127]
    v_exp_f32 v139, v139
    v_mfma_f32_16x16x32_bf16 a[124:127], a[220:223], v[188:191], a[124:127]
    v_exp_f32 v140, v140
    v_mfma_f32_16x16x32_bf16 a[120:123], a[220:223], v[184:187], a[120:123]
    v_exp_f32 v141, v141
    v_mfma_f32_16x16x32_bf16 a[120:123], a[216:219], v[168:171], a[120:123]
    v_cvt_pk_bf16_f32 v216, v136, v137
    v_cvt_pk_bf16_f32 v217, v138, v139
    v_mfma_f32_16x16x32_bf16 a[116:119], a[216:219], v[164:167], a[116:119]
    v_exp_f32 v142, v142
    v_mfma_f32_16x16x32_bf16 a[116:119], a[220:223], v[180:183], a[116:119]
    v_exp_f32 v143, v143
    v_mfma_f32_16x16x32_bf16 a[112:115], a[220:223], v[176:179], a[112:115]
    v_exp_f32 v144, v144
    v_mfma_f32_16x16x32_bf16 a[112:115], a[216:219], v[160:163], a[112:115]
    v_exp_f32 v145, v145
    v_mfma_f32_16x16x32_bf16 a[224:227], a[240:243], v[160:163], a[224:227]
    v_cvt_pk_bf16_f32 v220, v140, v141
    v_cvt_pk_bf16_f32 v221, v142, v143
    v_mfma_f32_16x16x32_bf16 a[224:227], a[240:243], v[176:179], a[224:227]
    v_exp_f32 v146, v146
    v_mfma_f32_16x16x32_bf16 a[228:231], a[240:243], v[164:167], a[228:231]
    v_exp_f32 v147, v147
    v_mfma_f32_16x16x32_bf16 a[228:231], a[240:243], v[180:183], a[228:231]
    v_exp_f32 v148, v148
    v_mfma_f32_16x16x32_bf16 a[232:235], a[240:243], v[168:171], a[232:235]
    v_exp_f32 v149, v149
    v_mfma_f32_16x16x32_bf16 a[232:235], a[240:243], v[184:187], a[232:235]
    v_cvt_pk_bf16_f32 v210, v144, v145
    v_cvt_pk_bf16_f32 v211, v146, v147
    v_mfma_f32_16x16x32_bf16 a[236:239], a[240:243], v[172:175], a[236:239]
    v_exp_f32 v150, v150
    v_mfma_f32_16x16x32_bf16 a[236:239], a[240:243], v[188:191], a[236:239]
    v_exp_f32 v151, v151
    v_exp_f32 v152, v152
    v_exp_f32 v153, v153
    v_cvt_pk_bf16_f32 v214, v148, v149
    v_cvt_pk_bf16_f32 v215, v150, v151
    v_exp_f32 v154, v154
    v_exp_f32 v155, v155
    v_exp_f32 v156, v156
    v_exp_f32 v157, v157
    v_cvt_pk_bf16_f32 v218, v152, v153
    v_cvt_pk_bf16_f32 v219, v154, v155
    v_exp_f32 v158, v158
    v_exp_f32 v159, v159
    s_nop 0
    v_cvt_pk_bf16_f32 v222, v156, v157
    v_cvt_pk_bf16_f32 v223, v158, v159
    s_waitcnt lgkmcnt(0)
    v_lshrrev_b32 v23, 2, v0
    v_lshlrev_b32 v23, 7, v23
    s_bfe_u32 s3, s2, 0x30003
    s_lshl_b32 s3, s3, 2
    s_add_u32 s3, s3, s44
    s_lshl_b32 s3, s3, 11
    v_add_u32 v23, s3, v23
    v_min_u32 v23, 53120, v23
    s_getpc_b64 s[8:9]
L_pc2:
    s_sub_u32 s8, s8, L_pc2-L_pc
    s_subb_u32 s9, s9, 0
    global_load_dword v23, v23, s[8:9]
    v_mfma_f32_16x16x32_bf16 v[96:99], a[192:195], a[128:131], 0
    ds_read_b64_tr_b16 a[208:209], v244 offset:49152
    v_mfma_f32_16x16x32_bf16 v[96:99], a[196:199], a[132:135], v[96:99]
    ds_read_b64_tr_b16 a[210:211], v244 offset:53248
    v_mfma_f32_16x16x32_bf16 v[96:99], a[200:203], a[136:139], v[96:99]
    ds_read_b64_tr_b16 a[212:213], v244 offset:57344
    v_mfma_f32_16x16x32_bf16 v[96:99], a[204:207], a[140:143], v[96:99]
    ds_read_b64_tr_b16 a[214:215], v244 offset:61440
    v_mfma_f32_16x16x32_bf16 v[100:103], a[204:207], a[156:159], 0
    ds_read_b64_tr_b16 a[216:217], v245 offset:49152
    v_mfma_f32_16x16x32_bf16 v[100:103], a[200:203], a[152:155], v[100:103]
    ds_read_b64_tr_b16 a[218:219], v245 offset:53248
    v_mfma_f32_16x16x32_bf16 v[100:103], a[196:199], a[148:151], v[100:103]
    ds_read_b64_tr_b16 a[220:221], v245 offset:57344
    v_mfma_f32_16x16x32_bf16 v[100:103], a[192:195], a[144:147], v[100:103]
    ds_read_b64_tr_b16 a[222:223], v245 offset:61440
    v_mfma_f32_16x16x32_bf16 v[104:107], a[192:195], a[160:163], 0
    v_exp_f32 v32, v32
    v_mfma_f32_16x16x32_bf16 v[104:107], a[196:199], a[164:167], v[104:107]
    s_lshl_b32 s3, s48, 1
    v_mfma_f32_16x16x32_bf16 v[104:107], a[200:203], a[168:171], v[104:107]
    v_exp_f32 v33, v33
    v_mfma_f32_16x16x32_bf16 v[104:107], a[204:207], a[172:175], v[104:107]
    v_exp_f32 v34, v34
    v_mfma_f32_16x16x32_bf16 v[108:111], a[204:207], a[188:191], 0
    s_lshr_b32 s49, s46, 4
    v_mfma_f32_16x16x32_bf16 v[108:111], a[200:203], a[184:187], v[108:111]
    s_mov_b32 s63, 262144
    s_mul_i32 s64, s47, 2
    s_add_u32 m0, s65, 65536
    v_mfma_f32_16x16x32_bf16 v[108:111], a[196:199], a[180:183], v[108:111]
    buffer_load_dwordx4 v252, s[20:23], s63 offen offset:0 lds
    v_mfma_f32_16x16x32_bf16 v[108:111], a[192:195], a[176:179], v[108:111]
    s_waitcnt lgkmcnt(0)
    v_mfma_f32_16x16x32_bf16 a[0:3], a[208:211], v[192:195], a[0:3]
    ds_read_b128 a[192:195], v240 offset:53248
    v_mfma_f32_16x16x32_bf16 a[0:3], a[212:215], v[208:211], a[0:3]
    ds_read_b128 a[196:199], v241 offset:53248
    v_mfma_f32_16x16x32_bf16 a[4:7], a[212:215], v[212:215], a[4:7]
    ds_read_b128 a[200:203], v242 offset:53248
    v_mfma_f32_16x16x32_bf16 a[4:7], a[208:211], v[196:199], a[4:7]
    ds_read_b128 a[204:207], v243 offset:53248
    v_mfma_f32_16x16x32_bf16 a[8:11], a[208:211], v[200:203], a[8:11]
    v_exp_f32 v35, v35
    v_mfma_f32_16x16x32_bf16 a[8:11], a[212:215], v[216:219], a[8:11]
    v_exp_f32 v36, v36
    v_mfma_f32_16x16x32_bf16 a[12:15], a[212:215], v[220:223], a[12:15]
    buffer_load_dwordx4 v253, s[20:23], s63 offen offset:1024 lds
    v_mfma_f32_16x16x32_bf16 a[12:15], a[208:211], v[204:207], a[12:15]
    v_exp_f32 v37, v37
    v_mfma_f32_16x16x32_bf16 a[28:31], a[216:219], v[204:207], a[28:31]
    s_add_u32 s3, s3, s49
    v_cvt_pk_bf16_f32 v160, v32, v33
    v_mfma_f32_16x16x32_bf16 a[28:31], a[220:223], v[220:223], a[28:31]
    v_cvt_pk_bf16_f32 v161, v34, v35
    v_mfma_f32_16x16x32_bf16 a[24:27], a[220:223], v[216:219], a[24:27]
    v_exp_f32 v38, v38
    v_mfma_f32_16x16x32_bf16 a[24:27], a[216:219], v[200:203], a[24:27]
    s_lshl_b32 s3, s3, 10
    v_mfma_f32_16x16x32_bf16 a[20:23], a[216:219], v[196:199], a[20:23]
    v_exp_f32 v39, v39
    v_mfma_f32_16x16x32_bf16 a[20:23], a[220:223], v[212:215], a[20:23]
    v_exp_f32 v40, v40
    v_mfma_f32_16x16x32_bf16 a[16:19], a[220:223], v[208:211], a[16:19]
    buffer_load_dwordx4 v254, s[20:23], s63 offen offset:2048 lds
    v_mfma_f32_16x16x32_bf16 a[16:19], a[216:219], v[192:195], a[16:19]
    s_waitcnt lgkmcnt(0)
    v_mfma_f32_16x16x32_bf16 v[124:127], a[192:195], a[176:179], 0
    ds_read_b64_tr_b16 a[208:209], v246 offset:49152
    v_mfma_f32_16x16x32_bf16 v[124:127], a[196:199], a[180:183], v[124:127]
    ds_read_b64_tr_b16 a[210:211], v246 offset:53248
    v_mfma_f32_16x16x32_bf16 v[124:127], a[200:203], a[184:187], v[124:127]
    ds_read_b64_tr_b16 a[212:213], v246 offset:57344
    v_mfma_f32_16x16x32_bf16 v[124:127], a[204:207], a[188:191], v[124:127]
    ds_read_b64_tr_b16 a[214:215], v246 offset:61440
    v_mfma_f32_16x16x32_bf16 v[120:123], a[204:207], a[172:175], 0
    ds_read_b64_tr_b16 a[216:217], v247 offset:49152
    v_mfma_f32_16x16x32_bf16 v[120:123], a[200:203], a[168:171], v[120:123]
    ds_read_b64_tr_b16 a[218:219], v247 offset:53248
    v_mfma_f32_16x16x32_bf16 v[120:123], a[196:199], a[164:167], v[120:123]
    ds_read_b64_tr_b16 a[220:221], v247 offset:57344
    buffer_load_dwordx4 v255, s[20:23], s63 offen offset:3072 lds
    v_mfma_f32_16x16x32_bf16 v[120:123], a[192:195], a[160:163], v[120:123]
    ds_read_b64_tr_b16 a[222:223], v247 offset:61440
    v_mfma_f32_16x16x32_bf16 v[116:119], a[192:195], a[144:147], 0
    v_exp_f32 v41, v41
    v_mfma_f32_16x16x32_bf16 v[116:119], a[196:199], a[148:151], v[116:119]
    s_and_b32 s49, s46, 15
    v_cvt_pk_bf16_f32 v164, v36, v37
    v_mfma_f32_16x16x32_bf16 v[116:119], a[200:203], a[152:155], v[116:119]
    v_cvt_pk_bf16_f32 v165, v38, v39
    v_mfma_f32_16x16x32_bf16 v[116:119], a[204:207], a[156:159], v[116:119]
    v_exp_f32 v42, v42
    v_mfma_f32_16x16x32_bf16 v[112:115], a[204:207], a[140:143], 0
    s_lshl_b32 s49, s49, 3
    v_mfma_f32_16x16x32_bf16 v[112:115], a[200:203], a[136:139], v[112:115]
    s_add_u32 m0, s65, 73728
    v_mfma_f32_16x16x32_bf16 v[112:115], a[196:199], a[132:135], v[112:115]
    buffer_load_dwordx4 v28, s[36:39], s64 offen offset:0 lds
    v_mfma_f32_16x16x32_bf16 v[112:115], a[192:195], a[128:131], v[112:115]
    s_waitcnt lgkmcnt(0)
    v_mfma_f32_16x16x32_bf16 a[32:35], a[208:211], v[192:195], a[32:35]
    ds_read_b128 a[192:195], v240 offset:57344
    v_mfma_f32_16x16x32_bf16 a[32:35], a[212:215], v[208:211], a[32:35]
    ds_read_b128 a[196:199], v241 offset:57344
    v_mfma_f32_16x16x32_bf16 a[36:39], a[212:215], v[212:215], a[36:39]
    ds_read_b128 a[200:203], v242 offset:57344
    v_mfma_f32_16x16x32_bf16 a[36:39], a[208:211], v[196:199], a[36:39]
    ds_read_b128 a[204:207], v243 offset:57344
    v_mfma_f32_16x16x32_bf16 a[40:43], a[208:211], v[200:203], a[40:43]
    v_exp_f32 v43, v43
    v_mfma_f32_16x16x32_bf16 a[40:43], a[212:215], v[216:219], a[40:43]
    v_exp_f32 v44, v44
    v_mfma_f32_16x16x32_bf16 a[44:47], a[212:215], v[220:223], a[44:47]
    buffer_load_dwordx4 v29, s[36:39], s64 offen offset:1024 lds
    v_mfma_f32_16x16x32_bf16 a[44:47], a[208:211], v[204:207], a[44:47]
    v_exp_f32 v45, v45
    v_mfma_f32_16x16x32_bf16 a[60:63], a[216:219], v[204:207], a[60:63]
    s_add_u32 s3, s3, s49
    v_cvt_pk_bf16_f32 v168, v40, v41
    v_mfma_f32_16x16x32_bf16 a[60:63], a[220:223], v[220:223], a[60:63]
    v_cvt_pk_bf16_f32 v169, v42, v43
    v_mfma_f32_16x16x32_bf16 a[56:59], a[220:223], v[216:219], a[56:59]
    v_exp_f32 v46, v46
    v_mfma_f32_16x16x32_bf16 a[56:59], a[216:219], v[200:203], a[56:59]
    s_add_u32 s3, s3, 102400
    v_mfma_f32_16x16x32_bf16 a[52:55], a[216:219], v[196:199], a[52:55]
    v_exp_f32 v47, v47
    v_mfma_f32_16x16x32_bf16 a[52:55], a[220:223], v[212:215], a[52:55]
    v_exp_f32 v48, v48
    v_mfma_f32_16x16x32_bf16 a[48:51], a[220:223], v[208:211], a[48:51]
    buffer_load_dwordx4 v30, s[36:39], s64 offen offset:2048 lds
    v_mfma_f32_16x16x32_bf16 a[48:51], a[216:219], v[192:195], a[48:51]
    s_waitcnt lgkmcnt(0)
    v_mfma_f32_16x16x32_bf16 v[128:131], a[192:195], a[128:131], 0
    ds_read_b64_tr_b16 a[208:209], v248 offset:49152
    v_mfma_f32_16x16x32_bf16 v[128:131], a[196:199], a[132:135], v[128:131]
    ds_read_b64_tr_b16 a[210:211], v248 offset:53248
    v_mfma_f32_16x16x32_bf16 v[128:131], a[200:203], a[136:139], v[128:131]
    ds_read_b64_tr_b16 a[212:213], v248 offset:57344
    v_mfma_f32_16x16x32_bf16 v[128:131], a[204:207], a[140:143], v[128:131]
    ds_read_b64_tr_b16 a[214:215], v248 offset:61440
    v_mfma_f32_16x16x32_bf16 v[132:135], a[204:207], a[156:159], 0
    ds_read_b64_tr_b16 a[216:217], v249 offset:49152
    v_mfma_f32_16x16x32_bf16 v[132:135], a[200:203], a[152:155], v[132:135]
    ds_read_b64_tr_b16 a[218:219], v249 offset:53248
    v_mfma_f32_16x16x32_bf16 v[132:135], a[196:199], a[148:151], v[132:135]
    ds_read_b64_tr_b16 a[220:221], v249 offset:57344
    buffer_load_dwordx4 v31, s[36:39], s64 offen offset:3072 lds
    v_mfma_f32_16x16x32_bf16 v[132:135], a[192:195], a[144:147], v[132:135]
    ds_read_b64_tr_b16 a[222:223], v249 offset:61440
    v_mfma_f32_16x16x32_bf16 v[136:139], a[192:195], a[160:163], 0
    v_exp_f32 v49, v49
    v_mfma_f32_16x16x32_bf16 v[136:139], a[196:199], a[164:167], v[136:139]
    v_and_b32 v18, 7, v0
    v_cvt_pk_bf16_f32 v172, v44, v45
    v_mfma_f32_16x16x32_bf16 v[136:139], a[200:203], a[168:171], v[136:139]
    v_cvt_pk_bf16_f32 v173, v46, v47
    v_mfma_f32_16x16x32_bf16 v[136:139], a[204:207], a[172:175], v[136:139]
    v_exp_f32 v50, v50
    v_mfma_f32_16x16x32_bf16 v[140:143], a[204:207], a[188:191], 0
    v_lshlrev_b32 v18, 7, v18
    v_mfma_f32_16x16x32_bf16 v[140:143], a[200:203], a[184:187], v[140:143]
    v_exp_f32 v51, v51
    v_mfma_f32_16x16x32_bf16 v[140:143], a[196:199], a[180:183], v[140:143]
    v_exp_f32 v52, v52
    v_mfma_f32_16x16x32_bf16 v[140:143], a[192:195], a[176:179], v[140:143]
    s_waitcnt lgkmcnt(0)
    v_mfma_f32_16x16x32_bf16 a[64:67], a[208:211], v[192:195], a[64:67]
    ds_read_b128 a[192:195], v240 offset:61440
    v_mfma_f32_16x16x32_bf16 a[64:67], a[212:215], v[208:211], a[64:67]
    ds_read_b128 a[196:199], v241 offset:61440
    v_mfma_f32_16x16x32_bf16 a[68:71], a[212:215], v[212:215], a[68:71]
    ds_read_b128 a[200:203], v242 offset:61440
    v_mfma_f32_16x16x32_bf16 a[68:71], a[208:211], v[196:199], a[68:71]
    ds_read_b128 a[204:207], v243 offset:61440
    v_mfma_f32_16x16x32_bf16 a[72:75], a[208:211], v[200:203], a[72:75]
    v_exp_f32 v53, v53
    v_mfma_f32_16x16x32_bf16 a[72:75], a[212:215], v[216:219], a[72:75]
    v_add_u32 v18, s3, v18
    v_cvt_pk_bf16_f32 v162, v48, v49
    v_mfma_f32_16x16x32_bf16 a[76:79], a[212:215], v[220:223], a[76:79]
    v_cvt_pk_bf16_f32 v163, v50, v51
    v_mfma_f32_16x16x32_bf16 a[76:79], a[208:211], v[204:207], a[76:79]
    v_exp_f32 v54, v54
    v_mfma_f32_16x16x32_bf16 a[92:95], a[216:219], v[204:207], a[92:95]
    s_lshl_b32 s3, s57, 1
    v_mfma_f32_16x16x32_bf16 a[92:95], a[220:223], v[220:223], a[92:95]
    v_exp_f32 v55, v55
    v_mfma_f32_16x16x32_bf16 a[88:91], a[220:223], v[216:219], a[88:91]
    v_exp_f32 v56, v56
    v_mfma_f32_16x16x32_bf16 a[88:91], a[216:219], v[200:203], a[88:91]
    v_exp_f32 v57, v57
    v_mfma_f32_16x16x32_bf16 a[84:87], a[216:219], v[196:199], a[84:87]
    s_add_u32 s3, s3, s59
    v_cvt_pk_bf16_f32 v166, v52, v53
    v_mfma_f32_16x16x32_bf16 a[84:87], a[220:223], v[212:215], a[84:87]
    v_cvt_pk_bf16_f32 v167, v54, v55
    v_mfma_f32_16x16x32_bf16 a[80:83], a[220:223], v[208:211], a[80:83]
    v_exp_f32 v58, v58
    v_mfma_f32_16x16x32_bf16 a[80:83], a[216:219], v[192:195], a[80:83]
    s_waitcnt lgkmcnt(0)
    s_lshl_b32 s3, s3, 1
    v_mfma_f32_16x16x32_bf16 v[156:159], a[192:195], a[176:179], 0
    ds_read_b64_tr_b16 a[208:209], v250 offset:49152
    v_mfma_f32_16x16x32_bf16 v[156:159], a[196:199], a[180:183], v[156:159]
    ds_read_b64_tr_b16 a[210:211], v250 offset:53248
    v_mfma_f32_16x16x32_bf16 v[156:159], a[200:203], a[184:187], v[156:159]
    ds_read_b64_tr_b16 a[212:213], v250 offset:57344
    v_mfma_f32_16x16x32_bf16 v[156:159], a[204:207], a[188:191], v[156:159]
    ds_read_b64_tr_b16 a[214:215], v250 offset:61440
    v_mfma_f32_16x16x32_bf16 v[152:155], a[204:207], a[172:175], 0
    ds_read_b64_tr_b16 a[216:217], v251 offset:49152
    v_mfma_f32_16x16x32_bf16 v[152:155], a[200:203], a[168:171], v[152:155]
    ds_read_b64_tr_b16 a[218:219], v251 offset:53248
    v_mfma_f32_16x16x32_bf16 v[152:155], a[196:199], a[164:167], v[152:155]
    ds_read_b64_tr_b16 a[220:221], v251 offset:57344
    v_mfma_f32_16x16x32_bf16 v[152:155], a[192:195], a[160:163], v[152:155]
    ds_read_b64_tr_b16 a[222:223], v251 offset:61440
    v_mfma_f32_16x16x32_bf16 v[148:151], a[192:195], a[144:147], 0
    v_exp_f32 v59, v59
    v_mfma_f32_16x16x32_bf16 v[148:151], a[196:199], a[148:151], v[148:151]
    v_exp_f32 v60, v60
    v_mfma_f32_16x16x32_bf16 v[148:151], a[200:203], a[152:155], v[148:151]
    v_exp_f32 v61, v61
    v_mfma_f32_16x16x32_bf16 v[148:151], a[204:207], a[156:159], v[148:151]
    s_add_u32 s3, s3, s60
    v_cvt_pk_bf16_f32 v170, v56, v57
    v_mfma_f32_16x16x32_bf16 v[144:147], a[204:207], a[140:143], 0
    v_cvt_pk_bf16_f32 v171, v58, v59
    v_mfma_f32_16x16x32_bf16 v[144:147], a[200:203], a[136:139], v[144:147]
    v_exp_f32 v62, v62
    v_mfma_f32_16x16x32_bf16 v[144:147], a[196:199], a[132:135], v[144:147]
    s_lshl_b32 s3, s3, 3
    v_mfma_f32_16x16x32_bf16 v[144:147], a[192:195], a[128:131], v[144:147]
    s_waitcnt vmcnt(8) lgkmcnt(0)
    s_barrier
    v_mfma_f32_16x16x32_bf16 a[96:99], a[208:211], v[192:195], a[96:99]
    v_xor_b32 v244, 0x8000, v244
    v_xor_b32 v245, 0x8000, v245
    v_mfma_f32_16x16x32_bf16 a[96:99], a[212:215], v[208:211], a[96:99]
    v_xor_b32 v246, 0x8000, v246
    v_xor_b32 v247, 0x8000, v247
    v_mfma_f32_16x16x32_bf16 a[100:103], a[212:215], v[212:215], a[100:103]
    v_xor_b32 v248, 0x8000, v248
    v_xor_b32 v249, 0x8000, v249
    v_mfma_f32_16x16x32_bf16 a[100:103], a[208:211], v[196:199], a[100:103]
    v_xor_b32 v250, 0x8000, v250
    v_xor_b32 v251, 0x8000, v251
    v_mfma_f32_16x16x32_bf16 a[104:107], a[208:211], v[200:203], a[104:107]
    ds_read_b64_tr_b16 v[224:225], v244 offset:32768
    v_mfma_f32_16x16x32_bf16 a[104:107], a[212:215], v[216:219], a[104:107]
    ds_read_b64_tr_b16 v[226:227], v244 offset:36864
    v_mfma_f32_16x16x32_bf16 a[108:111], a[212:215], v[220:223], a[108:111]
    ds_read_b64_tr_b16 v[228:229], v244 offset:40960
    v_mfma_f32_16x16x32_bf16 a[108:111], a[208:211], v[204:207], a[108:111]
    ds_read_b64_tr_b16 v[230:231], v244 offset:45056
    v_mfma_f32_16x16x32_bf16 a[124:127], a[216:219], v[204:207], a[124:127]
    ds_read_b64_tr_b16 v[232:233], v245 offset:32768
    v_mfma_f32_16x16x32_bf16 a[124:127], a[220:223], v[220:223], a[124:127]
    ds_read_b64_tr_b16 v[234:235], v245 offset:36864
    v_mfma_f32_16x16x32_bf16 a[120:123], a[220:223], v[216:219], a[120:123]
    ds_read_b64_tr_b16 v[236:237], v245 offset:40960
    v_mfma_f32_16x16x32_bf16 a[120:123], a[216:219], v[200:203], a[120:123]
    ds_read_b64_tr_b16 v[238:239], v245 offset:45056
    v_mfma_f32_16x16x32_bf16 a[116:119], a[216:219], v[196:199], a[116:119]
    ds_read_b64_tr_b16 v[240:241], v246 offset:32768
    v_mfma_f32_16x16x32_bf16 a[116:119], a[220:223], v[212:215], a[116:119]
    ds_read_b64_tr_b16 v[242:243], v246 offset:36864
    v_mfma_f32_16x16x32_bf16 a[112:115], a[220:223], v[208:211], a[112:115]
    ds_read_b64_tr_b16 a[244:245], v246 offset:40960
    v_mfma_f32_16x16x32_bf16 a[112:115], a[216:219], v[192:195], a[112:115]
    ds_read_b64_tr_b16 a[246:247], v246 offset:45056
    v_mfma_f32_16x16x32_bf16 a[224:227], a[240:243], v[192:195], a[224:227]
    ds_read_b64_tr_b16 a[248:249], v247 offset:32768
    v_mfma_f32_16x16x32_bf16 a[224:227], a[240:243], v[208:211], a[224:227]
    ds_read_b64_tr_b16 a[250:251], v247 offset:36864
    v_mfma_f32_16x16x32_bf16 a[228:231], a[240:243], v[196:199], a[228:231]
    ds_read_b64_tr_b16 a[252:253], v247 offset:40960
    v_mfma_f32_16x16x32_bf16 a[228:231], a[240:243], v[212:215], a[228:231]
    ds_read_b64_tr_b16 a[254:255], v247 offset:45056
    v_mfma_f32_16x16x32_bf16 a[232:235], a[240:243], v[200:203], a[232:235]
    ds_read_b64_tr_b16 a[192:193], v248 offset:32768
    v_mfma_f32_16x16x32_bf16 a[232:235], a[240:243], v[216:219], a[232:235]
    ds_read_b64_tr_b16 a[194:195], v248 offset:36864
    v_mfma_f32_16x16x32_bf16 a[236:239], a[240:243], v[204:207], a[236:239]
    ds_read_b64_tr_b16 a[196:197], v248 offset:40960
    v_mfma_f32_16x16x32_bf16 a[236:239], a[240:243], v[220:223], a[236:239]
    ds_read_b64_tr_b16 a[198:199], v248 offset:45056
    ds_read_b64_tr_b16 a[200:201], v249 offset:32768
    ds_read_b64_tr_b16 a[202:203], v249 offset:36864
    ds_read_b64_tr_b16 a[204:205], v249 offset:40960
    ds_read_b64_tr_b16 a[206:207], v249 offset:45056
    v_exp_f32 v63, v63
    v_exp_f32 v64, v64
    v_exp_f32 v65, v65
    s_add_u32 s3, s3, s58
    v_cvt_pk_bf16_f32 v174, v60, v61
    v_cvt_pk_bf16_f32 v175, v62, v63
    s_lshl_b32 s3, s3, 7
    v_exp_f32 v66, v66
    v_exp_f32 v67, v67
    v_exp_f32 v68, v68
    s_add_u32 s3, s3, 102400
    v_exp_f32 v69, v69
    v_cvt_pk_bf16_f32 v176, v64, v65
    v_cvt_pk_bf16_f32 v177, v66, v67
    v_and_b32 v19, 15, v0
    v_exp_f32 v70, v70
    v_exp_f32 v71, v71
    v_exp_f32 v72, v72
    v_lshlrev_b32 v19, 3, v19
    v_exp_f32 v73, v73
    v_cvt_pk_bf16_f32 v180, v68, v69
    v_cvt_pk_bf16_f32 v181, v70, v71
    v_add_u32 v19, s3, v19
    v_exp_f32 v74, v74
    v_exp_f32 v75, v75
    v_exp_f32 v76, v76
    s_lshl_b32 s52, s57, 3
    v_exp_f32 v77, v77
    v_cvt_pk_bf16_f32 v184, v72, v73
    v_cvt_pk_bf16_f32 v185, v74, v75
    s_add_u32 s52, s52, s58
    v_exp_f32 v78, v78
    v_exp_f32 v79, v79
    v_exp_f32 v80, v80
    s_lshl_b32 s52, s52, 2
    v_exp_f32 v81, v81
    v_cvt_pk_bf16_f32 v188, v76, v77
    v_cvt_pk_bf16_f32 v189, v78, v79
    s_add_u32 s52, s52, s44
    v_exp_f32 v82, v82
    v_exp_f32 v83, v83
    v_exp_f32 v84, v84
    s_lshl_b32 s3, s52, 6
    v_exp_f32 v85, v85
    v_cvt_pk_bf16_f32 v178, v80, v81
    v_cvt_pk_bf16_f32 v179, v82, v83
    s_add_u32 s3, s3, 4096
    v_exp_f32 v86, v86
    v_exp_f32 v87, v87
    v_exp_f32 v88, v88
    v_mov_b32 v22, s3
    v_exp_f32 v89, v89
    v_cvt_pk_bf16_f32 v182, v84, v85
    v_cvt_pk_bf16_f32 v183, v86, v87
    s_mov_b32 s49, 4096
    v_exp_f32 v90, v90
    v_exp_f32 v91, v91
    v_exp_f32 v92, v92
    s_mov_b32 s50, 10240
    v_exp_f32 v93, v93
    v_cvt_pk_bf16_f32 v186, v88, v89
    v_cvt_pk_bf16_f32 v187, v90, v91
    s_mov_b32 s53, 14336
    v_exp_f32 v94, v94
    v_exp_f32 v95, v95
    s_nop 0
    s_mov_b64 s[74:75], 0
    v_cvt_pk_bf16_f32 v190, v92, v93
    v_cvt_pk_bf16_f32 v191, v94, v95
    s_waitcnt lgkmcnt(0)
    v_mfma_f32_16x16x32_bf16 a[224:227], a[240:243], v[160:163], a[224:227]
    ds_read_b64_tr_b16 a[208:209], v250 offset:32768
    ds_read_b64_tr_b16 a[210:211], v250 offset:36864
    ds_read_b64_tr_b16 a[212:213], v250 offset:40960
    v_mfma_f32_16x16x32_bf16 a[224:227], a[240:243], v[176:179], a[224:227]
    ds_read_b64_tr_b16 a[214:215], v250 offset:45056
    ds_read_b64_tr_b16 a[216:217], v251 offset:32768
    ds_read_b64_tr_b16 a[218:219], v251 offset:36864
    v_mfma_f32_16x16x32_bf16 a[0:3], v[224:227], v[160:163], a[0:3]
    ds_read_b64_tr_b16 a[220:221], v251 offset:40960
    ds_read_b64_tr_b16 a[222:223], v251 offset:45056
    ds_read_b64_tr_b16 v[32:33], v244 offset:49152
    v_mfma_f32_16x16x32_bf16 a[0:3], v[228:231], v[176:179], a[0:3]
    ds_read_b64_tr_b16 v[34:35], v244 offset:53248
    ds_read_b64_tr_b16 v[36:37], v244 offset:57344
    ds_read_b64_tr_b16 v[38:39], v244 offset:61440
    v_mfma_f32_16x16x32_bf16 a[16:19], v[232:235], v[160:163], a[16:19]
    ds_read_b64_tr_b16 v[40:41], v245 offset:49152
    ds_read_b64_tr_b16 v[42:43], v245 offset:53248
    ds_read_b64_tr_b16 v[44:45], v245 offset:57344
    v_mfma_f32_16x16x32_bf16 a[16:19], v[236:239], v[176:179], a[16:19]
    ds_read_b64_tr_b16 v[46:47], v245 offset:61440
    ds_read_b64_tr_b16 v[48:49], v246 offset:49152
    ds_read_b64_tr_b16 v[50:51], v246 offset:53248
    v_mfma_f32_16x16x32_bf16 a[32:35], v[240:243], v[160:163], a[32:35]
    ds_read_b64_tr_b16 v[52:53], v246 offset:57344
    ds_read_b64_tr_b16 v[54:55], v246 offset:61440
    ds_read_b64_tr_b16 v[56:57], v247 offset:49152
    v_mfma_f32_16x16x32_bf16 a[32:35], a[244:247], v[176:179], a[32:35]
    ds_read_b64_tr_b16 v[58:59], v247 offset:53248
    ds_read_b64_tr_b16 v[60:61], v247 offset:57344
    ds_read_b64_tr_b16 v[62:63], v247 offset:61440
    v_mfma_f32_16x16x32_bf16 a[48:51], a[248:251], v[160:163], a[48:51]
    ds_read_b64_tr_b16 v[64:65], v248 offset:49152
    ds_read_b64_tr_b16 v[66:67], v248 offset:53248
    ds_read_b64_tr_b16 v[68:69], v248 offset:57344
    v_mfma_f32_16x16x32_bf16 a[48:51], a[252:255], v[176:179], a[48:51]
    ds_read_b64_tr_b16 v[70:71], v248 offset:61440
    ds_read_b64_tr_b16 v[72:73], v249 offset:49152
    ds_read_b64_tr_b16 v[74:75], v249 offset:53248
    v_mfma_f32_16x16x32_bf16 a[64:67], a[192:195], v[160:163], a[64:67]
    ds_read_b64_tr_b16 v[76:77], v249 offset:57344
    ds_read_b64_tr_b16 v[78:79], v249 offset:61440
    ds_read_b64_tr_b16 v[80:81], v250 offset:49152
    v_mfma_f32_16x16x32_bf16 a[64:67], a[196:199], v[176:179], a[64:67]
    ds_read_b64_tr_b16 v[82:83], v250 offset:53248
    ds_read_b64_tr_b16 v[84:85], v250 offset:57344
    ds_read_b64_tr_b16 v[86:87], v250 offset:61440
    v_mfma_f32_16x16x32_bf16 a[80:83], a[200:203], v[160:163], a[80:83]
    ds_read_b64_tr_b16 v[88:89], v251 offset:49152
    ds_read_b64_tr_b16 v[90:91], v251 offset:53248
    ds_read_b64_tr_b16 v[92:93], v251 offset:57344
    v_mfma_f32_16x16x32_bf16 a[80:83], a[204:207], v[176:179], a[80:83]
    ds_read_b64_tr_b16 v[94:95], v251 offset:61440
    s_waitcnt lgkmcnt(15)
    v_mfma_f32_16x16x32_bf16 a[96:99], a[208:211], v[160:163], a[96:99]
    v_mfma_f32_16x16x32_bf16 a[96:99], a[212:215], v[176:179], a[96:99]
    v_mfma_f32_16x16x32_bf16 a[112:115], a[216:219], v[160:163], a[112:115]
    v_mfma_f32_16x16x32_bf16 a[112:115], a[220:223], v[176:179], a[112:115]
    v_mfma_f32_16x16x32_bf16 a[228:231], a[240:243], v[164:167], a[228:231]
    v_mfma_f32_16x16x32_bf16 a[228:231], a[240:243], v[180:183], a[228:231]
    v_exp_f32 v96, v96
    v_mfma_f32_16x16x32_bf16 a[4:7], v[224:227], v[164:167], a[4:7]
    s_mov_b32 s63, 131072
    s_mul_i32 s64, s47, 1
    s_add_u32 m0, s65, 32768
    s_nop 0
    buffer_load_dwordx4 v252, s[20:23], s63 offen offset:0 lds
    v_mfma_f32_16x16x32_bf16 a[4:7], v[228:231], v[180:183], a[4:7]
    v_exp_f32 v97, v97
    v_mfma_f32_16x16x32_bf16 a[20:23], v[232:235], v[164:167], a[20:23]
    v_exp_f32 v98, v98
    v_mfma_f32_16x16x32_bf16 a[20:23], v[236:239], v[180:183], a[20:23]
    v_exp_f32 v99, v99
    v_mfma_f32_16x16x32_bf16 a[36:39], v[240:243], v[164:167], a[36:39]
    buffer_load_dwordx4 v253, s[20:23], s63 offen offset:1024 lds
    v_mfma_f32_16x16x32_bf16 a[36:39], a[244:247], v[180:183], a[36:39]
    v_exp_f32 v112, v112
    v_mfma_f32_16x16x32_bf16 a[52:55], a[248:251], v[164:167], a[52:55]
    v_exp_f32 v113, v113
    v_cvt_pk_bf16_f32 v192, v96, v97
    v_mfma_f32_16x16x32_bf16 a[52:55], a[252:255], v[180:183], a[52:55]
    buffer_load_dwordx4 v254, s[20:23], s63 offen offset:2048 lds
    v_cvt_pk_bf16_f32 v193, v98, v99
    v_mfma_f32_16x16x32_bf16 a[68:71], a[192:195], v[164:167], a[68:71]
    v_exp_f32 v114, v114
    v_mfma_f32_16x16x32_bf16 a[68:71], a[196:199], v[180:183], a[68:71]
    v_exp_f32 v115, v115
    v_mfma_f32_16x16x32_bf16 a[84:87], a[200:203], v[164:167], a[84:87]
    buffer_load_dwordx4 v255, s[20:23], s63 offen offset:3072 lds
    v_mfma_f32_16x16x32_bf16 a[84:87], a[204:207], v[180:183], a[84:87]
    v_exp_f32 v128, v128
    v_mfma_f32_16x16x32_bf16 a[100:103], a[208:211], v[164:167], a[100:103]
    v_exp_f32 v129, v129
    v_cvt_pk_bf16_f32 v194, v112, v113
    v_mfma_f32_16x16x32_bf16 a[100:103], a[212:215], v[180:183], a[100:103]
    s_add_u32 m0, s65, 40960
    s_nop 0
    buffer_load_dwordx4 v28, s[36:39], s64 offen offset:0 lds
    v_mfma_f32_16x16x32_bf16 a[116:119], a[216:219], v[164:167], a[116:119]
    v_cvt_pk_bf16_f32 v195, v114, v115
    v_exp_f32 v130, v130
    v_mfma_f32_16x16x32_bf16 a[116:119], a[220:223], v[180:183], a[116:119]
    v_exp_f32 v131, v131
    buffer_load_dwordx4 v29, s[36:39], s64 offen offset:1024 lds
    v_exp_f32 v144, v144
    v_exp_f32 v145, v145
    v_cvt_pk_bf16_f32 v208, v128, v129
    buffer_load_dwordx4 v30, s[36:39], s64 offen offset:2048 lds
    v_cvt_pk_bf16_f32 v209, v130, v131
    v_exp_f32 v146, v146
    v_exp_f32 v147, v147
    buffer_load_dwordx4 v31, s[36:39], s64 offen offset:3072 lds
    s_nop 0
    v_cvt_pk_bf16_f32 v210, v144, v145
    v_cvt_pk_bf16_f32 v211, v146, v147
    s_mov_b32 s63, 393216
    s_mul_i32 s64, s47, 3
    s_waitcnt lgkmcnt(0)
    v_mfma_f32_16x16x32_bf16 a[224:227], a[240:243], v[192:195], a[224:227]
    v_mfma_f32_16x16x32_bf16 a[224:227], a[240:243], v[208:211], a[224:227]
    v_exp_f32 v100, v100
    v_mfma_f32_16x16x32_bf16 a[0:3], v[32:35], v[192:195], a[0:3]
    v_exp_f32 v101, v101
    v_mfma_f32_16x16x32_bf16 a[0:3], v[36:39], v[208:211], a[0:3]
    v_exp_f32 v102, v102
    v_mfma_f32_16x16x32_bf16 a[16:19], v[40:43], v[192:195], a[16:19]
    v_exp_f32 v103, v103
    v_mfma_f32_16x16x32_bf16 a[16:19], v[44:47], v[208:211], a[16:19]
    v_exp_f32 v116, v116
    v_mfma_f32_16x16x32_bf16 a[32:35], v[48:51], v[192:195], a[32:35]
    v_exp_f32 v117, v117
    v_cvt_pk_bf16_f32 v196, v100, v101
    v_mfma_f32_16x16x32_bf16 a[32:35], v[52:55], v[208:211], a[32:35]
    v_cvt_pk_bf16_f32 v197, v102, v103
    v_exp_f32 v118, v118
    v_mfma_f32_16x16x32_bf16 a[48:51], v[56:59], v[192:195], a[48:51]
    v_exp_f32 v119, v119
    v_mfma_f32_16x16x32_bf16 a[48:51], v[60:63], v[208:211], a[48:51]
    v_exp_f32 v132, v132
    v_mfma_f32_16x16x32_bf16 a[64:67], v[64:67], v[192:195], a[64:67]
    v_exp_f32 v133, v133
    v_cvt_pk_bf16_f32 v198, v116, v117
    v_mfma_f32_16x16x32_bf16 a[64:67], v[68:71], v[208:211], a[64:67]
    v_cvt_pk_bf16_f32 v199, v118, v119
    v_exp_f32 v134, v134
    v_mfma_f32_16x16x32_bf16 a[80:83], v[72:75], v[192:195], a[80:83]
    v_exp_f32 v135, v135
    v_mfma_f32_16x16x32_bf16 a[80:83], v[76:79], v[208:211], a[80:83]
    v_exp_f32 v148, v148
    v_mfma_f32_16x16x32_bf16 a[96:99], v[80:83], v[192:195], a[96:99]
    v_exp_f32 v149, v149
    v_cvt_pk_bf16_f32 v212, v132, v133
    v_mfma_f32_16x16x32_bf16 a[96:99], v[84:87], v[208:211], a[96:99]
    v_cvt_pk_bf16_f32 v213, v134, v135
    v_exp_f32 v150, v150
    v_mfma_f32_16x16x32_bf16 a[112:115], v[88:91], v[192:195], a[112:115]
    v_exp_f32 v151, v151
    s_nop 0
    v_mfma_f32_16x16x32_bf16 a[112:115], v[92:95], v[208:211], a[112:115]
    v_cvt_pk_bf16_f32 v214, v148, v149
    v_cvt_pk_bf16_f32 v215, v150, v151
    v_mfma_f32_16x16x32_bf16 a[232:235], a[240:243], v[168:171], a[232:235]
    v_mfma_f32_16x16x32_bf16 a[232:235], a[240:243], v[184:187], a[232:235]
    v_accvgpr_read_b32 v24, a224
    v_subrev_u32 v25, 0x1f800000, v24
    v_rcp_f32 v24, v24
    v_cmp_lt_u32 vcc, 0x40000000, v25
    v_mfma_f32_16x16x32_bf16 a[8:11], v[224:227], v[168:171], a[8:11]
    v_accvgpr_read_b32 v96, a0
    v_accvgpr_read_b32 v97, a1
    v_accvgpr_read_b32 v98, a2
    v_accvgpr_read_b32 v99, a3
    v_accvgpr_read_b32 v112, a16
    v_mfma_f32_16x16x32_bf16 a[8:11], v[228:231], v[184:187], a[8:11]
    v_accvgpr_read_b32 v113, a17
    v_accvgpr_read_b32 v114, a18
    v_accvgpr_read_b32 v115, a19
    v_accvgpr_read_b32 v128, a32
    v_accvgpr_read_b32 v129, a33
    v_mfma_f32_16x16x32_bf16 a[24:27], v[232:235], v[168:171], a[24:27]
    v_accvgpr_read_b32 v130, a34
    v_accvgpr_read_b32 v131, a35
    v_accvgpr_read_b32 v144, a48
    v_accvgpr_read_b32 v145, a49
    v_accvgpr_read_b32 v146, a50
    v_mfma_f32_16x16x32_bf16 a[24:27], v[236:239], v[184:187], a[24:27]
    v_accvgpr_read_b32 v147, a51
    s_or_b64 s[74:75], s[74:75], vcc
    v_mul_f32 v96, v24, v96
    v_mul_f32 v97, v24, v97
    v_mul_f32 v98, v24, v98
    v_mfma_f32_16x16x32_bf16 a[40:43], v[240:243], v[168:171], a[40:43]
    v_mul_f32 v99, v24, v99
    v_mul_f32 v112, v24, v112
    v_mul_f32 v113, v24, v113
    v_mul_f32 v114, v24, v114
    v_mul_f32 v115, v24, v115
    v_mfma_f32_16x16x32_bf16 a[40:43], a[244:247], v[184:187], a[40:43]
    v_cvt_pk_bf16_f32 v96, v96, v97
    v_cvt_pk_bf16_f32 v97, v98, v99
    v_cvt_pk_bf16_f32 v98, v112, v113
    v_cvt_pk_bf16_f32 v99, v114, v115
    v_mfma_f32_16x16x32_bf16 a[56:59], a[248:251], v[168:171], a[56:59]
    buffer_store_dwordx4 v[96:99], v4, s[40:43], 0 offen offset:0 sc1
    v_mul_f32 v128, v24, v128
    v_mul_f32 v129, v24, v129
    v_mul_f32 v130, v24, v130
    v_mfma_f32_16x16x32_bf16 a[56:59], a[252:255], v[184:187], a[56:59]
    v_mul_f32 v131, v24, v131
    v_mul_f32 v144, v24, v144
    v_mul_f32 v145, v24, v145
    v_mul_f32 v146, v24, v146
    v_mul_f32 v147, v24, v147
    v_mfma_f32_16x16x32_bf16 a[72:75], a[192:195], v[168:171], a[72:75]
    v_cvt_pk_bf16_f32 v128, v128, v129
    v_cvt_pk_bf16_f32 v129, v130, v131
    v_cvt_pk_bf16_f32 v130, v144, v145
    v_cvt_pk_bf16_f32 v131, v146, v147
    v_mfma_f32_16x16x32_bf16 a[72:75], a[196:199], v[184:187], a[72:75]
    buffer_store_dwordx4 v[128:131], v8, s[40:43], s49 offen offset:0 sc1
    v_accvgpr_read_b32 v96, a64
    v_accvgpr_read_b32 v97, a65
    v_accvgpr_read_b32 v98, a66
    v_mfma_f32_16x16x32_bf16 a[88:91], a[200:203], v[168:171], a[88:91]
    v_accvgpr_read_b32 v99, a67
    v_accvgpr_read_b32 v112, a80
    v_accvgpr_read_b32 v113, a81
    v_accvgpr_read_b32 v114, a82
    v_accvgpr_read_b32 v115, a83
    v_mfma_f32_16x16x32_bf16 a[88:91], a[204:207], v[184:187], a[88:91]
    v_accvgpr_read_b32 v128, a96
    v_accvgpr_read_b32 v129, a97
    v_accvgpr_read_b32 v130, a98
    v_accvgpr_read_b32 v131, a99
    v_accvgpr_read_b32 v144, a112
    v_mfma_f32_16x16x32_bf16 a[104:107], a[208:211], v[168:171], a[104:107]
    v_accvgpr_read_b32 v145, a113
    v_accvgpr_read_b32 v146, a114
    v_accvgpr_read_b32 v147, a115
    v_mul_f32 v96, v24, v96
    v_mul_f32 v97, v24, v97
    v_mfma_f32_16x16x32_bf16 a[104:107], a[212:215], v[184:187], a[104:107]
    v_mul_f32 v98, v24, v98
    v_mul_f32 v99, v24, v99
    v_mul_f32 v112, v24, v112
    v_mul_f32 v113, v24, v113
    v_mul_f32 v114, v24, v114
    v_mfma_f32_16x16x32_bf16 a[120:123], a[216:219], v[168:171], a[120:123]
    v_mul_f32 v115, v24, v115
    v_cvt_pk_bf16_f32 v96, v96, v97
    v_cvt_pk_bf16_f32 v97, v98, v99
    v_cvt_pk_bf16_f32 v98, v112, v113
    v_cvt_pk_bf16_f32 v99, v114, v115
    v_mfma_f32_16x16x32_bf16 a[120:123], a[220:223], v[184:187], a[120:123]
    buffer_store_dwordx4 v[96:99], v4, s[40:43], s50 offen offset:0 sc1
    v_mul_f32 v128, v24, v128
    v_mul_f32 v129, v24, v129
    v_mul_f32 v130, v24, v130
    v_mul_f32 v131, v24, v131
    v_mul_f32 v144, v24, v144
    v_mul_f32 v145, v24, v145
    v_mul_f32 v146, v24, v146
    v_mul_f32 v147, v24, v147
    v_cvt_pk_bf16_f32 v128, v128, v129
    v_cvt_pk_bf16_f32 v129, v130, v131
    v_cvt_pk_bf16_f32 v130, v144, v145
    v_cvt_pk_bf16_f32 v131, v146, v147
    buffer_store_dwordx4 v[128:131], v8, s[40:43], s53 offen offset:0 sc1
    v_mfma_f32_16x16x32_bf16 a[228:231], a[240:243], v[196:199], a[228:231]
    v_mfma_f32_16x16x32_bf16 a[228:231], a[240:243], v[212:215], a[228:231]
    v_exp_f32 v104, v104
    v_mfma_f32_16x16x32_bf16 a[4:7], v[32:35], v[196:199], a[4:7]
    v_exp_f32 v105, v105
    v_mfma_f32_16x16x32_bf16 a[4:7], v[36:39], v[212:215], a[4:7]
    v_exp_f32 v106, v106
    v_mfma_f32_16x16x32_bf16 a[20:23], v[40:43], v[196:199], a[20:23]
    v_exp_f32 v107, v107
    v_mfma_f32_16x16x32_bf16 a[20:23], v[44:47], v[212:215], a[20:23]
    v_exp_f32 v120, v120
    v_mfma_f32_16x16x32_bf16 a[36:39], v[48:51], v[196:199], a[36:39]
    v_exp_f32 v121, v121
    v_cvt_pk_bf16_f32 v200, v104, v105
    v_mfma_f32_16x16x32_bf16 a[36:39], v[52:55], v[212:215], a[36:39]
    v_cvt_pk_bf16_f32 v201, v106, v107
    v_exp_f32 v122, v122
    v_mfma_f32_16x16x32_bf16 a[52:55], v[56:59], v[196:199], a[52:55]
    v_exp_f32 v123, v123
    v_mfma_f32_16x16x32_bf16 a[52:55], v[60:63], v[212:215], a[52:55]
    v_exp_f32 v136, v136
    v_mfma_f32_16x16x32_bf16 a[68:71], v[64:67], v[196:199], a[68:71]
    v_exp_f32 v137, v137
    v_cvt_pk_bf16_f32 v202, v120, v121
    v_mfma_f32_16x16x32_bf16 a[68:71], v[68:71], v[212:215], a[68:71]
    v_cvt_pk_bf16_f32 v203, v122, v123
    v_exp_f32 v138, v138
    v_mfma_f32_16x16x32_bf16 a[84:87], v[72:75], v[196:199], a[84:87]
    v_exp_f32 v139, v139
    v_mfma_f32_16x16x32_bf16 a[84:87], v[76:79], v[212:215], a[84:87]
    v_exp_f32 v152, v152
    v_mfma_f32_16x16x32_bf16 a[100:103], v[80:83], v[196:199], a[100:103]
    v_exp_f32 v153, v153
    v_cvt_pk_bf16_f32 v216, v136, v137
    v_mfma_f32_16x16x32_bf16 a[100:103], v[84:87], v[212:215], a[100:103]
    v_cvt_pk_bf16_f32 v217, v138, v139
    v_exp_f32 v154, v154
    v_mfma_f32_16x16x32_bf16 a[116:119], v[88:91], v[196:199], a[116:119]
    v_exp_f32 v155, v155
    s_nop 0
    v_mfma_f32_16x16x32_bf16 a[116:119], v[92:95], v[212:215], a[116:119]
    v_cvt_pk_bf16_f32 v218, v152, v153
    v_cvt_pk_bf16_f32 v219, v154, v155
    v_mfma_f32_16x16x32_bf16 a[236:239], a[240:243], v[172:175], a[236:239]
    v_mfma_f32_16x16x32_bf16 a[236:239], a[240:243], v[188:191], a[236:239]
    v_accvgpr_read_b32 v24, a228
    v_subrev_u32 v25, 0x1f800000, v24
    v_rcp_f32 v24, v24
    v_cmp_lt_u32 vcc, 0x40000000, v25
    v_mfma_f32_16x16x32_bf16 a[12:15], v[224:227], v[172:175], a[12:15]
    v_accvgpr_read_b32 v100, a4
    v_accvgpr_read_b32 v101, a5
    v_accvgpr_read_b32 v102, a6
    v_accvgpr_read_b32 v103, a7
    v_accvgpr_read_b32 v116, a20
    v_mfma_f32_16x16x32_bf16 a[12:15], v[228:231], v[188:191], a[12:15]
    v_accvgpr_read_b32 v117, a21
    v_accvgpr_read_b32 v118, a22
    v_accvgpr_read_b32 v119, a23
    v_accvgpr_read_b32 v132, a36
    v_accvgpr_read_b32 v133, a37
    v_mfma_f32_16x16x32_bf16 a[28:31], v[232:235], v[172:175], a[28:31]
    v_accvgpr_read_b32 v134, a38
    v_accvgpr_read_b32 v135, a39
    v_accvgpr_read_b32 v148, a52
    v_accvgpr_read_b32 v149, a53
    v_accvgpr_read_b32 v150, a54
    v_mfma_f32_16x16x32_bf16 a[28:31], v[236:239], v[188:191], a[28:31]
    v_accvgpr_read_b32 v151, a55
    s_or_b64 s[74:75], s[74:75], vcc
    v_mul_f32 v100, v24, v100
    v_mul_f32 v101, v24, v101
    v_mul_f32 v102, v24, v102
    v_mfma_f32_16x16x32_bf16 a[44:47], v[240:243], v[172:175], a[44:47]
    v_mul_f32 v103, v24, v103
    v_mul_f32 v116, v24, v116
    v_mul_f32 v117, v24, v117
    v_mul_f32 v118, v24, v118
    v_mul_f32 v119, v24, v119
    v_mfma_f32_16x16x32_bf16 a[44:47], a[244:247], v[188:191], a[44:47]
    v_cvt_pk_bf16_f32 v100, v100, v101
    v_cvt_pk_bf16_f32 v101, v102, v103
    v_cvt_pk_bf16_f32 v102, v116, v117
    v_cvt_pk_bf16_f32 v103, v118, v119
    v_mfma_f32_16x16x32_bf16 a[60:63], a[248:251], v[172:175], a[60:63]
    buffer_store_dwordx4 v[100:103], v5, s[40:43], 0 offen offset:1024 sc1
    v_mul_f32 v132, v24, v132
    v_mul_f32 v133, v24, v133
    v_mul_f32 v134, v24, v134
    v_mfma_f32_16x16x32_bf16 a[60:63], a[252:255], v[188:191], a[60:63]
    v_mul_f32 v135, v24, v135
    v_mul_f32 v148, v24, v148
    v_mul_f32 v149, v24, v149
    v_mul_f32 v150, v24, v150
    v_mul_f32 v151, v24, v151
    v_mfma_f32_16x16x32_bf16 a[76:79], a[192:195], v[172:175], a[76:79]
    v_cvt_pk_bf16_f32 v132, v132, v133
    v_cvt_pk_bf16_f32 v133, v134, v135
    v_cvt_pk_bf16_f32 v134, v148, v149
    v_cvt_pk_bf16_f32 v135, v150, v151
    v_mfma_f32_16x16x32_bf16 a[76:79], a[196:199], v[188:191], a[76:79]
    buffer_store_dwordx4 v[132:135], v9, s[40:43], s49 offen offset:1024 sc1
    v_accvgpr_read_b32 v100, a68
    v_accvgpr_read_b32 v101, a69
    v_accvgpr_read_b32 v102, a70
    v_mfma_f32_16x16x32_bf16 a[92:95], a[200:203], v[172:175], a[92:95]
    v_accvgpr_read_b32 v103, a71
    v_accvgpr_read_b32 v116, a84
    v_accvgpr_read_b32 v117, a85
    v_accvgpr_read_b32 v118, a86
    v_accvgpr_read_b32 v119, a87
    v_mfma_f32_16x16x32_bf16 a[92:95], a[204:207], v[188:191], a[92:95]
    v_accvgpr_read_b32 v132, a100
    v_accvgpr_read_b32 v133, a101
    v_accvgpr_read_b32 v134, a102
    v_accvgpr_read_b32 v135, a103
    v_accvgpr_read_b32 v148, a116
    v_mfma_f32_16x16x32_bf16 a[108:111], a[208:211], v[172:175], a[108:111]
    v_accvgpr_read_b32 v149, a117
    v_accvgpr_read_b32 v150, a118
    v_accvgpr_read_b32 v151, a119
    v_mul_f32 v100, v24, v100
    v_mul_f32 v101, v24, v101
    v_mfma_f32_16x16x32_bf16 a[108:111], a[212:215], v[188:191], a[108:111]
    v_mul_f32 v102, v24, v102
    v_mul_f32 v103, v24, v103
    v_mul_f32 v116, v24, v116
    v_mul_f32 v117, v24, v117
    v_mul_f32 v118, v24, v118
    v_mfma_f32_16x16x32_bf16 a[124:127], a[216:219], v[172:175], a[124:127]
    v_mul_f32 v119, v24, v119
    v_cvt_pk_bf16_f32 v100, v100, v101
    v_cvt_pk_bf16_f32 v101, v102, v103
    v_cvt_pk_bf16_f32 v102, v116, v117
    v_cvt_pk_bf16_f32 v103, v118, v119
    v_mfma_f32_16x16x32_bf16 a[124:127], a[220:223], v[188:191], a[124:127]
    buffer_store_dwordx4 v[100:103], v5, s[40:43], s50 offen offset:1024 sc1
    v_mul_f32 v132, v24, v132
    v_mul_f32 v133, v24, v133
    v_mul_f32 v134, v24, v134
    v_mul_f32 v135, v24, v135
    v_mul_f32 v148, v24, v148
    v_mul_f32 v149, v24, v149
    v_mul_f32 v150, v24, v150
    v_mul_f32 v151, v24, v151
    v_cvt_pk_bf16_f32 v132, v132, v133
    v_cvt_pk_bf16_f32 v133, v134, v135
    v_cvt_pk_bf16_f32 v134, v148, v149
    v_cvt_pk_bf16_f32 v135, v150, v151
    buffer_store_dwordx4 v[132:135], v9, s[40:43], s53 offen offset:1024 sc1
    v_mfma_f32_16x16x32_bf16 a[232:235], a[240:243], v[200:203], a[232:235]
    v_mfma_f32_16x16x32_bf16 a[232:235], a[240:243], v[216:219], a[232:235]
    v_exp_f32 v108, v108
    v_mfma_f32_16x16x32_bf16 a[8:11], v[32:35], v[200:203], a[8:11]
    v_exp_f32 v109, v109
    v_mfma_f32_16x16x32_bf16 a[8:11], v[36:39], v[216:219], a[8:11]
    v_exp_f32 v110, v110
    v_mfma_f32_16x16x32_bf16 a[24:27], v[40:43], v[200:203], a[24:27]
    v_exp_f32 v111, v111
    v_mfma_f32_16x16x32_bf16 a[24:27], v[44:47], v[216:219], a[24:27]
    v_exp_f32 v124, v124
    v_mfma_f32_16x16x32_bf16 a[40:43], v[48:51], v[200:203], a[40:43]
    v_exp_f32 v125, v125
    v_cvt_pk_bf16_f32 v204, v108, v109
    v_mfma_f32_16x16x32_bf16 a[40:43], v[52:55], v[216:219], a[40:43]
    v_cvt_pk_bf16_f32 v205, v110, v111
    v_exp_f32 v126, v126
    v_mfma_f32_16x16x32_bf16 a[56:59], v[56:59], v[200:203], a[56:59]
    v_exp_f32 v127, v127
    v_mfma_f32_16x16x32_bf16 a[56:59], v[60:63], v[216:219], a[56:59]
    v_exp_f32 v140, v140
    v_mfma_f32_16x16x32_bf16 a[72:75], v[64:67], v[200:203], a[72:75]
    v_exp_f32 v141, v141
    v_cvt_pk_bf16_f32 v206, v124, v125
    v_mfma_f32_16x16x32_bf16 a[72:75], v[68:71], v[216:219], a[72:75]
    v_cvt_pk_bf16_f32 v207, v126, v127
    v_exp_f32 v142, v142
    v_mfma_f32_16x16x32_bf16 a[88:91], v[72:75], v[200:203], a[88:91]
    v_exp_f32 v143, v143
    v_mfma_f32_16x16x32_bf16 a[88:91], v[76:79], v[216:219], a[88:91]
    v_exp_f32 v156, v156
    v_mfma_f32_16x16x32_bf16 a[104:107], v[80:83], v[200:203], a[104:107]
    v_exp_f32 v157, v157
    v_cvt_pk_bf16_f32 v220, v140, v141
    v_mfma_f32_16x16x32_bf16 a[104:107], v[84:87], v[216:219], a[104:107]
    v_cvt_pk_bf16_f32 v221, v142, v143
    v_exp_f32 v158, v158
    v_mfma_f32_16x16x32_bf16 a[120:123], v[88:91], v[200:203], a[120:123]
    v_exp_f32 v159, v159
    s_nop 0
    v_mfma_f32_16x16x32_bf16 a[120:123], v[92:95], v[216:219], a[120:123]
    v_cvt_pk_bf16_f32 v222, v156, v157
    v_cvt_pk_bf16_f32 v223, v158, v159
    s_nop 1
    v_mfma_f32_16x16x32_bf16 a[236:239], a[240:243], v[204:207], a[236:239]
    v_mfma_f32_16x16x32_bf16 a[236:239], a[240:243], v[220:223], a[236:239]
    v_accvgpr_read_b32 v24, a232
    v_subrev_u32 v25, 0x1f800000, v24
    v_rcp_f32 v24, v24
    v_cmp_lt_u32 vcc, 0x40000000, v25
    v_mfma_f32_16x16x32_bf16 a[12:15], v[32:35], v[204:207], a[12:15]
    v_accvgpr_read_b32 v104, a8
    v_accvgpr_read_b32 v105, a9
    v_accvgpr_read_b32 v106, a10
    v_accvgpr_read_b32 v107, a11
    v_accvgpr_read_b32 v120, a24
    v_mfma_f32_16x16x32_bf16 a[12:15], v[36:39], v[220:223], a[12:15]
    v_accvgpr_read_b32 v121, a25
    v_accvgpr_read_b32 v122, a26
    v_accvgpr_read_b32 v123, a27
    v_accvgpr_read_b32 v136, a40
    v_accvgpr_read_b32 v137, a41
    v_mfma_f32_16x16x32_bf16 a[28:31], v[40:43], v[204:207], a[28:31]
    v_accvgpr_read_b32 v138, a42
    v_accvgpr_read_b32 v139, a43
    v_accvgpr_read_b32 v152, a56
    v_accvgpr_read_b32 v153, a57
    v_accvgpr_read_b32 v154, a58
    v_mfma_f32_16x16x32_bf16 a[28:31], v[44:47], v[220:223], a[28:31]
    v_accvgpr_read_b32 v155, a59
    s_or_b64 s[74:75], s[74:75], vcc
    v_mul_f32 v104, v24, v104
    v_mul_f32 v105, v24, v105
    v_mul_f32 v106, v24, v106
    v_mfma_f32_16x16x32_bf16 a[44:47], v[48:51], v[204:207], a[44:47]
    v_mul_f32 v107, v24, v107
    v_mul_f32 v120, v24, v120
    v_mul_f32 v121, v24, v121
    v_mul_f32 v122, v24, v122
    v_mul_f32 v123, v24, v123
    v_mfma_f32_16x16x32_bf16 a[44:47], v[52:55], v[220:223], a[44:47]
    v_cvt_pk_bf16_f32 v104, v104, v105
    v_cvt_pk_bf16_f32 v105, v106, v107
    v_cvt_pk_bf16_f32 v106, v120, v121
    v_cvt_pk_bf16_f32 v107, v122, v123
    v_mfma_f32_16x16x32_bf16 a[60:63], v[56:59], v[204:207], a[60:63]
    buffer_store_dwordx4 v[104:107], v6, s[40:43], 0 offen offset:2048 sc1
    v_mul_f32 v136, v24, v136
    v_mul_f32 v137, v24, v137
    v_mul_f32 v138, v24, v138
    v_mfma_f32_16x16x32_bf16 a[60:63], v[60:63], v[220:223], a[60:63]
    v_mul_f32 v139, v24, v139
    v_mul_f32 v152, v24, v152
    v_mul_f32 v153, v24, v153
    v_mul_f32 v154, v24, v154
    v_mul_f32 v155, v24, v155
    v_mfma_f32_16x16x32_bf16 a[76:79], v[64:67], v[204:207], a[76:79]
    v_cvt_pk_bf16_f32 v136, v136, v137
    v_cvt_pk_bf16_f32 v137, v138, v139
    v_cvt_pk_bf16_f32 v138, v152, v153
    v_cvt_pk_bf16_f32 v139, v154, v155
    v_mfma_f32_16x16x32_bf16 a[76:79], v[68:71], v[220:223], a[76:79]
    buffer_store_dwordx4 v[136:139], v10, s[40:43], s49 offen offset:2048 sc1
    v_accvgpr_read_b32 v104, a72
    v_accvgpr_read_b32 v105, a73
    v_accvgpr_read_b32 v106, a74
    v_mfma_f32_16x16x32_bf16 a[92:95], v[72:75], v[204:207], a[92:95]
    v_accvgpr_read_b32 v107, a75
    v_accvgpr_read_b32 v120, a88
    v_accvgpr_read_b32 v121, a89
    v_accvgpr_read_b32 v122, a90
    v_accvgpr_read_b32 v123, a91
    v_mfma_f32_16x16x32_bf16 a[92:95], v[76:79], v[220:223], a[92:95]
    v_accvgpr_read_b32 v136, a104
    v_accvgpr_read_b32 v137, a105
    v_accvgpr_read_b32 v138, a106
    v_accvgpr_read_b32 v139, a107
    v_accvgpr_read_b32 v152, a120
    v_mfma_f32_16x16x32_bf16 a[108:111], v[80:83], v[204:207], a[108:111]
    v_accvgpr_read_b32 v153, a121
    v_accvgpr_read_b32 v154, a122
    v_accvgpr_read_b32 v155, a123
    v_mul_f32 v104, v24, v104
    v_mul_f32 v105, v24, v105
    v_mfma_f32_16x16x32_bf16 a[108:111], v[84:87], v[220:223], a[108:111]
    v_mul_f32 v106, v24, v106
    v_mul_f32 v107, v24, v107
    v_mul_f32 v120, v24, v120
    v_mul_f32 v121, v24, v121
    v_mul_f32 v122, v24, v122
    v_mfma_f32_16x16x32_bf16 a[124:127], v[88:91], v[204:207], a[124:127]
    v_mul_f32 v123, v24, v123
    v_cvt_pk_bf16_f32 v104, v104, v105
    v_cvt_pk_bf16_f32 v105, v106, v107
    v_cvt_pk_bf16_f32 v106, v120, v121
    v_cvt_pk_bf16_f32 v107, v122, v123
    v_mfma_f32_16x16x32_bf16 a[124:127], v[92:95], v[220:223], a[124:127]
    buffer_store_dwordx4 v[104:107], v6, s[40:43], s50 offen offset:2048 sc1
    v_mul_f32 v136, v24, v136
    v_mul_f32 v137, v24, v137
    v_mul_f32 v138, v24, v138
    v_mul_f32 v139, v24, v139
    v_mul_f32 v152, v24, v152
    v_mul_f32 v153, v24, v153
    v_mul_f32 v154, v24, v154
    v_mul_f32 v155, v24, v155
    v_cvt_pk_bf16_f32 v136, v136, v137
    v_cvt_pk_bf16_f32 v137, v138, v139
    v_cvt_pk_bf16_f32 v138, v152, v153
    v_cvt_pk_bf16_f32 v139, v154, v155
    buffer_store_dwordx4 v[136:139], v10, s[40:43], s53 offen offset:2048 sc1
    s_waitcnt vmcnt(12)
    s_barrier
    s_nop 4
    v_accvgpr_read_b32 v24, a236
    v_subrev_u32 v25, 0x1f800000, v24
    v_rcp_f32 v24, v24
    v_cmp_lt_u32 vcc, 0x40000000, v25
    v_accvgpr_read_b32 v108, a12
    v_accvgpr_read_b32 v109, a13
    v_accvgpr_read_b32 v110, a14
    v_accvgpr_read_b32 v111, a15
    v_accvgpr_read_b32 v124, a28
    v_accvgpr_read_b32 v125, a29
    v_accvgpr_read_b32 v126, a30
    v_accvgpr_read_b32 v127, a31
    v_accvgpr_read_b32 v140, a44
    v_accvgpr_read_b32 v141, a45
    v_accvgpr_read_b32 v142, a46
    v_accvgpr_read_b32 v143, a47
    v_accvgpr_read_b32 v156, a60
    v_accvgpr_read_b32 v157, a61
    v_accvgpr_read_b32 v158, a62
    v_accvgpr_read_b32 v159, a63
    s_or_b64 s[74:75], s[74:75], vcc
    v_pk_mul_f32 v[108:109], v[108:109], v[24:25] op_sel_hi:[1,0]
    v_pk_mul_f32 v[110:111], v[110:111], v[24:25] op_sel_hi:[1,0]
    v_pk_mul_f32 v[124:125], v[124:125], v[24:25] op_sel_hi:[1,0]
    v_pk_mul_f32 v[126:127], v[126:127], v[24:25] op_sel_hi:[1,0]
    v_cvt_pk_bf16_f32 v108, v108, v109
    v_cvt_pk_bf16_f32 v109, v110, v111
    v_cvt_pk_bf16_f32 v110, v124, v125
    v_cvt_pk_bf16_f32 v111, v126, v127
    buffer_store_dwordx4 v[108:111], v7, s[40:43], 0 offen offset:3072 sc1
    v_pk_mul_f32 v[140:141], v[140:141], v[24:25] op_sel_hi:[1,0]
    v_pk_mul_f32 v[142:143], v[142:143], v[24:25] op_sel_hi:[1,0]
    v_pk_mul_f32 v[156:157], v[156:157], v[24:25] op_sel_hi:[1,0]
    v_pk_mul_f32 v[158:159], v[158:159], v[24:25] op_sel_hi:[1,0]
    v_cvt_pk_bf16_f32 v140, v140, v141
    v_cvt_pk_bf16_f32 v141, v142, v143
    v_cvt_pk_bf16_f32 v142, v156, v157
    v_cvt_pk_bf16_f32 v143, v158, v159
    buffer_store_dwordx4 v[140:143], v11, s[40:43], s49 offen offset:3072 sc1
    v_accvgpr_read_b32 v108, a76
    v_accvgpr_read_b32 v109, a77
    v_accvgpr_read_b32 v110, a78
    v_accvgpr_read_b32 v111, a79
    v_accvgpr_read_b32 v124, a92
    v_accvgpr_read_b32 v125, a93
    v_accvgpr_read_b32 v126, a94
    v_accvgpr_read_b32 v127, a95
    v_accvgpr_read_b32 v140, a108
    v_accvgpr_read_b32 v141, a109
    v_accvgpr_read_b32 v142, a110
    v_accvgpr_read_b32 v143, a111
    v_accvgpr_read_b32 v156, a124
    v_accvgpr_read_b32 v157, a125
    v_accvgpr_read_b32 v158, a126
    v_accvgpr_read_b32 v159, a127
    v_pk_mul_f32 v[108:109], v[108:109], v[24:25] op_sel_hi:[1,0]
    v_pk_mul_f32 v[110:111], v[110:111], v[24:25] op_sel_hi:[1,0]
    v_pk_mul_f32 v[124:125], v[124:125], v[24:25] op_sel_hi:[1,0]
    v_pk_mul_f32 v[126:127], v[126:127], v[24:25] op_sel_hi:[1,0]
    v_cvt_pk_bf16_f32 v108, v108, v109
    v_cvt_pk_bf16_f32 v109, v110, v111
    v_cvt_pk_bf16_f32 v110, v124, v125
    v_cvt_pk_bf16_f32 v111, v126, v127
    buffer_store_dwordx4 v[108:111], v7, s[40:43], s50 offen offset:3072 sc1
    v_pk_mul_f32 v[140:141], v[140:141], v[24:25] op_sel_hi:[1,0]
    v_pk_mul_f32 v[142:143], v[142:143], v[24:25] op_sel_hi:[1,0]
    v_pk_mul_f32 v[156:157], v[156:157], v[24:25] op_sel_hi:[1,0]
    v_pk_mul_f32 v[158:159], v[158:159], v[24:25] op_sel_hi:[1,0]
    v_cvt_pk_bf16_f32 v140, v140, v141
    v_cvt_pk_bf16_f32 v141, v142, v143
    v_cvt_pk_bf16_f32 v142, v156, v157
    v_cvt_pk_bf16_f32 v143, v158, v159
    buffer_store_dwordx4 v[140:143], v11, s[40:43], s53 offen offset:3072 sc1
    s_cmp_lg_u64 s[74:75], 0
    s_cbranch_scc1 L_slow
L_slow_done:
    v_mov_b32 v100, v252
    v_mov_b32 v104, v28
    v_mov_b32 v101, v253
    v_mov_b32 v105, v29
    v_mov_b32 v102, v254
    v_mov_b32 v106, v30
    v_mov_b32 v103, v255
    v_mov_b32 v107, v31
    s_lshl_b32 s3, s52, 13
    s_add_u32 s3, s3, 239075328
    s_add_u32 s28, s10, s3
    s_addc_u32 s29, s11, 0
    s_mov_b32 s30, 8192
    s_mov_b32 s31, 0x20000
    v_lshrrev_b32 v25, 4, v0
    v_and_b32 v24, 15, v0
    v_lshlrev_b32 v23, 11, v25
    v_add_u32 v31, 0, v25
    v_xor_b32 v31, v31, v24
    v_lshl_add_u32 v96, v31, 4, v23
    v_add_u32 v31, 4, v25
    v_xor_b32 v31, v31, v24
    v_lshl_add_u32 v97, v31, 4, v23
    v_add_u32 v97, 7168, v97
    v_add_u32 v31, 8, v25
    v_xor_b32 v31, v31, v24
    v_lshl_add_u32 v98, v31, 4, v23
    v_add_u32 v98, 14336, v98
    v_add_u32 v31, 12, v25
    v_xor_b32 v31, v31, v24
    v_lshl_add_u32 v99, v31, 4, v23
    v_add_u32 v99, 21504, v99
    v_lshl_add_u32 v28, v24, 4, v23
    s_mul_i32 s3, s44, 8704
    s_add_u32 s3, s3, 65536
    v_mul_u32_u24 v31, 272, v24
    v_lshl_add_u32 v31, v25, 3, v31
    v_add_u32 v29, s3, v31
    v_mul_u32_u24 v31, 272, v25
    v_lshl_add_u32 v31, v24, 4, v31
    v_add_u32 v30, s3, v31
    s_cmp_eq_u32 s60, 0
    s_cselect_b64 vcc, -1, 0
    s_lshl_b32 s3, s60, 11
    v_cndmask_b32 v108, v6, v4, vcc
    v_cndmask_b32 v109, v7, v5, vcc
    v_cndmask_b32 v110, v4, v6, vcc
    v_cndmask_b32 v111, v5, v7, vcc
    v_cndmask_b32 v112, v10, v8, vcc
    v_cndmask_b32 v113, v11, v9, vcc
    v_cndmask_b32 v114, v8, v10, vcc
    v_cndmask_b32 v115, v9, v11, vcc
    s_xor_b32 s8, s3, 0
    v_add_u32 v108, s8, v108
    v_add_u32 v112, s8, v112
    s_xor_b32 s8, s3, 1024
    v_add_u32 v109, s8, v109
    v_add_u32 v113, s8, v113
    s_xor_b32 s8, s3, 2048
    v_add_u32 v110, s8, v110
    v_add_u32 v114, s8, v114
    s_xor_b32 s8, s3, 3072
    v_add_u32 v111, s8, v111
    v_add_u32 v115, s8, v115
    s_mov_b32 s50, 32768
    s_waitcnt vmcnt(0)
    s_mov_b64 exec, 0xff
    buffer_store_dwordx2 v[26:27], v18, s[12:15], 0 offen sc1
    s_mov_b64 exec, -1
    s_cmp_eq_u32 s56, 0
    s_cbranch_scc0 L_o_ok
    s_mov_b32 s3, 16384
L_o_l:
    buffer_load_dwordx2 v[24:25], v19, s[12:15], 0 offen sc1
    s_waitcnt vmcnt(0)
    v_cmp_ne_u64 vcc, s[54:55], v[24:25]
    s_sub_u32 s3, s3, 1
    s_cmp_eq_u32 s3, 0
    s_cbranch_scc1 L_o_ok
    s_cbranch_vccnz L_o_l
L_o_ok:
    buffer_load_dwordx4 a[0:3], v108, s[16:19], s61 offen sc1
    buffer_load_dwordx4 a[4:7], v109, s[16:19], s61 offen sc1
    buffer_load_dwordx4 a[8:11], v110, s[16:19], s61 offen sc1
    buffer_load_dwordx4 a[12:15], v111, s[16:19], s61 offen sc1
    buffer_load_dwordx4 a[16:19], v112, s[16:19], s62 offen sc1
    buffer_load_dwordx4 a[20:23], v113, s[16:19], s62 offen sc1
    buffer_load_dwordx4 a[24:27], v114, s[16:19], s62 offen sc1
    buffer_load_dwordx4 a[28:31], v115, s[16:19], s62 offen sc1
    s_add_u32 s61, s61, 10240
    s_add_u32 s62, s62, 10240
    buffer_load_dwordx4 a[32:35], v108, s[16:19], s61 offen sc1
    buffer_load_dwordx4 a[36:39], v109, s[16:19], s61 offen sc1
    buffer_load_dwordx4 a[40:43], v110, s[16:19], s61 offen sc1
    buffer_load_dwordx4 a[44:47], v111, s[16:19], s61 offen sc1
    buffer_load_dwordx4 a[48:51], v112, s[16:19], s62 offen sc1
    buffer_load_dwordx4 a[52:55], v113, s[16:19], s62 offen sc1
    buffer_load_dwordx4 a[56:59], v114, s[16:19], s62 offen sc1
    buffer_load_dwordx4 a[60:63], v115, s[16:19], s62 offen sc1
    s_add_u32 s61, s61, 10240
    s_add_u32 s62, s62, 10240
    buffer_load_dwordx4 a[64:67], v108, s[16:19], s61 offen sc1
    buffer_load_dwordx4 a[68:71], v109, s[16:19], s61 offen sc1
    buffer_load_dwordx4 a[72:75], v110, s[16:19], s61 offen sc1
    buffer_load_dwordx4 a[76:79], v111, s[16:19], s61 offen sc1
    buffer_load_dwordx4 a[80:83], v112, s[16:19], s62 offen sc1
    buffer_load_dwordx4 a[84:87], v113, s[16:19], s62 offen sc1
    buffer_load_dwordx4 a[88:91], v114, s[16:19], s62 offen sc1
    buffer_load_dwordx4 a[92:95], v115, s[16:19], s62 offen sc1
    s_add_u32 s61, s61, 10240
    s_add_u32 s62, s62, 10240
    s_or_b32 s3, s2, s44
    s_cmp_eq_u32 s3, 0
    s_cselect_b32 s3, 0, 2130706432
    v_mov_b32 v23, s3
    ds_read_b64_tr_b16 a[128:129], v12 offset:0
    ds_read_b64_tr_b16 a[130:131], v12 offset:2048
    ds_read_b64_tr_b16 a[132:133], v12 offset:4096
    ds_read_b64_tr_b16 a[134:135], v12 offset:6144
    ds_read_b64_tr_b16 a[136:137], v13 offset:0
    ds_read_b64_tr_b16 a[138:139], v13 offset:2048
    ds_read_b64_tr_b16 a[140:141], v13 offset:4096
    ds_read_b64_tr_b16 a[142:143], v13 offset:6144
    s_waitcnt vmcnt(16) lgkmcnt(4)
    v_mfma_f32_16x16x32_bf16 v[128:131], a[128:131], a[0:3], 0
    ds_read_b64_tr_b16 a[144:145], v14 offset:0
    buffer_store_dword v26, v23, s[12:15], 0 offen sc1
    v_mfma_f32_16x16x32_bf16 v[128:131], a[132:135], a[16:19], v[128:131]
    ds_read_b64_tr_b16 a[146:147], v14 offset:2048
    v_mfma_f32_16x16x32_bf16 v[132:135], a[132:135], a[20:23], 0
    v_mfma_f32_16x16x32_bf16 v[132:135], a[128:131], a[4:7], v[132:135]
    ds_read_b64_tr_b16 a[148:149], v14 offset:4096
    v_mfma_f32_16x16x32_bf16 v[136:139], a[128:131], a[8:11], 0
    ds_read_b64_tr_b16 a[150:151], v14 offset:6144
    s_add_u32 m0, s65, 98304
    v_mfma_f32_16x16x32_bf16 v[136:139], a[132:135], a[24:27], v[136:139]
    buffer_load_dwordx4 v100, s[20:23], s63 offen offset:0 lds
    v_mfma_f32_16x16x32_bf16 v[140:143], a[132:135], a[28:31], 0
    buffer_load_dwordx4 v101, s[20:23], s63 offen offset:1024 lds
    v_mfma_f32_16x16x32_bf16 v[140:143], a[128:131], a[12:15], v[140:143]
    s_waitcnt lgkmcnt(4)
    v_mfma_f32_16x16x32_bf16 v[156:159], a[136:139], a[12:15], 0
    ds_read_b64_tr_b16 a[152:153], v15 offset:0
    v_mfma_f32_16x16x32_bf16 v[156:159], a[140:143], a[28:31], v[156:159]
    ds_read_b64_tr_b16 a[154:155], v15 offset:2048
    v_mfma_f32_16x16x32_bf16 v[152:155], a[140:143], a[24:27], 0
    v_mfma_f32_16x16x32_bf16 v[152:155], a[136:139], a[8:11], v[152:155]
    ds_read_b64_tr_b16 a[156:157], v15 offset:4096
    v_mfma_f32_16x16x32_bf16 v[148:151], a[136:139], a[4:7], 0
    ds_read_b64_tr_b16 a[158:159], v15 offset:6144
    v_mfma_f32_16x16x32_bf16 v[148:151], a[140:143], a[20:23], v[148:151]
    buffer_load_dwordx4 v102, s[20:23], s63 offen offset:2048 lds
    v_mfma_f32_16x16x32_bf16 v[144:147], a[140:143], a[16:19], 0
    buffer_load_dwordx4 v103, s[20:23], s63 offen offset:3072 lds
    v_mfma_f32_16x16x32_bf16 v[144:147], a[136:139], a[0:3], v[144:147]
    s_waitcnt lgkmcnt(4)
    v_mfma_f32_16x16x32_bf16 v[160:163], a[144:147], a[0:3], 0
    ds_read_b64_tr_b16 a[128:129], v12 offset:8192
    v_mfma_f32_16x16x32_bf16 v[160:163], a[148:151], a[16:19], v[160:163]
    ds_read_b64_tr_b16 a[130:131], v12 offset:10240
    v_mfma_f32_16x16x32_bf16 v[164:167], a[148:151], a[20:23], 0
    v_mfma_f32_16x16x32_bf16 v[164:167], a[144:147], a[4:7], v[164:167]
    ds_read_b64_tr_b16 a[132:133], v12 offset:12288
    v_mfma_f32_16x16x32_bf16 v[168:171], a[144:147], a[8:11], 0
    ds_read_b64_tr_b16 a[134:135], v12 offset:14336
    s_add_u32 m0, s65, 106496
    v_mfma_f32_16x16x32_bf16 v[168:171], a[148:151], a[24:27], v[168:171]
    buffer_load_dwordx4 v104, s[36:39], s64 offen offset:0 lds
    v_mfma_f32_16x16x32_bf16 v[172:175], a[148:151], a[28:31], 0
    buffer_load_dwordx4 v105, s[36:39], s64 offen offset:1024 lds
    v_mfma_f32_16x16x32_bf16 v[172:175], a[144:147], a[12:15], v[172:175]
    s_waitcnt lgkmcnt(4)
    v_mfma_f32_16x16x32_bf16 v[188:191], a[152:155], a[12:15], 0
    ds_read_b64_tr_b16 a[136:137], v13 offset:8192
    v_mfma_f32_16x16x32_bf16 v[188:191], a[156:159], a[28:31], v[188:191]
    ds_read_b64_tr_b16 a[138:139], v13 offset:10240
    v_mfma_f32_16x16x32_bf16 v[184:187], a[156:159], a[24:27], 0
    v_mfma_f32_16x16x32_bf16 v[184:187], a[152:155], a[8:11], v[184:187]
    ds_read_b64_tr_b16 a[140:141], v13 offset:12288
    v_mfma_f32_16x16x32_bf16 v[180:183], a[152:155], a[4:7], 0
    ds_read_b64_tr_b16 a[142:143], v13 offset:14336
    v_mfma_f32_16x16x32_bf16 v[180:183], a[156:159], a[20:23], v[180:183]
    buffer_load_dwordx4 v106, s[36:39], s64 offen offset:2048 lds
    v_mfma_f32_16x16x32_bf16 v[176:179], a[156:159], a[16:19], 0
    buffer_load_dwordx4 v107, s[36:39], s64 offen offset:3072 lds
    v_mfma_f32_16x16x32_bf16 v[176:179], a[152:155], a[0:3], v[176:179]
    s_waitcnt lgkmcnt(4)
    v_mfma_f32_16x16x32_bf16 v[192:195], a[128:131], a[0:3], 0
    ds_read_b64_tr_b16 a[144:145], v14 offset:8192
    v_mfma_f32_16x16x32_bf16 v[192:195], a[132:135], a[16:19], v[192:195]
    ds_read_b64_tr_b16 a[146:147], v14 offset:10240
    v_mfma_f32_16x16x32_bf16 v[196:199], a[132:135], a[20:23], 0
    v_mfma_f32_16x16x32_bf16 v[196:199], a[128:131], a[4:7], v[196:199]
    ds_read_b64_tr_b16 a[148:149], v14 offset:12288
    v_mfma_f32_16x16x32_bf16 v[200:203], a[128:131], a[8:11], 0
    ds_read_b64_tr_b16 a[150:151], v14 offset:14336
    v_mfma_f32_16x16x32_bf16 v[200:203], a[132:135], a[24:27], v[200:203]
    buffer_load_dwordx4 a[96:99], v108, s[16:19], s61 offen sc1
    v_mfma_f32_16x16x32_bf16 v[204:207], a[132:135], a[28:31], 0
    buffer_load_dwordx4 a[100:103], v109, s[16:19], s61 offen sc1
    s_add_u32 s63, s63, 131072
    v_mfma_f32_16x16x32_bf16 v[204:207], a[128:131], a[12:15], v[204:207]
    s_add_u32 s64, s64, s47
    s_waitcnt lgkmcnt(4)
    v_mfma_f32_16x16x32_bf16 v[220:223], a[136:139], a[12:15], 0
    ds_read_b64_tr_b16 a[152:153], v15 offset:8192
    v_mfma_f32_16x16x32_bf16 v[220:223], a[140:143], a[28:31], v[220:223]
    ds_read_b64_tr_b16 a[154:155], v15 offset:10240
    v_mfma_f32_16x16x32_bf16 v[216:219], a[140:143], a[24:27], 0
    v_mfma_f32_16x16x32_bf16 v[216:219], a[136:139], a[8:11], v[216:219]
    ds_read_b64_tr_b16 a[156:157], v15 offset:12288
    v_mfma_f32_16x16x32_bf16 v[212:215], a[136:139], a[4:7], 0
    ds_read_b64_tr_b16 a[158:159], v15 offset:14336
    v_mfma_f32_16x16x32_bf16 v[212:215], a[140:143], a[20:23], v[212:215]
    buffer_load_dwordx4 a[104:107], v110, s[16:19], s61 offen sc1
    v_mfma_f32_16x16x32_bf16 v[208:211], a[140:143], a[16:19], 0
    buffer_load_dwordx4 a[108:111], v111, s[16:19], s61 offen sc1
    v_mfma_f32_16x16x32_bf16 v[208:211], a[136:139], a[0:3], v[208:211]
    s_waitcnt lgkmcnt(4)
    v_mfma_f32_16x16x32_bf16 v[224:227], a[144:147], a[0:3], 0
    v_mfma_f32_16x16x32_bf16 v[224:227], a[148:151], a[16:19], v[224:227]
    v_mfma_f32_16x16x32_bf16 v[228:231], a[148:151], a[20:23], 0
    v_mfma_f32_16x16x32_bf16 v[228:231], a[144:147], a[4:7], v[228:231]
    v_mfma_f32_16x16x32_bf16 v[232:235], a[144:147], a[8:11], 0
    v_mfma_f32_16x16x32_bf16 v[232:235], a[148:151], a[24:27], v[232:235]
    buffer_load_dwordx4 a[112:115], v112, s[16:19], s62 offen sc1
    v_mfma_f32_16x16x32_bf16 v[236:239], a[148:151], a[28:31], 0
    buffer_load_dwordx4 a[116:119], v113, s[16:19], s62 offen sc1
    v_mfma_f32_16x16x32_bf16 v[236:239], a[144:147], a[12:15], v[236:239]
    s_waitcnt vmcnt(23) lgkmcnt(0)
    s_barrier
    v_mfma_f32_16x16x32_bf16 v[252:255], a[152:155], a[12:15], 0
    ds_read_b64_tr_b16 a[128:129], v12 offset:32768
    v_mfma_f32_16x16x32_bf16 v[252:255], a[156:159], a[28:31], v[252:255]
    ds_read_b64_tr_b16 a[130:131], v12 offset:34816
    v_mfma_f32_16x16x32_bf16 v[248:251], a[156:159], a[24:27], 0
    ds_read_b64_tr_b16 a[132:133], v12 offset:36864
    v_mfma_f32_16x16x32_bf16 v[248:251], a[152:155], a[8:11], v[248:251]
    ds_read_b64_tr_b16 a[134:135], v12 offset:38912
    v_mfma_f32_16x16x32_bf16 v[244:247], a[152:155], a[4:7], 0
    ds_read_b64_tr_b16 a[136:137], v13 offset:32768
    v_mfma_f32_16x16x32_bf16 v[244:247], a[156:159], a[20:23], v[244:247]
    buffer_load_dwordx4 a[120:123], v114, s[16:19], s62 offen sc1
    ds_read_b64_tr_b16 a[138:139], v13 offset:34816
    v_mfma_f32_16x16x32_bf16 v[240:243], a[156:159], a[16:19], 0
    buffer_load_dwordx4 a[124:127], v115, s[16:19], s62 offen sc1
    ds_read_b64_tr_b16 a[140:141], v13 offset:36864
    v_mfma_f32_16x16x32_bf16 v[240:243], a[152:155], a[0:3], v[240:243]
    s_add_u32 s61, s61, 10240
    s_add_u32 s62, s62, 10240
    ds_read_b64_tr_b16 a[142:143], v13 offset:38912
    s_waitcnt lgkmcnt(4)
    v_mfma_f32_16x16x32_bf16 v[128:131], a[128:131], a[32:35], v[128:131]
    ds_read_b64_tr_b16 a[144:145], v14 offset:32768
    v_mfma_f32_16x16x32_bf16 v[128:131], a[132:135], a[48:51], v[128:131]
    ds_read_b64_tr_b16 a[146:147], v14 offset:34816
    v_mfma_f32_16x16x32_bf16 v[132:135], a[132:135], a[52:55], v[132:135]
    v_mfma_f32_16x16x32_bf16 v[132:135], a[128:131], a[36:39], v[132:135]
    ds_read_b64_tr_b16 a[148:149], v14 offset:36864
    v_mfma_f32_16x16x32_bf16 v[136:139], a[128:131], a[40:43], v[136:139]
    ds_read_b64_tr_b16 a[150:151], v14 offset:38912
    s_add_u32 m0, s65, 0
    v_mfma_f32_16x16x32_bf16 v[136:139], a[132:135], a[56:59], v[136:139]
    buffer_load_dwordx4 v100, s[20:23], s63 offen offset:0 lds
    v_mfma_f32_16x16x32_bf16 v[140:143], a[132:135], a[60:63], v[140:143]
    buffer_load_dwordx4 v101, s[20:23], s63 offen offset:1024 lds
    v_mfma_f32_16x16x32_bf16 v[140:143], a[128:131], a[44:47], v[140:143]
    s_waitcnt lgkmcnt(4)
    v_mfma_f32_16x16x32_bf16 v[156:159], a[136:139], a[44:47], v[156:159]
    ds_read_b64_tr_b16 a[152:153], v15 offset:32768
    v_mfma_f32_16x16x32_bf16 v[156:159], a[140:143], a[60:63], v[156:159]
    ds_read_b64_tr_b16 a[154:155], v15 offset:34816
    v_mfma_f32_16x16x32_bf16 v[152:155], a[140:143], a[56:59], v[152:155]
    v_mfma_f32_16x16x32_bf16 v[152:155], a[136:139], a[40:43], v[152:155]
    ds_read_b64_tr_b16 a[156:157], v15 offset:36864
    v_mfma_f32_16x16x32_bf16 v[148:151], a[136:139], a[36:39], v[148:151]
    ds_read_b64_tr_b16 a[158:159], v15 offset:38912
    v_mfma_f32_16x16x32_bf16 v[148:151], a[140:143], a[52:55], v[148:151]
    buffer_load_dwordx4 v102, s[20:23], s63 offen offset:2048 lds
    v_mfma_f32_16x16x32_bf16 v[144:147], a[140:143], a[48:51], v[144:147]
    buffer_load_dwordx4 v103, s[20:23], s63 offen offset:3072 lds
    v_mfma_f32_16x16x32_bf16 v[144:147], a[136:139], a[32:35], v[144:147]
    s_waitcnt lgkmcnt(4)
    v_mfma_f32_16x16x32_bf16 v[160:163], a[144:147], a[32:35], v[160:163]
    ds_read_b64_tr_b16 a[128:129], v12 offset:40960
    v_mfma_f32_16x16x32_bf16 v[160:163], a[148:151], a[48:51], v[160:163]
    ds_read_b64_tr_b16 a[130:131], v12 offset:43008
    v_mfma_f32_16x16x32_bf16 v[164:167], a[148:151], a[52:55], v[164:167]
    v_mfma_f32_16x16x32_bf16 v[164:167], a[144:147], a[36:39], v[164:167]
    ds_read_b64_tr_b16 a[132:133], v12 offset:45056
    v_mfma_f32_16x16x32_bf16 v[168:171], a[144:147], a[40:43], v[168:171]
    ds_read_b64_tr_b16 a[134:135], v12 offset:47104
    s_add_u32 m0, s65, 8192
    v_mfma_f32_16x16x32_bf16 v[168:171], a[148:151], a[56:59], v[168:171]
    buffer_load_dwordx4 v104, s[36:39], s64 offen offset:0 lds
    v_mfma_f32_16x16x32_bf16 v[172:175], a[148:151], a[60:63], v[172:175]
    buffer_load_dwordx4 v105, s[36:39], s64 offen offset:1024 lds
    v_mfma_f32_16x16x32_bf16 v[172:175], a[144:147], a[44:47], v[172:175]
    s_waitcnt lgkmcnt(4)
    v_mfma_f32_16x16x32_bf16 v[188:191], a[152:155], a[44:47], v[188:191]
    ds_read_b64_tr_b16 a[136:137], v13 offset:40960
    v_mfma_f32_16x16x32_bf16 v[188:191], a[156:159], a[60:63], v[188:191]
    ds_read_b64_tr_b16 a[138:139], v13 offset:43008
    v_mfma_f32_16x16x32_bf16 v[184:187], a[156:159], a[56:59], v[184:187]
    v_mfma_f32_16x16x32_bf16 v[184:187], a[152:155], a[40:43], v[184:187]
    ds_read_b64_tr_b16 a[140:141], v13 offset:45056
    v_mfma_f32_16x16x32_bf16 v[180:183], a[152:155], a[36:39], v[180:183]
    ds_read_b64_tr_b16 a[142:143], v13 offset:47104
    v_mfma_f32_16x16x32_bf16 v[180:183], a[156:159], a[52:55], v[180:183]
    buffer_load_dwordx4 v106, s[36:39], s64 offen offset:2048 lds
    v_mfma_f32_16x16x32_bf16 v[176:179], a[156:159], a[48:51], v[176:179]
    buffer_load_dwordx4 v107, s[36:39], s64 offen offset:3072 lds
    v_mfma_f32_16x16x32_bf16 v[176:179], a[152:155], a[32:35], v[176:179]
    s_waitcnt lgkmcnt(4)
    v_mfma_f32_16x16x32_bf16 v[192:195], a[128:131], a[32:35], v[192:195]
    ds_read_b64_tr_b16 a[144:145], v14 offset:40960
    v_mfma_f32_16x16x32_bf16 v[192:195], a[132:135], a[48:51], v[192:195]
    ds_read_b64_tr_b16 a[146:147], v14 offset:43008
    v_mfma_f32_16x16x32_bf16 v[196:199], a[132:135], a[52:55], v[196:199]
    v_mfma_f32_16x16x32_bf16 v[196:199], a[128:131], a[36:39], v[196:199]
    ds_read_b64_tr_b16 a[148:149], v14 offset:45056
    v_mfma_f32_16x16x32_bf16 v[200:203], a[128:131], a[40:43], v[200:203]
    ds_read_b64_tr_b16 a[150:151], v14 offset:47104
    v_mfma_f32_16x16x32_bf16 v[200:203], a[132:135], a[56:59], v[200:203]
    buffer_load_dwordx4 a[0:3], v108, s[16:19], s61 offen sc1
    v_mfma_f32_16x16x32_bf16 v[204:207], a[132:135], a[60:63], v[204:207]
    buffer_load_dwordx4 a[4:7], v109, s[16:19], s61 offen sc1
    s_add_u32 s63, s63, 131072
    v_mfma_f32_16x16x32_bf16 v[204:207], a[128:131], a[44:47], v[204:207]
    s_add_u32 s64, s64, s47
    s_waitcnt lgkmcnt(4)
    v_mfma_f32_16x16x32_bf16 v[220:223], a[136:139], a[44:47], v[220:223]
    ds_read_b64_tr_b16 a[152:153], v15 offset:40960
    v_mfma_f32_16x16x32_bf16 v[220:223], a[140:143], a[60:63], v[220:223]
    ds_read_b64_tr_b16 a[154:155], v15 offset:43008
    v_mfma_f32_16x16x32_bf16 v[216:219], a[140:143], a[56:59], v[216:219]
    v_mfma_f32_16x16x32_bf16 v[216:219], a[136:139], a[40:43], v[216:219]
    ds_read_b64_tr_b16 a[156:157], v15 offset:45056
    v_mfma_f32_16x16x32_bf16 v[212:215], a[136:139], a[36:39], v[212:215]
    ds_read_b64_tr_b16 a[158:159], v15 offset:47104
    v_mfma_f32_16x16x32_bf16 v[212:215], a[140:143], a[52:55], v[212:215]
    buffer_load_dwordx4 a[8:11], v110, s[16:19], s61 offen sc1
    v_mfma_f32_16x16x32_bf16 v[208:211], a[140:143], a[48:51], v[208:211]
    buffer_load_dwordx4 a[12:15], v111, s[16:19], s61 offen sc1
    v_mfma_f32_16x16x32_bf16 v[208:211], a[136:139], a[32:35], v[208:211]
    s_waitcnt lgkmcnt(4)
    v_mfma_f32_16x16x32_bf16 v[224:227], a[144:147], a[32:35], v[224:227]
    v_mfma_f32_16x16x32_bf16 v[224:227], a[148:151], a[48:51], v[224:227]
    v_mfma_f32_16x16x32_bf16 v[228:231], a[148:151], a[52:55], v[228:231]
    v_mfma_f32_16x16x32_bf16 v[228:231], a[144:147], a[36:39], v[228:231]
    v_mfma_f32_16x16x32_bf16 v[232:235], a[144:147], a[40:43], v[232:235]
    v_mfma_f32_16x16x32_bf16 v[232:235], a[148:151], a[56:59], v[232:235]
    buffer_load_dwordx4 a[16:19], v112, s[16:19], s62 offen sc1
    v_mfma_f32_16x16x32_bf16 v[236:239], a[148:151], a[60:63], v[236:239]
    buffer_load_dwordx4 a[20:23], v113, s[16:19], s62 offen sc1
    v_mfma_f32_16x16x32_bf16 v[236:239], a[144:147], a[44:47], v[236:239]
    s_waitcnt vmcnt(30) lgkmcnt(0)
    s_barrier
    v_mfma_f32_16x16x32_bf16 v[252:255], a[152:155], a[44:47], v[252:255]
    ds_read_b64_tr_b16 a[128:129], v16 offset:0
    v_mfma_f32_16x16x32_bf16 v[252:255], a[156:159], a[60:63], v[252:255]
    ds_read_b64_tr_b16 a[130:131], v16 offset:2048
    v_mfma_f32_16x16x32_bf16 v[248:251], a[156:159], a[56:59], v[248:251]
    ds_read_b64_tr_b16 a[132:133], v16 offset:4096
    v_mfma_f32_16x16x32_bf16 v[248:251], a[152:155], a[40:43], v[248:251]
    ds_read_b64_tr_b16 a[134:135], v16 offset:6144
    v_mfma_f32_16x16x32_bf16 v[244:247], a[152:155], a[36:39], v[244:247]
    ds_read_b64_tr_b16 a[136:137], v17 offset:0
    v_mfma_f32_16x16x32_bf16 v[244:247], a[156:159], a[52:55], v[244:247]
    buffer_load_dwordx4 a[24:27], v114, s[16:19], s62 offen sc1
    ds_read_b64_tr_b16 a[138:139], v17 offset:2048
    v_mfma_f32_16x16x32_bf16 v[240:243], a[156:159], a[48:51], v[240:243]
    buffer_load_dwordx4 a[28:31], v115, s[16:19], s62 offen sc1
    ds_read_b64_tr_b16 a[140:141], v17 offset:4096
    v_mfma_f32_16x16x32_bf16 v[240:243], a[152:155], a[32:35], v[240:243]
    s_add_u32 s61, s61, 10240
    s_add_u32 s62, s62, 10240
    ds_read_b64_tr_b16 a[142:143], v17 offset:6144
    s_waitcnt lgkmcnt(4)
    v_mfma_f32_16x16x32_bf16 v[128:131], a[128:131], a[64:67], v[128:131]
    ds_read_b64_tr_b16 a[144:145], v2 offset:0
    v_mfma_f32_16x16x32_bf16 v[128:131], a[132:135], a[80:83], v[128:131]
    ds_read_b64_tr_b16 a[146:147], v2 offset:2048
    v_mfma_f32_16x16x32_bf16 v[132:135], a[132:135], a[84:87], v[132:135]
    v_mfma_f32_16x16x32_bf16 v[132:135], a[128:131], a[68:71], v[132:135]
    ds_read_b64_tr_b16 a[148:149], v2 offset:4096
    v_mfma_f32_16x16x32_bf16 v[136:139], a[128:131], a[72:75], v[136:139]
    ds_read_b64_tr_b16 a[150:151], v2 offset:6144
    s_add_u32 m0, s65, 32768
    v_mfma_f32_16x16x32_bf16 v[136:139], a[132:135], a[88:91], v[136:139]
    buffer_load_dwordx4 v100, s[20:23], s63 offen offset:0 lds
    v_mfma_f32_16x16x32_bf16 v[140:143], a[132:135], a[92:95], v[140:143]
    buffer_load_dwordx4 v101, s[20:23], s63 offen offset:1024 lds
    v_mfma_f32_16x16x32_bf16 v[140:143], a[128:131], a[76:79], v[140:143]
    s_waitcnt lgkmcnt(4)
    v_mfma_f32_16x16x32_bf16 v[156:159], a[136:139], a[76:79], v[156:159]
    ds_read_b64_tr_b16 a[152:153], v3 offset:0
    v_mfma_f32_16x16x32_bf16 v[156:159], a[140:143], a[92:95], v[156:159]
    ds_read_b64_tr_b16 a[154:155], v3 offset:2048
    v_mfma_f32_16x16x32_bf16 v[152:155], a[140:143], a[88:91], v[152:155]
    v_mfma_f32_16x16x32_bf16 v[152:155], a[136:139], a[72:75], v[152:155]
    ds_read_b64_tr_b16 a[156:157], v3 offset:4096
    v_mfma_f32_16x16x32_bf16 v[148:151], a[136:139], a[68:71], v[148:151]
    ds_read_b64_tr_b16 a[158:159], v3 offset:6144
    v_mfma_f32_16x16x32_bf16 v[148:151], a[140:143], a[84:87], v[148:151]
    buffer_load_dwordx4 v102, s[20:23], s63 offen offset:2048 lds
    v_mfma_f32_16x16x32_bf16 v[144:147], a[140:143], a[80:83], v[144:147]
    buffer_load_dwordx4 v103, s[20:23], s63 offen offset:3072 lds
    v_mfma_f32_16x16x32_bf16 v[144:147], a[136:139], a[64:67], v[144:147]
    s_waitcnt lgkmcnt(4)
    v_mfma_f32_16x16x32_bf16 v[160:163], a[144:147], a[64:67], v[160:163]
    ds_read_b64_tr_b16 a[128:129], v16 offset:8192
    v_mfma_f32_16x16x32_bf16 v[160:163], a[148:151], a[80:83], v[160:163]
    ds_read_b64_tr_b16 a[130:131], v16 offset:10240
    v_mfma_f32_16x16x32_bf16 v[164:167], a[148:151], a[84:87], v[164:167]
    v_mfma_f32_16x16x32_bf16 v[164:167], a[144:147], a[68:71], v[164:167]
    ds_read_b64_tr_b16 a[132:133], v16 offset:12288
    v_mfma_f32_16x16x32_bf16 v[168:171], a[144:147], a[72:75], v[168:171]
    ds_read_b64_tr_b16 a[134:135], v16 offset:14336
    s_add_u32 m0, s65, 40960
    v_mfma_f32_16x16x32_bf16 v[168:171], a[148:151], a[88:91], v[168:171]
    buffer_load_dwordx4 v104, s[36:39], s64 offen offset:0 lds
    v_mfma_f32_16x16x32_bf16 v[172:175], a[148:151], a[92:95], v[172:175]
    buffer_load_dwordx4 v105, s[36:39], s64 offen offset:1024 lds
    v_mfma_f32_16x16x32_bf16 v[172:175], a[144:147], a[76:79], v[172:175]
    s_waitcnt lgkmcnt(4)
    v_mfma_f32_16x16x32_bf16 v[188:191], a[152:155], a[76:79], v[188:191]
    ds_read_b64_tr_b16 a[136:137], v17 offset:8192
    v_mfma_f32_16x16x32_bf16 v[188:191], a[156:159], a[92:95], v[188:191]
    ds_read_b64_tr_b16 a[138:139], v17 offset:10240
    v_mfma_f32_16x16x32_bf16 v[184:187], a[156:159], a[88:91], v[184:187]
    v_mfma_f32_16x16x32_bf16 v[184:187], a[152:155], a[72:75], v[184:187]
    ds_read_b64_tr_b16 a[140:141], v17 offset:12288
    v_mfma_f32_16x16x32_bf16 v[180:183], a[152:155], a[68:71], v[180:183]
    ds_read_b64_tr_b16 a[142:143], v17 offset:14336
    v_mfma_f32_16x16x32_bf16 v[180:183], a[156:159], a[84:87], v[180:183]
    buffer_load_dwordx4 v106, s[36:39], s64 offen offset:2048 lds
    v_mfma_f32_16x16x32_bf16 v[176:179], a[156:159], a[80:83], v[176:179]
    buffer_load_dwordx4 v107, s[36:39], s64 offen offset:3072 lds
    v_mfma_f32_16x16x32_bf16 v[176:179], a[152:155], a[64:67], v[176:179]
    s_waitcnt lgkmcnt(4)
    v_mfma_f32_16x16x32_bf16 v[192:195], a[128:131], a[64:67], v[192:195]
    ds_read_b64_tr_b16 a[144:145], v2 offset:8192
    v_mfma_f32_16x16x32_bf16 v[192:195], a[132:135], a[80:83], v[192:195]
    ds_read_b64_tr_b16 a[146:147], v2 offset:10240
    v_mfma_f32_16x16x32_bf16 v[196:199], a[132:135], a[84:87], v[196:199]
    v_mfma_f32_16x16x32_bf16 v[196:199], a[128:131], a[68:71], v[196:199]
    ds_read_b64_tr_b16 a[148:149], v2 offset:12288
    v_mfma_f32_16x16x32_bf16 v[200:203], a[128:131], a[72:75], v[200:203]
    ds_read_b64_tr_b16 a[150:151], v2 offset:14336
    v_mfma_f32_16x16x32_bf16 v[200:203], a[132:135], a[88:91], v[200:203]
    buffer_load_dwordx4 a[32:35], v108, s[16:19], s61 offen sc1
    v_mfma_f32_16x16x32_bf16 v[204:207], a[132:135], a[92:95], v[204:207]
    buffer_load_dwordx4 a[36:39], v109, s[16:19], s61 offen sc1
    s_add_u32 s63, s63, 131072
    v_mfma_f32_16x16x32_bf16 v[204:207], a[128:131], a[76:79], v[204:207]
    s_add_u32 s64, s64, s47
    s_waitcnt lgkmcnt(4)
    v_mfma_f32_16x16x32_bf16 v[220:223], a[136:139], a[76:79], v[220:223]
    ds_read_b64_tr_b16 a[152:153], v3 offset:8192
    v_mfma_f32_16x16x32_bf16 v[220:223], a[140:143], a[92:95], v[220:223]
    ds_read_b64_tr_b16 a[154:155], v3 offset:10240
    v_mfma_f32_16x16x32_bf16 v[216:219], a[140:143], a[88:91], v[216:219]
    v_mfma_f32_16x16x32_bf16 v[216:219], a[136:139], a[72:75], v[216:219]
    ds_read_b64_tr_b16 a[156:157], v3 offset:12288
    v_mfma_f32_16x16x32_bf16 v[212:215], a[136:139], a[68:71], v[212:215]
    ds_read_b64_tr_b16 a[158:159], v3 offset:14336
    v_mfma_f32_16x16x32_bf16 v[212:215], a[140:143], a[84:87], v[212:215]
    buffer_load_dwordx4 a[40:43], v110, s[16:19], s61 offen sc1
    v_mfma_f32_16x16x32_bf16 v[208:211], a[140:143], a[80:83], v[208:211]
    buffer_load_dwordx4 a[44:47], v111, s[16:19], s61 offen sc1
    v_mfma_f32_16x16x32_bf16 v[208:211], a[136:139], a[64:67], v[208:211]
    s_waitcnt lgkmcnt(4)
    v_mfma_f32_16x16x32_bf16 v[224:227], a[144:147], a[64:67], v[224:227]
    v_mfma_f32_16x16x32_bf16 v[224:227], a[148:151], a[80:83], v[224:227]
    v_mfma_f32_16x16x32_bf16 v[228:231], a[148:151], a[84:87], v[228:231]
    v_mfma_f32_16x16x32_bf16 v[228:231], a[144:147], a[68:71], v[228:231]
    v_mfma_f32_16x16x32_bf16 v[232:235], a[144:147], a[72:75], v[232:235]
    v_mfma_f32_16x16x32_bf16 v[232:235], a[148:151], a[88:91], v[232:235]
    buffer_load_dwordx4 a[48:51], v112, s[16:19], s62 offen sc1
    v_mfma_f32_16x16x32_bf16 v[236:239], a[148:151], a[92:95], v[236:239]
    buffer_load_dwordx4 a[52:55], v113, s[16:19], s62 offen sc1
    v_mfma_f32_16x16x32_bf16 v[236:239], a[144:147], a[76:79], v[236:239]
    s_waitcnt vmcnt(30) lgkmcnt(0)
    s_barrier
    v_mfma_f32_16x16x32_bf16 v[252:255], a[152:155], a[76:79], v[252:255]
    ds_read_b64_tr_b16 a[128:129], v16 offset:32768
    v_mfma_f32_16x16x32_bf16 v[252:255], a[156:159], a[92:95], v[252:255]
    ds_read_b64_tr_b16 a[130:131], v16 offset:34816
    v_mfma_f32_16x16x32_bf16 v[248:251], a[156:159], a[88:91], v[248:251]
    ds_read_b64_tr_b16 a[132:133], v16 offset:36864
    v_mfma_f32_16x16x32_bf16 v[248:251], a[152:155], a[72:75], v[248:251]
    ds_read_b64_tr_b16 a[134:135], v16 offset:38912
    v_mfma_f32_16x16x32_bf16 v[244:247], a[152:155], a[68:71], v[244:247]
    ds_read_b64_tr_b16 a[136:137], v17 offset:32768
    v_mfma_f32_16x16x32_bf16 v[244:247], a[156:159], a[84:87], v[244:247]
    buffer_load_dwordx4 a[56:59], v114, s[16:19], s62 offen sc1
    ds_read_b64_tr_b16 a[138:139], v17 offset:34816
    v_mfma_f32_16x16x32_bf16 v[240:243], a[156:159], a[80:83], v[240:243]
    buffer_load_dwordx4 a[60:63], v115, s[16:19], s62 offen sc1
    ds_read_b64_tr_b16 a[140:141], v17 offset:36864
    v_mfma_f32_16x16x32_bf16 v[240:243], a[152:155], a[64:67], v[240:243]
    s_add_u32 s61, s61, 10240
    s_add_u32 s62, s62, 10240
    s_add_u32 m0, s67, 0
    s_nop 0
    buffer_load_dwordx4 v96, s[24:27], 0 offen offset:0 lds
    buffer_load_dwordx4 v97, s[24:27], 0 offen offset:1024 lds
    buffer_load_dwordx4 v98, s[24:27], 0 offen offset:2048 lds
    buffer_load_dwordx4 v99, s[24:27], 0 offen offset:3072 lds
    ds_read_b64_tr_b16 a[142:143], v17 offset:38912
    s_waitcnt lgkmcnt(4)
    v_mfma_f32_16x16x32_bf16 v[128:131], a[128:131], a[96:99], v[128:131]
    ds_read_b64_tr_b16 a[144:145], v2 offset:32768
    v_mfma_f32_16x16x32_bf16 v[128:131], a[132:135], a[112:115], v[128:131]
    ds_read_b64_tr_b16 a[146:147], v2 offset:34816
    v_mfma_f32_16x16x32_bf16 v[132:135], a[132:135], a[116:119], v[132:135]
    v_mfma_f32_16x16x32_bf16 v[132:135], a[128:131], a[100:103], v[132:135]
    ds_read_b64_tr_b16 a[148:149], v2 offset:36864
    v_mfma_f32_16x16x32_bf16 v[136:139], a[128:131], a[104:107], v[136:139]
    ds_read_b64_tr_b16 a[150:151], v2 offset:38912
    s_add_u32 m0, s65, 65536
    v_mfma_f32_16x16x32_bf16 v[136:139], a[132:135], a[120:123], v[136:139]
    buffer_load_dwordx4 v100, s[20:23], s63 offen offset:0 lds
    v_mfma_f32_16x16x32_bf16 v[140:143], a[132:135], a[124:127], v[140:143]
    buffer_load_dwordx4 v101, s[20:23], s63 offen offset:1024 lds
    v_mfma_f32_16x16x32_bf16 v[140:143], a[128:131], a[108:111], v[140:143]
    s_waitcnt lgkmcnt(4)
    v_mfma_f32_16x16x32_bf16 v[156:159], a[136:139], a[108:111], v[156:159]
    ds_read_b64_tr_b16 a[152:153], v3 offset:32768
    v_mfma_f32_16x16x32_bf16 v[156:159], a[140:143], a[124:127], v[156:159]
    ds_read_b64_tr_b16 a[154:155], v3 offset:34816
    v_mfma_f32_16x16x32_bf16 v[152:155], a[140:143], a[120:123], v[152:155]
    v_mfma_f32_16x16x32_bf16 v[152:155], a[136:139], a[104:107], v[152:155]
    ds_read_b64_tr_b16 a[156:157], v3 offset:36864
    v_mfma_f32_16x16x32_bf16 v[148:151], a[136:139], a[100:103], v[148:151]
    ds_read_b64_tr_b16 a[158:159], v3 offset:38912
    v_mfma_f32_16x16x32_bf16 v[148:151], a[140:143], a[116:119], v[148:151]
    buffer_load_dwordx4 v102, s[20:23], s63 offen offset:2048 lds
    v_mfma_f32_16x16x32_bf16 v[144:147], a[140:143], a[112:115], v[144:147]
    buffer_load_dwordx4 v103, s[20:23], s63 offen offset:3072 lds
    v_mfma_f32_16x16x32_bf16 v[144:147], a[136:139], a[96:99], v[144:147]
    s_waitcnt lgkmcnt(4)
    v_mfma_f32_16x16x32_bf16 v[160:163], a[144:147], a[96:99], v[160:163]
    ds_read_b64_tr_b16 a[128:129], v16 offset:40960
    v_mfma_f32_16x16x32_bf16 v[160:163], a[148:151], a[112:115], v[160:163]
    ds_read_b64_tr_b16 a[130:131], v16 offset:43008
    v_mfma_f32_16x16x32_bf16 v[164:167], a[148:151], a[116:119], v[164:167]
    v_mfma_f32_16x16x32_bf16 v[164:167], a[144:147], a[100:103], v[164:167]
    ds_read_b64_tr_b16 a[132:133], v16 offset:45056
    v_mfma_f32_16x16x32_bf16 v[168:171], a[144:147], a[104:107], v[168:171]
    ds_read_b64_tr_b16 a[134:135], v16 offset:47104
    s_add_u32 m0, s65, 73728
    v_mfma_f32_16x16x32_bf16 v[168:171], a[148:151], a[120:123], v[168:171]
    buffer_load_dwordx4 v104, s[36:39], s64 offen offset:0 lds
    v_mfma_f32_16x16x32_bf16 v[172:175], a[148:151], a[124:127], v[172:175]
    buffer_load_dwordx4 v105, s[36:39], s64 offen offset:1024 lds
    v_mfma_f32_16x16x32_bf16 v[172:175], a[144:147], a[108:111], v[172:175]
    s_waitcnt lgkmcnt(4)
    v_mfma_f32_16x16x32_bf16 v[188:191], a[152:155], a[108:111], v[188:191]
    ds_read_b64_tr_b16 a[136:137], v17 offset:40960
    v_mfma_f32_16x16x32_bf16 v[188:191], a[156:159], a[124:127], v[188:191]
    ds_read_b64_tr_b16 a[138:139], v17 offset:43008
    v_mfma_f32_16x16x32_bf16 v[184:187], a[156:159], a[120:123], v[184:187]
    v_mfma_f32_16x16x32_bf16 v[184:187], a[152:155], a[104:107], v[184:187]
    ds_read_b64_tr_b16 a[140:141], v17 offset:45056
    v_mfma_f32_16x16x32_bf16 v[180:183], a[152:155], a[100:103], v[180:183]
    ds_read_b64_tr_b16 a[142:143], v17 offset:47104
    v_mfma_f32_16x16x32_bf16 v[180:183], a[156:159], a[116:119], v[180:183]
    buffer_load_dwordx4 v106, s[36:39], s64 offen offset:2048 lds
    v_mfma_f32_16x16x32_bf16 v[176:179], a[156:159], a[112:115], v[176:179]
    buffer_load_dwordx4 v107, s[36:39], s64 offen offset:3072 lds
    v_mfma_f32_16x16x32_bf16 v[176:179], a[152:155], a[96:99], v[176:179]
    s_waitcnt lgkmcnt(4)
    v_mfma_f32_16x16x32_bf16 v[192:195], a[128:131], a[96:99], v[192:195]
    ds_read_b64_tr_b16 a[144:145], v2 offset:40960
    v_mfma_f32_16x16x32_bf16 v[192:195], a[132:135], a[112:115], v[192:195]
    ds_read_b64_tr_b16 a[146:147], v2 offset:43008
    v_mfma_f32_16x16x32_bf16 v[196:199], a[132:135], a[116:119], v[196:199]
    v_mfma_f32_16x16x32_bf16 v[196:199], a[128:131], a[100:103], v[196:199]
    ds_read_b64_tr_b16 a[148:149], v2 offset:45056
    v_mfma_f32_16x16x32_bf16 v[200:203], a[128:131], a[104:107], v[200:203]
    ds_read_b64_tr_b16 a[150:151], v2 offset:47104
    v_mfma_f32_16x16x32_bf16 v[200:203], a[132:135], a[120:123], v[200:203]
    buffer_load_dwordx4 a[64:67], v108, s[16:19], s61 offen sc1
    v_mfma_f32_16x16x32_bf16 v[204:207], a[132:135], a[124:127], v[204:207]
    buffer_load_dwordx4 a[68:71], v109, s[16:19], s61 offen sc1
    s_add_u32 s63, s63, 131072
    v_mfma_f32_16x16x32_bf16 v[204:207], a[128:131], a[108:111], v[204:207]
    s_add_u32 s64, s64, s47
    s_waitcnt lgkmcnt(4)
    v_mfma_f32_16x16x32_bf16 v[220:223], a[136:139], a[108:111], v[220:223]
    ds_read_b64_tr_b16 a[152:153], v3 offset:40960
    v_mfma_f32_16x16x32_bf16 v[220:223], a[140:143], a[124:127], v[220:223]
    ds_read_b64_tr_b16 a[154:155], v3 offset:43008
    v_mfma_f32_16x16x32_bf16 v[216:219], a[140:143], a[120:123], v[216:219]
    v_mfma_f32_16x16x32_bf16 v[216:219], a[136:139], a[104:107], v[216:219]
    ds_read_b64_tr_b16 a[156:157], v3 offset:45056
    v_mfma_f32_16x16x32_bf16 v[212:215], a[136:139], a[100:103], v[212:215]
    ds_read_b64_tr_b16 a[158:159], v3 offset:47104
    v_mfma_f32_16x16x32_bf16 v[212:215], a[140:143], a[116:119], v[212:215]
    buffer_load_dwordx4 a[72:75], v110, s[16:19], s61 offen sc1
    v_mfma_f32_16x16x32_bf16 v[208:211], a[140:143], a[112:115], v[208:211]
    buffer_load_dwordx4 a[76:79], v111, s[16:19], s61 offen sc1
    v_mfma_f32_16x16x32_bf16 v[208:211], a[136:139], a[96:99], v[208:211]
    s_waitcnt lgkmcnt(4)
    v_mfma_f32_16x16x32_bf16 v[224:227], a[144:147], a[96:99], v[224:227]
    v_mfma_f32_16x16x32_bf16 v[224:227], a[148:151], a[112:115], v[224:227]
    v_mfma_f32_16x16x32_bf16 v[228:231], a[148:151], a[116:119], v[228:231]
    v_mfma_f32_16x16x32_bf16 v[228:231], a[144:147], a[100:103], v[228:231]
    v_mfma_f32_16x16x32_bf16 v[232:235], a[144:147], a[104:107], v[232:235]
    v_mfma_f32_16x16x32_bf16 v[232:235], a[148:151], a[120:123], v[232:235]
    buffer_load_dwordx4 a[80:83], v112, s[16:19], s62 offen sc1
    v_mfma_f32_16x16x32_bf16 v[236:239], a[148:151], a[124:127], v[236:239]
    buffer_load_dwordx4 a[84:87], v113, s[16:19], s62 offen sc1
    v_mfma_f32_16x16x32_bf16 v[236:239], a[144:147], a[108:111], v[236:239]
    s_waitcnt vmcnt(34) lgkmcnt(0)
    s_barrier
    v_mfma_f32_16x16x32_bf16 v[252:255], a[152:155], a[108:111], v[252:255]
    ds_read_b64_tr_b16 a[128:129], v12 offset:0
    v_mfma_f32_16x16x32_bf16 v[252:255], a[156:159], a[124:127], v[252:255]
    ds_read_b64_tr_b16 a[130:131], v12 offset:2048
    v_mfma_f32_16x16x32_bf16 v[248:251], a[156:159], a[120:123], v[248:251]
    ds_read_b64_tr_b16 a[132:133], v12 offset:4096
    v_mfma_f32_16x16x32_bf16 v[248:251], a[152:155], a[104:107], v[248:251]
    ds_read_b64_tr_b16 a[134:135], v12 offset:6144
    v_mfma_f32_16x16x32_bf16 v[244:247], a[152:155], a[100:103], v[244:247]
    ds_read_b64_tr_b16 a[136:137], v13 offset:0
    v_mfma_f32_16x16x32_bf16 v[244:247], a[156:159], a[116:119], v[244:247]
    buffer_load_dwordx4 a[88:91], v114, s[16:19], s62 offen sc1
    ds_read_b64_tr_b16 a[138:139], v13 offset:2048
    v_mfma_f32_16x16x32_bf16 v[240:243], a[156:159], a[112:115], v[240:243]
    buffer_load_dwordx4 a[92:95], v115, s[16:19], s62 offen sc1
    ds_read_b64_tr_b16 a[140:141], v13 offset:4096
    v_mfma_f32_16x16x32_bf16 v[240:243], a[152:155], a[96:99], v[240:243]
    s_add_u32 s61, s61, 10240
    s_add_u32 s62, s62, 10240
    s_add_u32 m0, s67, 4096
    s_nop 0
    buffer_load_dwordx4 v96, s[24:27], s50 offen offset:0 lds
    buffer_load_dwordx4 v97, s[24:27], s50 offen offset:1024 lds
    buffer_load_dwordx4 v98, s[24:27], s50 offen offset:2048 lds
    buffer_load_dwordx4 v99, s[24:27], s50 offen offset:3072 lds
    ds_read_b64_tr_b16 a[142:143], v13 offset:6144
    s_waitcnt lgkmcnt(4)
.p2align 6
L_p3_loop:
    v_mfma_f32_16x16x32_bf16 v[128:131], a[128:131], a[0:3], v[128:131]
    ds_read_b64_tr_b16 a[144:145], v14 offset:0
    v_mfma_f32_16x16x32_bf16 v[128:131], a[132:135], a[16:19], v[128:131]
    ds_read_b64_tr_b16 a[146:147], v14 offset:2048
    v_mfma_f32_16x16x32_bf16 v[132:135], a[132:135], a[20:23], v[132:135]
    v_mfma_f32_16x16x32_bf16 v[132:135], a[128:131], a[4:7], v[132:135]
    ds_read_b64_tr_b16 a[148:149], v14 offset:4096
    v_mfma_f32_16x16x32_bf16 v[136:139], a[128:131], a[8:11], v[136:139]
    ds_read_b64_tr_b16 a[150:151], v14 offset:6144
    s_add_u32 m0, s65, 98304
    v_mfma_f32_16x16x32_bf16 v[136:139], a[132:135], a[24:27], v[136:139]
    buffer_load_dwordx4 v100, s[20:23], s63 offen offset:0 lds
    v_mfma_f32_16x16x32_bf16 v[140:143], a[132:135], a[28:31], v[140:143]
    buffer_load_dwordx4 v101, s[20:23], s63 offen offset:1024 lds
    v_mfma_f32_16x16x32_bf16 v[140:143], a[128:131], a[12:15], v[140:143]
    s_waitcnt lgkmcnt(4)
    v_mfma_f32_16x16x32_bf16 v[156:159], a[136:139], a[12:15], v[156:159]
    ds_read_b64_tr_b16 a[152:153], v15 offset:0
    v_mfma_f32_16x16x32_bf16 v[156:159], a[140:143], a[28:31], v[156:159]
    ds_read_b64_tr_b16 a[154:155], v15 offset:2048
    v_mfma_f32_16x16x32_bf16 v[152:155], a[140:143], a[24:27], v[152:155]
    v_mfma_f32_16x16x32_bf16 v[152:155], a[136:139], a[8:11], v[152:155]
    ds_read_b64_tr_b16 a[156:157], v15 offset:4096
    v_mfma_f32_16x16x32_bf16 v[148:151], a[136:139], a[4:7], v[148:151]
    ds_read_b64_tr_b16 a[158:159], v15 offset:6144
    v_mfma_f32_16x16x32_bf16 v[148:151], a[140:143], a[20:23], v[148:151]
    buffer_load_dwordx4 v102, s[20:23], s63 offen offset:2048 lds
    v_mfma_f32_16x16x32_bf16 v[144:147], a[140:143], a[16:19], v[144:147]
    buffer_load_dwordx4 v103, s[20:23], s63 offen offset:3072 lds
    v_mfma_f32_16x16x32_bf16 v[144:147], a[136:139], a[0:3], v[144:147]
    s_waitcnt lgkmcnt(4)
    v_mfma_f32_16x16x32_bf16 v[160:163], a[144:147], a[0:3], v[160:163]
    ds_read_b64_tr_b16 a[128:129], v12 offset:8192
    v_mfma_f32_16x16x32_bf16 v[160:163], a[148:151], a[16:19], v[160:163]
    ds_read_b64_tr_b16 a[130:131], v12 offset:10240
    v_mfma_f32_16x16x32_bf16 v[164:167], a[148:151], a[20:23], v[164:167]
    v_mfma_f32_16x16x32_bf16 v[164:167], a[144:147], a[4:7], v[164:167]
    ds_read_b64_tr_b16 a[132:133], v12 offset:12288
    v_mfma_f32_16x16x32_bf16 v[168:171], a[144:147], a[8:11], v[168:171]
    ds_read_b64_tr_b16 a[134:135], v12 offset:14336
    s_add_u32 m0, s65, 106496
    v_mfma_f32_16x16x32_bf16 v[168:171], a[148:151], a[24:27], v[168:171]
    buffer_load_dwordx4 v104, s[36:39], s64 offen offset:0 lds
    v_mfma_f32_16x16x32_bf16 v[172:175], a[148:151], a[28:31], v[172:175]
    buffer_load_dwordx4 v105, s[36:39], s64 offen offset:1024 lds
    v_mfma_f32_16x16x32_bf16 v[172:175], a[144:147], a[12:15], v[172:175]
    s_waitcnt lgkmcnt(4)
    v_mfma_f32_16x16x32_bf16 v[188:191], a[152:155], a[12:15], v[188:191]
    ds_read_b64_tr_b16 a[136:137], v13 offset:8192
    v_mfma_f32_16x16x32_bf16 v[188:191], a[156:159], a[28:31], v[188:191]
    ds_read_b64_tr_b16 a[138:139], v13 offset:10240
    v_mfma_f32_16x16x32_bf16 v[184:187], a[156:159], a[24:27], v[184:187]
    v_mfma_f32_16x16x32_bf16 v[184:187], a[152:155], a[8:11], v[184:187]
    ds_read_b64_tr_b16 a[140:141], v13 offset:12288
    v_mfma_f32_16x16x32_bf16 v[180:183], a[152:155], a[4:7], v[180:183]
    ds_read_b64_tr_b16 a[142:143], v13 offset:14336
    v_mfma_f32_16x16x32_bf16 v[180:183], a[156:159], a[20:23], v[180:183]
    buffer_load_dwordx4 v106, s[36:39], s64 offen offset:2048 lds
    v_mfma_f32_16x16x32_bf16 v[176:179], a[156:159], a[16:19], v[176:179]
    buffer_load_dwordx4 v107, s[36:39], s64 offen offset:3072 lds
    v_mfma_f32_16x16x32_bf16 v[176:179], a[152:155], a[0:3], v[176:179]
    s_waitcnt lgkmcnt(4)
    v_mfma_f32_16x16x32_bf16 v[192:195], a[128:131], a[0:3], v[192:195]
    ds_read_b64_tr_b16 a[144:145], v14 offset:8192
    v_mfma_f32_16x16x32_bf16 v[192:195], a[132:135], a[16:19], v[192:195]
    ds_read_b64_tr_b16 a[146:147], v14 offset:10240
    v_mfma_f32_16x16x32_bf16 v[196:199], a[132:135], a[20:23], v[196:199]
    v_mfma_f32_16x16x32_bf16 v[196:199], a[128:131], a[4:7], v[196:199]
    ds_read_b64_tr_b16 a[148:149], v14 offset:12288
    v_mfma_f32_16x16x32_bf16 v[200:203], a[128:131], a[8:11], v[200:203]
    ds_read_b64_tr_b16 a[150:151], v14 offset:14336
    v_mfma_f32_16x16x32_bf16 v[200:203], a[132:135], a[24:27], v[200:203]
    buffer_load_dwordx4 a[96:99], v108, s[16:19], s61 offen sc1
    v_mfma_f32_16x16x32_bf16 v[204:207], a[132:135], a[28:31], v[204:207]
    buffer_load_dwordx4 a[100:103], v109, s[16:19], s61 offen sc1
    s_add_u32 s63, s63, 131072
    v_mfma_f32_16x16x32_bf16 v[204:207], a[128:131], a[12:15], v[204:207]
    s_add_u32 s64, s64, s47
    s_waitcnt lgkmcnt(4)
    v_mfma_f32_16x16x32_bf16 v[220:223], a[136:139], a[12:15], v[220:223]
    ds_read_b64_tr_b16 a[152:153], v15 offset:8192
    v_mfma_f32_16x16x32_bf16 v[220:223], a[140:143], a[28:31], v[220:223]
    ds_read_b64_tr_b16 a[154:155], v15 offset:10240
    v_mfma_f32_16x16x32_bf16 v[216:219], a[140:143], a[24:27], v[216:219]
    v_mfma_f32_16x16x32_bf16 v[216:219], a[136:139], a[8:11], v[216:219]
    ds_read_b64_tr_b16 a[156:157], v15 offset:12288
    v_mfma_f32_16x16x32_bf16 v[212:215], a[136:139], a[4:7], v[212:215]
    ds_read_b64_tr_b16 a[158:159], v15 offset:14336
    v_mfma_f32_16x16x32_bf16 v[212:215], a[140:143], a[20:23], v[212:215]
    buffer_load_dwordx4 a[104:107], v110, s[16:19], s61 offen sc1
    v_mfma_f32_16x16x32_bf16 v[208:211], a[140:143], a[16:19], v[208:211]
    buffer_load_dwordx4 a[108:111], v111, s[16:19], s61 offen sc1
    v_mfma_f32_16x16x32_bf16 v[208:211], a[136:139], a[0:3], v[208:211]
    s_waitcnt lgkmcnt(4)
    v_mfma_f32_16x16x32_bf16 v[224:227], a[144:147], a[0:3], v[224:227]
    v_mfma_f32_16x16x32_bf16 v[224:227], a[148:151], a[16:19], v[224:227]
    v_mfma_f32_16x16x32_bf16 v[228:231], a[148:151], a[20:23], v[228:231]
    v_mfma_f32_16x16x32_bf16 v[228:231], a[144:147], a[4:7], v[228:231]
    v_mfma_f32_16x16x32_bf16 v[232:235], a[144:147], a[8:11], v[232:235]
    v_mfma_f32_16x16x32_bf16 v[232:235], a[148:151], a[24:27], v[232:235]
    buffer_load_dwordx4 a[112:115], v112, s[16:19], s62 offen sc1
    v_mfma_f32_16x16x32_bf16 v[236:239], a[148:151], a[28:31], v[236:239]
    buffer_load_dwordx4 a[116:119], v113, s[16:19], s62 offen sc1
    v_mfma_f32_16x16x32_bf16 v[236:239], a[144:147], a[12:15], v[236:239]
    s_waitcnt vmcnt(30) lgkmcnt(0)
    s_barrier
    v_mfma_f32_16x16x32_bf16 v[252:255], a[152:155], a[12:15], v[252:255]
    ds_read_b64_tr_b16 a[128:129], v12 offset:32768
    v_mfma_f32_16x16x32_bf16 v[252:255], a[156:159], a[28:31], v[252:255]
    ds_read_b64_tr_b16 a[130:131], v12 offset:34816
    v_mfma_f32_16x16x32_bf16 v[248:251], a[156:159], a[24:27], v[248:251]
    ds_read_b64_tr_b16 a[132:133], v12 offset:36864
    v_mfma_f32_16x16x32_bf16 v[248:251], a[152:155], a[8:11], v[248:251]
    ds_read_b64_tr_b16 a[134:135], v12 offset:38912
    v_mfma_f32_16x16x32_bf16 v[244:247], a[152:155], a[4:7], v[244:247]
    ds_read_b64_tr_b16 a[136:137], v13 offset:32768
    v_mfma_f32_16x16x32_bf16 v[244:247], a[156:159], a[20:23], v[244:247]
    buffer_load_dwordx4 a[120:123], v114, s[16:19], s62 offen sc1
    ds_read_b64_tr_b16 a[138:139], v13 offset:34816
    v_mfma_f32_16x16x32_bf16 v[240:243], a[156:159], a[16:19], v[240:243]
    buffer_load_dwordx4 a[124:127], v115, s[16:19], s62 offen sc1
    ds_read_b64_tr_b16 a[140:141], v13 offset:36864
    v_mfma_f32_16x16x32_bf16 v[240:243], a[152:155], a[0:3], v[240:243]
    s_add_u32 s61, s61, 10240
    s_add_u32 s62, s62, 10240
    ds_read_b64_tr_b16 a[142:143], v13 offset:38912
    s_waitcnt lgkmcnt(4)
    v_mfma_f32_16x16x32_bf16 v[128:131], a[128:131], a[32:35], v[128:131]
    ds_read_b64_tr_b16 a[144:145], v14 offset:32768
    v_mfma_f32_16x16x32_bf16 v[128:131], a[132:135], a[48:51], v[128:131]
    ds_read_b64_tr_b16 a[146:147], v14 offset:34816
    v_mfma_f32_16x16x32_bf16 v[132:135], a[132:135], a[52:55], v[132:135]
    v_mfma_f32_16x16x32_bf16 v[132:135], a[128:131], a[36:39], v[132:135]
    ds_read_b64_tr_b16 a[148:149], v14 offset:36864
    v_mfma_f32_16x16x32_bf16 v[136:139], a[128:131], a[40:43], v[136:139]
    ds_read_b64_tr_b16 a[150:151], v14 offset:38912
    s_add_u32 m0, s65, 0
    v_mfma_f32_16x16x32_bf16 v[136:139], a[132:135], a[56:59], v[136:139]
    buffer_load_dwordx4 v100, s[20:23], s63 offen offset:0 lds
    v_mfma_f32_16x16x32_bf16 v[140:143], a[132:135], a[60:63], v[140:143]
    buffer_load_dwordx4 v101, s[20:23], s63 offen offset:1024 lds
    v_mfma_f32_16x16x32_bf16 v[140:143], a[128:131], a[44:47], v[140:143]
    s_waitcnt lgkmcnt(4)
    v_mfma_f32_16x16x32_bf16 v[156:159], a[136:139], a[44:47], v[156:159]
    ds_read_b64_tr_b16 a[152:153], v15 offset:32768
    v_mfma_f32_16x16x32_bf16 v[156:159], a[140:143], a[60:63], v[156:159]
    ds_read_b64_tr_b16 a[154:155], v15 offset:34816
    v_mfma_f32_16x16x32_bf16 v[152:155], a[140:143], a[56:59], v[152:155]
    v_mfma_f32_16x16x32_bf16 v[152:155], a[136:139], a[40:43], v[152:155]
    ds_read_b64_tr_b16 a[156:157], v15 offset:36864
    v_mfma_f32_16x16x32_bf16 v[148:151], a[136:139], a[36:39], v[148:151]
    ds_read_b64_tr_b16 a[158:159], v15 offset:38912
    v_mfma_f32_16x16x32_bf16 v[148:151], a[140:143], a[52:55], v[148:151]
    buffer_load_dwordx4 v102, s[20:23], s63 offen offset:2048 lds
    v_mfma_f32_16x16x32_bf16 v[144:147], a[140:143], a[48:51], v[144:147]
    buffer_load_dwordx4 v103, s[20:23], s63 offen offset:3072 lds
    v_mfma_f32_16x16x32_bf16 v[144:147], a[136:139], a[32:35], v[144:147]
    s_waitcnt lgkmcnt(4)
    v_mfma_f32_16x16x32_bf16 v[160:163], a[144:147], a[32:35], v[160:163]
    ds_read_b64_tr_b16 a[128:129], v12 offset:40960
    v_mfma_f32_16x16x32_bf16 v[160:163], a[148:151], a[48:51], v[160:163]
    ds_read_b64_tr_b16 a[130:131], v12 offset:43008
    v_mfma_f32_16x16x32_bf16 v[164:167], a[148:151], a[52:55], v[164:167]
    v_mfma_f32_16x16x32_bf16 v[164:167], a[144:147], a[36:39], v[164:167]
    ds_read_b64_tr_b16 a[132:133], v12 offset:45056
    v_mfma_f32_16x16x32_bf16 v[168:171], a[144:147], a[40:43], v[168:171]
    ds_read_b64_tr_b16 a[134:135], v12 offset:47104
    s_add_u32 m0, s65, 8192
    v_mfma_f32_16x16x32_bf16 v[168:171], a[148:151], a[56:59], v[168:171]
    buffer_load_dwordx4 v104, s[36:39], s64 offen offset:0 lds
    v_mfma_f32_16x16x32_bf16 v[172:175], a[148:151], a[60:63], v[172:175]
    buffer_load_dwordx4 v105, s[36:39], s64 offen offset:1024 lds
    v_mfma_f32_16x16x32_bf16 v[172:175], a[144:147], a[44:47], v[172:175]
    s_waitcnt lgkmcnt(4)
    v_mfma_f32_16x16x32_bf16 v[188:191], a[152:155], a[44:47], v[188:191]
    ds_read_b64_tr_b16 a[136:137], v13 offset:40960
    v_mfma_f32_16x16x32_bf16 v[188:191], a[156:159], a[60:63], v[188:191]
    ds_read_b64_tr_b16 a[138:139], v13 offset:43008
    v_mfma_f32_16x16x32_bf16 v[184:187], a[156:159], a[56:59], v[184:187]
    v_mfma_f32_16x16x32_bf16 v[184:187], a[152:155], a[40:43], v[184:187]
    ds_read_b64_tr_b16 a[140:141], v13 offset:45056
    v_mfma_f32_16x16x32_bf16 v[180:183], a[152:155], a[36:39], v[180:183]
    ds_read_b64_tr_b16 a[142:143], v13 offset:47104
    v_mfma_f32_16x16x32_bf16 v[180:183], a[156:159], a[52:55], v[180:183]
    buffer_load_dwordx4 v106, s[36:39], s64 offen offset:2048 lds
    v_mfma_f32_16x16x32_bf16 v[176:179], a[156:159], a[48:51], v[176:179]
    buffer_load_dwordx4 v107, s[36:39], s64 offen offset:3072 lds
    v_mfma_f32_16x16x32_bf16 v[176:179], a[152:155], a[32:35], v[176:179]
    s_waitcnt lgkmcnt(4)
    v_mfma_f32_16x16x32_bf16 v[192:195], a[128:131], a[32:35], v[192:195]
    ds_read_b64_tr_b16 a[144:145], v14 offset:40960
    v_mfma_f32_16x16x32_bf16 v[192:195], a[132:135], a[48:51], v[192:195]
    ds_read_b64_tr_b16 a[146:147], v14 offset:43008
    v_mfma_f32_16x16x32_bf16 v[196:199], a[132:135], a[52:55], v[196:199]
    v_mfma_f32_16x16x32_bf16 v[196:199], a[128:131], a[36:39], v[196:199]
    ds_read_b64_tr_b16 a[148:149], v14 offset:45056
    v_mfma_f32_16x16x32_bf16 v[200:203], a[128:131], a[40:43], v[200:203]
    ds_read_b64_tr_b16 a[150:151], v14 offset:47104
    v_mfma_f32_16x16x32_bf16 v[200:203], a[132:135], a[56:59], v[200:203]
    buffer_load_dwordx4 a[0:3], v108, s[16:19], s61 offen sc1
    v_mfma_f32_16x16x32_bf16 v[204:207], a[132:135], a[60:63], v[204:207]
    buffer_load_dwordx4 a[4:7], v109, s[16:19], s61 offen sc1
    s_add_u32 s63, s63, 131072
    v_mfma_f32_16x16x32_bf16 v[204:207], a[128:131], a[44:47], v[204:207]
    s_add_u32 s64, s64, s47
    s_waitcnt lgkmcnt(4)
    v_mfma_f32_16x16x32_bf16 v[220:223], a[136:139], a[44:47], v[220:223]
    ds_read_b64_tr_b16 a[152:153], v15 offset:40960
    v_mfma_f32_16x16x32_bf16 v[220:223], a[140:143], a[60:63], v[220:223]
    ds_read_b64_tr_b16 a[154:155], v15 offset:43008
    v_mfma_f32_16x16x32_bf16 v[216:219], a[140:143], a[56:59], v[216:219]
    v_mfma_f32_16x16x32_bf16 v[216:219], a[136:139], a[40:43], v[216:219]
    ds_read_b64_tr_b16 a[156:157], v15 offset:45056
    v_mfma_f32_16x16x32_bf16 v[212:215], a[136:139], a[36:39], v[212:215]
    ds_read_b64_tr_b16 a[158:159], v15 offset:47104
    v_mfma_f32_16x16x32_bf16 v[212:215], a[140:143], a[52:55], v[212:215]
    buffer_load_dwordx4 a[8:11], v110, s[16:19], s61 offen sc1
    v_mfma_f32_16x16x32_bf16 v[208:211], a[140:143], a[48:51], v[208:211]
    buffer_load_dwordx4 a[12:15], v111, s[16:19], s61 offen sc1
    v_mfma_f32_16x16x32_bf16 v[208:211], a[136:139], a[32:35], v[208:211]
    s_waitcnt lgkmcnt(4)
    v_mfma_f32_16x16x32_bf16 v[224:227], a[144:147], a[32:35], v[224:227]
    v_mfma_f32_16x16x32_bf16 v[224:227], a[148:151], a[48:51], v[224:227]
    v_mfma_f32_16x16x32_bf16 v[228:231], a[148:151], a[52:55], v[228:231]
    v_mfma_f32_16x16x32_bf16 v[228:231], a[144:147], a[36:39], v[228:231]
    v_mfma_f32_16x16x32_bf16 v[232:235], a[144:147], a[40:43], v[232:235]
    v_mfma_f32_16x16x32_bf16 v[232:235], a[148:151], a[56:59], v[232:235]
    buffer_load_dwordx4 a[16:19], v112, s[16:19], s62 offen sc1
    v_mfma_f32_16x16x32_bf16 v[236:239], a[148:151], a[60:63], v[236:239]
    buffer_load_dwordx4 a[20:23], v113, s[16:19], s62 offen sc1
    v_mfma_f32_16x16x32_bf16 v[236:239], a[144:147], a[44:47], v[236:239]
    s_waitcnt vmcnt(30) lgkmcnt(0)
    s_barrier
    v_mfma_f32_16x16x32_bf16 v[252:255], a[152:155], a[44:47], v[252:255]
    ds_read_b64_tr_b16 a[128:129], v16 offset:0
    v_mfma_f32_16x16x32_bf16 v[252:255], a[156:159], a[60:63], v[252:255]
    ds_read_b64_tr_b16 a[130:131], v16 offset:2048
    v_mfma_f32_16x16x32_bf16 v[248:251], a[156:159], a[56:59], v[248:251]
    ds_read_b64_tr_b16 a[132:133], v16 offset:4096
    v_mfma_f32_16x16x32_bf16 v[248:251], a[152:155], a[40:43], v[248:251]
    ds_read_b64_tr_b16 a[134:135], v16 offset:6144
    v_mfma_f32_16x16x32_bf16 v[244:247], a[152:155], a[36:39], v[244:247]
    ds_read_b64_tr_b16 a[136:137], v17 offset:0
    v_mfma_f32_16x16x32_bf16 v[244:247], a[156:159], a[52:55], v[244:247]
    buffer_load_dwordx4 a[24:27], v114, s[16:19], s62 offen sc1
    ds_read_b64_tr_b16 a[138:139], v17 offset:2048
    v_mfma_f32_16x16x32_bf16 v[240:243], a[156:159], a[48:51], v[240:243]
    buffer_load_dwordx4 a[28:31], v115, s[16:19], s62 offen sc1
    ds_read_b64_tr_b16 a[140:141], v17 offset:4096
    v_mfma_f32_16x16x32_bf16 v[240:243], a[152:155], a[32:35], v[240:243]
    s_add_u32 s61, s61, 10240
    s_add_u32 s62, s62, 10240
    ds_read_b64_tr_b16 a[142:143], v17 offset:6144
    s_waitcnt lgkmcnt(4)
    v_mfma_f32_16x16x32_bf16 v[128:131], a[128:131], a[64:67], v[128:131]
    ds_read_b64_tr_b16 a[144:145], v2 offset:0
    v_mfma_f32_16x16x32_bf16 v[128:131], a[132:135], a[80:83], v[128:131]
    ds_read_b64_tr_b16 a[146:147], v2 offset:2048
    v_mfma_f32_16x16x32_bf16 v[132:135], a[132:135], a[84:87], v[132:135]
    v_mfma_f32_16x16x32_bf16 v[132:135], a[128:131], a[68:71], v[132:135]
    ds_read_b64_tr_b16 a[148:149], v2 offset:4096
    v_mfma_f32_16x16x32_bf16 v[136:139], a[128:131], a[72:75], v[136:139]
    ds_read_b64_tr_b16 a[150:151], v2 offset:6144
    s_add_u32 m0, s65, 32768
    v_mfma_f32_16x16x32_bf16 v[136:139], a[132:135], a[88:91], v[136:139]
    buffer_load_dwordx4 v100, s[20:23], s63 offen offset:0 lds
    v_mfma_f32_16x16x32_bf16 v[140:143], a[132:135], a[92:95], v[140:143]
    buffer_load_dwordx4 v101, s[20:23], s63 offen offset:1024 lds
    v_mfma_f32_16x16x32_bf16 v[140:143], a[128:131], a[76:79], v[140:143]
    s_waitcnt lgkmcnt(4)
    v_mfma_f32_16x16x32_bf16 v[156:159], a[136:139], a[76:79], v[156:159]
    ds_read_b64_tr_b16 a[152:153], v3 offset:0
    v_mfma_f32_16x16x32_bf16 v[156:159], a[140:143], a[92:95], v[156:159]
    ds_read_b64_tr_b16 a[154:155], v3 offset:2048
    v_mfma_f32_16x16x32_bf16 v[152:155], a[140:143], a[88:91], v[152:155]
    v_mfma_f32_16x16x32_bf16 v[152:155], a[136:139], a[72:75], v[152:155]
    ds_read_b64_tr_b16 a[156:157], v3 offset:4096
    v_mfma_f32_16x16x32_bf16 v[148:151], a[136:139], a[68:71], v[148:151]
    ds_read_b64_tr_b16 a[158:159], v3 offset:6144
    v_mfma_f32_16x16x32_bf16 v[148:151], a[140:143], a[84:87], v[148:151]
    buffer_load_dwordx4 v102, s[20:23], s63 offen offset:2048 lds
    v_mfma_f32_16x16x32_bf16 v[144:147], a[140:143], a[80:83], v[144:147]
    buffer_load_dwordx4 v103, s[20:23], s63 offen offset:3072 lds
    v_mfma_f32_16x16x32_bf16 v[144:147], a[136:139], a[64:67], v[144:147]
    s_waitcnt lgkmcnt(4)
    v_mfma_f32_16x16x32_bf16 v[160:163], a[144:147], a[64:67], v[160:163]
    ds_read_b64_tr_b16 a[128:129], v16 offset:8192
    v_mfma_f32_16x16x32_bf16 v[160:163], a[148:151], a[80:83], v[160:163]
    ds_read_b64_tr_b16 a[130:131], v16 offset:10240
    v_mfma_f32_16x16x32_bf16 v[164:167], a[148:151], a[84:87], v[164:167]
    v_mfma_f32_16x16x32_bf16 v[164:167], a[144:147], a[68:71], v[164:167]
    ds_read_b64_tr_b16 a[132:133], v16 offset:12288
    v_mfma_f32_16x16x32_bf16 v[168:171], a[144:147], a[72:75], v[168:171]
    ds_read_b64_tr_b16 a[134:135], v16 offset:14336
    s_add_u32 m0, s65, 40960
    v_mfma_f32_16x16x32_bf16 v[168:171], a[148:151], a[88:91], v[168:171]
    buffer_load_dwordx4 v104, s[36:39], s64 offen offset:0 lds
    v_mfma_f32_16x16x32_bf16 v[172:175], a[148:151], a[92:95], v[172:175]
    buffer_load_dwordx4 v105, s[36:39], s64 offen offset:1024 lds
    v_mfma_f32_16x16x32_bf16 v[172:175], a[144:147], a[76:79], v[172:175]
    s_waitcnt lgkmcnt(4)
    v_mfma_f32_16x16x32_bf16 v[188:191], a[152:155], a[76:79], v[188:191]
    ds_read_b64_tr_b16 a[136:137], v17 offset:8192
    v_mfma_f32_16x16x32_bf16 v[188:191], a[156:159], a[92:95], v[188:191]
    ds_read_b64_tr_b16 a[138:139], v17 offset:10240
    v_mfma_f32_16x16x32_bf16 v[184:187], a[156:159], a[88:91], v[184:187]
    v_mfma_f32_16x16x32_bf16 v[184:187], a[152:155], a[72:75], v[184:187]
    ds_read_b64_tr_b16 a[140:141], v17 offset:12288
    v_mfma_f32_16x16x32_bf16 v[180:183], a[152:155], a[68:71], v[180:183]
    ds_read_b64_tr_b16 a[142:143], v17 offset:14336
    v_mfma_f32_16x16x32_bf16 v[180:183], a[156:159], a[84:87], v[180:183]
    buffer_load_dwordx4 v106, s[36:39], s64 offen offset:2048 lds
    v_mfma_f32_16x16x32_bf16 v[176:179], a[156:159], a[80:83], v[176:179]
    buffer_load_dwordx4 v107, s[36:39], s64 offen offset:3072 lds
    v_mfma_f32_16x16x32_bf16 v[176:179], a[152:155], a[64:67], v[176:179]
    s_waitcnt lgkmcnt(4)
    v_mfma_f32_16x16x32_bf16 v[192:195], a[128:131], a[64:67], v[192:195]
    ds_read_b64_tr_b16 a[144:145], v2 offset:8192
    v_mfma_f32_16x16x32_bf16 v[192:195], a[132:135], a[80:83], v[192:195]
    ds_read_b64_tr_b16 a[146:147], v2 offset:10240
    v_mfma_f32_16x16x32_bf16 v[196:199], a[132:135], a[84:87], v[196:199]
    v_mfma_f32_16x16x32_bf16 v[196:199], a[128:131], a[68:71], v[196:199]
    ds_read_b64_tr_b16 a[148:149], v2 offset:12288
    v_mfma_f32_16x16x32_bf16 v[200:203], a[128:131], a[72:75], v[200:203]
    ds_read_b64_tr_b16 a[150:151], v2 offset:14336
    v_mfma_f32_16x16x32_bf16 v[200:203], a[132:135], a[88:91], v[200:203]
    buffer_load_dwordx4 a[32:35], v108, s[16:19], s61 offen sc1
    v_mfma_f32_16x16x32_bf16 v[204:207], a[132:135], a[92:95], v[204:207]
    buffer_load_dwordx4 a[36:39], v109, s[16:19], s61 offen sc1
    s_add_u32 s63, s63, 131072
    v_mfma_f32_16x16x32_bf16 v[204:207], a[128:131], a[76:79], v[204:207]
    s_add_u32 s64, s64, s47
    s_waitcnt lgkmcnt(4)
    v_mfma_f32_16x16x32_bf16 v[220:223], a[136:139], a[76:79], v[220:223]
    ds_read_b64_tr_b16 a[152:153], v3 offset:8192
    v_mfma_f32_16x16x32_bf16 v[220:223], a[140:143], a[92:95], v[220:223]
    ds_read_b64_tr_b16 a[154:155], v3 offset:10240
    v_mfma_f32_16x16x32_bf16 v[216:219], a[140:143], a[88:91], v[216:219]
    v_mfma_f32_16x16x32_bf16 v[216:219], a[136:139], a[72:75], v[216:219]
    ds_read_b64_tr_b16 a[156:157], v3 offset:12288
    v_mfma_f32_16x16x32_bf16 v[212:215], a[136:139], a[68:71], v[212:215]
    ds_read_b64_tr_b16 a[158:159], v3 offset:14336
    v_mfma_f32_16x16x32_bf16 v[212:215], a[140:143], a[84:87], v[212:215]
    buffer_load_dwordx4 a[40:43], v110, s[16:19], s61 offen sc1
    v_mfma_f32_16x16x32_bf16 v[208:211], a[140:143], a[80:83], v[208:211]
    buffer_load_dwordx4 a[44:47], v111, s[16:19], s61 offen sc1
    v_mfma_f32_16x16x32_bf16 v[208:211], a[136:139], a[64:67], v[208:211]
    s_waitcnt lgkmcnt(4)
    v_mfma_f32_16x16x32_bf16 v[224:227], a[144:147], a[64:67], v[224:227]
    v_mfma_f32_16x16x32_bf16 v[224:227], a[148:151], a[80:83], v[224:227]
    v_mfma_f32_16x16x32_bf16 v[228:231], a[148:151], a[84:87], v[228:231]
    v_mfma_f32_16x16x32_bf16 v[228:231], a[144:147], a[68:71], v[228:231]
    v_mfma_f32_16x16x32_bf16 v[232:235], a[144:147], a[72:75], v[232:235]
    v_mfma_f32_16x16x32_bf16 v[232:235], a[148:151], a[88:91], v[232:235]
    buffer_load_dwordx4 a[48:51], v112, s[16:19], s62 offen sc1
    v_mfma_f32_16x16x32_bf16 v[236:239], a[148:151], a[92:95], v[236:239]
    buffer_load_dwordx4 a[52:55], v113, s[16:19], s62 offen sc1
    v_mfma_f32_16x16x32_bf16 v[236:239], a[144:147], a[76:79], v[236:239]
    s_waitcnt vmcnt(30) lgkmcnt(0)
    s_barrier
    v_mfma_f32_16x16x32_bf16 v[252:255], a[152:155], a[76:79], v[252:255]
    ds_read_b64_tr_b16 a[128:129], v16 offset:32768
    v_mfma_f32_16x16x32_bf16 v[252:255], a[156:159], a[92:95], v[252:255]
    ds_read_b64_tr_b16 a[130:131], v16 offset:34816
    v_mfma_f32_16x16x32_bf16 v[248:251], a[156:159], a[88:91], v[248:251]
    ds_read_b64_tr_b16 a[132:133], v16 offset:36864
    v_mfma_f32_16x16x32_bf16 v[248:251], a[152:155], a[72:75], v[248:251]
    ds_read_b64_tr_b16 a[134:135], v16 offset:38912
    v_mfma_f32_16x16x32_bf16 v[244:247], a[152:155], a[68:71], v[244:247]
    ds_read_b64_tr_b16 a[136:137], v17 offset:32768
    v_mfma_f32_16x16x32_bf16 v[244:247], a[156:159], a[84:87], v[244:247]
    buffer_load_dwordx4 a[56:59], v114, s[16:19], s62 offen sc1
    ds_read_b64_tr_b16 a[138:139], v17 offset:34816
    v_mfma_f32_16x16x32_bf16 v[240:243], a[156:159], a[80:83], v[240:243]
    buffer_load_dwordx4 a[60:63], v115, s[16:19], s62 offen sc1
    ds_read_b64_tr_b16 a[140:141], v17 offset:36864
    v_mfma_f32_16x16x32_bf16 v[240:243], a[152:155], a[64:67], v[240:243]
    s_add_u32 s61, s61, 10240
    s_add_u32 s62, s62, 10240
    ds_read_b64_tr_b16 a[142:143], v17 offset:38912
    s_waitcnt lgkmcnt(4)
    v_mfma_f32_16x16x32_bf16 v[128:131], a[128:131], a[96:99], v[128:131]
    ds_read_b64_tr_b16 a[144:145], v2 offset:32768
    v_mfma_f32_16x16x32_bf16 v[128:131], a[132:135], a[112:115], v[128:131]
    ds_read_b64_tr_b16 a[146:147], v2 offset:34816
    v_mfma_f32_16x16x32_bf16 v[132:135], a[132:135], a[116:119], v[132:135]
    v_mfma_f32_16x16x32_bf16 v[132:135], a[128:131], a[100:103], v[132:135]
    ds_read_b64_tr_b16 a[148:149], v2 offset:36864
    v_mfma_f32_16x16x32_bf16 v[136:139], a[128:131], a[104:107], v[136:139]
    ds_read_b64_tr_b16 a[150:151], v2 offset:38912
    s_add_u32 m0, s65, 65536
    v_mfma_f32_16x16x32_bf16 v[136:139], a[132:135], a[120:123], v[136:139]
    buffer_load_dwordx4 v100, s[20:23], s63 offen offset:0 lds
    v_mfma_f32_16x16x32_bf16 v[140:143], a[132:135], a[124:127], v[140:143]
    buffer_load_dwordx4 v101, s[20:23], s63 offen offset:1024 lds
    v_mfma_f32_16x16x32_bf16 v[140:143], a[128:131], a[108:111], v[140:143]
    s_waitcnt lgkmcnt(4)
    v_mfma_f32_16x16x32_bf16 v[156:159], a[136:139], a[108:111], v[156:159]
    ds_read_b64_tr_b16 a[152:153], v3 offset:32768
    v_mfma_f32_16x16x32_bf16 v[156:159], a[140:143], a[124:127], v[156:159]
    ds_read_b64_tr_b16 a[154:155], v3 offset:34816
    v_mfma_f32_16x16x32_bf16 v[152:155], a[140:143], a[120:123], v[152:155]
    v_mfma_f32_16x16x32_bf16 v[152:155], a[136:139], a[104:107], v[152:155]
    ds_read_b64_tr_b16 a[156:157], v3 offset:36864
    v_mfma_f32_16x16x32_bf16 v[148:151], a[136:139], a[100:103], v[148:151]
    ds_read_b64_tr_b16 a[158:159], v3 offset:38912
    v_mfma_f32_16x16x32_bf16 v[148:151], a[140:143], a[116:119], v[148:151]
    buffer_load_dwordx4 v102, s[20:23], s63 offen offset:2048 lds
    v_mfma_f32_16x16x32_bf16 v[144:147], a[140:143], a[112:115], v[144:147]
    buffer_load_dwordx4 v103, s[20:23], s63 offen offset:3072 lds
    v_mfma_f32_16x16x32_bf16 v[144:147], a[136:139], a[96:99], v[144:147]
    s_waitcnt lgkmcnt(4)
    v_mfma_f32_16x16x32_bf16 v[160:163], a[144:147], a[96:99], v[160:163]
    ds_read_b64_tr_b16 a[128:129], v16 offset:40960
    v_mfma_f32_16x16x32_bf16 v[160:163], a[148:151], a[112:115], v[160:163]
    ds_read_b64_tr_b16 a[130:131], v16 offset:43008
    v_mfma_f32_16x16x32_bf16 v[164:167], a[148:151], a[116:119], v[164:167]
    v_mfma_f32_16x16x32_bf16 v[164:167], a[144:147], a[100:103], v[164:167]
    ds_read_b64_tr_b16 a[132:133], v16 offset:45056
    v_mfma_f32_16x16x32_bf16 v[168:171], a[144:147], a[104:107], v[168:171]
    ds_read_b64_tr_b16 a[134:135], v16 offset:47104
    s_add_u32 m0, s65, 73728
    v_mfma_f32_16x16x32_bf16 v[168:171], a[148:151], a[120:123], v[168:171]
    buffer_load_dwordx4 v104, s[36:39], s64 offen offset:0 lds
    v_mfma_f32_16x16x32_bf16 v[172:175], a[148:151], a[124:127], v[172:175]
    buffer_load_dwordx4 v105, s[36:39], s64 offen offset:1024 lds
    v_mfma_f32_16x16x32_bf16 v[172:175], a[144:147], a[108:111], v[172:175]
    s_waitcnt lgkmcnt(4)
    v_mfma_f32_16x16x32_bf16 v[188:191], a[152:155], a[108:111], v[188:191]
    ds_read_b64_tr_b16 a[136:137], v17 offset:40960
    v_mfma_f32_16x16x32_bf16 v[188:191], a[156:159], a[124:127], v[188:191]
    ds_read_b64_tr_b16 a[138:139], v17 offset:43008
    v_mfma_f32_16x16x32_bf16 v[184:187], a[156:159], a[120:123], v[184:187]
    v_mfma_f32_16x16x32_bf16 v[184:187], a[152:155], a[104:107], v[184:187]
    ds_read_b64_tr_b16 a[140:141], v17 offset:45056
    v_mfma_f32_16x16x32_bf16 v[180:183], a[152:155], a[100:103], v[180:183]
    ds_read_b64_tr_b16 a[142:143], v17 offset:47104
    v_mfma_f32_16x16x32_bf16 v[180:183], a[156:159], a[116:119], v[180:183]
    buffer_load_dwordx4 v106, s[36:39], s64 offen offset:2048 lds
    v_mfma_f32_16x16x32_bf16 v[176:179], a[156:159], a[112:115], v[176:179]
    buffer_load_dwordx4 v107, s[36:39], s64 offen offset:3072 lds
    v_mfma_f32_16x16x32_bf16 v[176:179], a[152:155], a[96:99], v[176:179]
    s_waitcnt lgkmcnt(4)
    v_mfma_f32_16x16x32_bf16 v[192:195], a[128:131], a[96:99], v[192:195]
    ds_read_b64_tr_b16 a[144:145], v2 offset:40960
    v_mfma_f32_16x16x32_bf16 v[192:195], a[132:135], a[112:115], v[192:195]
    ds_read_b64_tr_b16 a[146:147], v2 offset:43008
    v_mfma_f32_16x16x32_bf16 v[196:199], a[132:135], a[116:119], v[196:199]
    v_mfma_f32_16x16x32_bf16 v[196:199], a[128:131], a[100:103], v[196:199]
    ds_read_b64_tr_b16 a[148:149], v2 offset:45056
    v_mfma_f32_16x16x32_bf16 v[200:203], a[128:131], a[104:107], v[200:203]
    ds_read_b64_tr_b16 a[150:151], v2 offset:47104
    v_mfma_f32_16x16x32_bf16 v[200:203], a[132:135], a[120:123], v[200:203]
    buffer_load_dwordx4 a[64:67], v108, s[16:19], s61 offen sc1
    v_mfma_f32_16x16x32_bf16 v[204:207], a[132:135], a[124:127], v[204:207]
    buffer_load_dwordx4 a[68:71], v109, s[16:19], s61 offen sc1
    s_add_u32 s63, s63, 131072
    v_mfma_f32_16x16x32_bf16 v[204:207], a[128:131], a[108:111], v[204:207]
    s_add_u32 s64, s64, s47
    s_waitcnt lgkmcnt(4)
    v_mfma_f32_16x16x32_bf16 v[220:223], a[136:139], a[108:111], v[220:223]
    ds_read_b64_tr_b16 a[152:153], v3 offset:40960
    v_mfma_f32_16x16x32_bf16 v[220:223], a[140:143], a[124:127], v[220:223]
    ds_read_b64_tr_b16 a[154:155], v3 offset:43008
    v_mfma_f32_16x16x32_bf16 v[216:219], a[140:143], a[120:123], v[216:219]
    v_mfma_f32_16x16x32_bf16 v[216:219], a[136:139], a[104:107], v[216:219]
    ds_read_b64_tr_b16 a[156:157], v3 offset:45056
    v_mfma_f32_16x16x32_bf16 v[212:215], a[136:139], a[100:103], v[212:215]
    ds_read_b64_tr_b16 a[158:159], v3 offset:47104
    v_mfma_f32_16x16x32_bf16 v[212:215], a[140:143], a[116:119], v[212:215]
    buffer_load_dwordx4 a[72:75], v110, s[16:19], s61 offen sc1
    v_mfma_f32_16x16x32_bf16 v[208:211], a[140:143], a[112:115], v[208:211]
    buffer_load_dwordx4 a[76:79], v111, s[16:19], s61 offen sc1
    v_mfma_f32_16x16x32_bf16 v[208:211], a[136:139], a[96:99], v[208:211]
    s_waitcnt lgkmcnt(4)
    v_mfma_f32_16x16x32_bf16 v[224:227], a[144:147], a[96:99], v[224:227]
    v_mfma_f32_16x16x32_bf16 v[224:227], a[148:151], a[112:115], v[224:227]
    v_mfma_f32_16x16x32_bf16 v[228:231], a[148:151], a[116:119], v[228:231]
    v_mfma_f32_16x16x32_bf16 v[228:231], a[144:147], a[100:103], v[228:231]
    v_mfma_f32_16x16x32_bf16 v[232:235], a[144:147], a[104:107], v[232:235]
    v_mfma_f32_16x16x32_bf16 v[232:235], a[148:151], a[120:123], v[232:235]
    buffer_load_dwordx4 a[80:83], v112, s[16:19], s62 offen sc1
    v_mfma_f32_16x16x32_bf16 v[236:239], a[148:151], a[124:127], v[236:239]
    buffer_load_dwordx4 a[84:87], v113, s[16:19], s62 offen sc1
    v_mfma_f32_16x16x32_bf16 v[236:239], a[144:147], a[108:111], v[236:239]
    s_waitcnt vmcnt(30) lgkmcnt(0)
    s_barrier
    v_mfma_f32_16x16x32_bf16 v[252:255], a[152:155], a[108:111], v[252:255]
    ds_read_b64_tr_b16 a[128:129], v12 offset:0
    v_mfma_f32_16x16x32_bf16 v[252:255], a[156:159], a[124:127], v[252:255]
    ds_read_b64_tr_b16 a[130:131], v12 offset:2048
    v_mfma_f32_16x16x32_bf16 v[248:251], a[156:159], a[120:123], v[248:251]
    ds_read_b64_tr_b16 a[132:133], v12 offset:4096
    v_mfma_f32_16x16x32_bf16 v[248:251], a[152:155], a[104:107], v[248:251]
    ds_read_b64_tr_b16 a[134:135], v12 offset:6144
    v_mfma_f32_16x16x32_bf16 v[244:247], a[152:155], a[100:103], v[244:247]
    ds_read_b64_tr_b16 a[136:137], v13 offset:0
    v_mfma_f32_16x16x32_bf16 v[244:247], a[156:159], a[116:119], v[244:247]
    buffer_load_dwordx4 a[88:91], v114, s[16:19], s62 offen sc1
    ds_read_b64_tr_b16 a[138:139], v13 offset:2048
    v_mfma_f32_16x16x32_bf16 v[240:243], a[156:159], a[112:115], v[240:243]
    buffer_load_dwordx4 a[92:95], v115, s[16:19], s62 offen sc1
    ds_read_b64_tr_b16 a[140:141], v13 offset:4096
    v_mfma_f32_16x16x32_bf16 v[240:243], a[152:155], a[96:99], v[240:243]
    s_add_u32 s61, s61, 10240
    s_add_u32 s62, s62, 10240
    ds_read_b64_tr_b16 a[142:143], v13 offset:6144
    s_sub_u32 s66, s66, 1
    s_cmp_lg_u32 s66, 0
    s_waitcnt lgkmcnt(4)
    s_cbranch_scc1 L_p3_loop
L_p3_last:
    v_mfma_f32_16x16x32_bf16 v[128:131], a[128:131], a[0:3], v[128:131]
    ds_read_b64_tr_b16 a[144:145], v14 offset:0
    v_mfma_f32_16x16x32_bf16 v[128:131], a[132:135], a[16:19], v[128:131]
    ds_read_b64_tr_b16 a[146:147], v14 offset:2048
    v_mfma_f32_16x16x32_bf16 v[132:135], a[132:135], a[20:23], v[132:135]
    v_mfma_f32_16x16x32_bf16 v[132:135], a[128:131], a[4:7], v[132:135]
    ds_read_b64_tr_b16 a[148:149], v14 offset:4096
    v_mfma_f32_16x16x32_bf16 v[136:139], a[128:131], a[8:11], v[136:139]
    ds_read_b64_tr_b16 a[150:151], v14 offset:6144
    s_add_u32 m0, s65, 98304
    v_mfma_f32_16x16x32_bf16 v[136:139], a[132:135], a[24:27], v[136:139]
    buffer_load_dwordx4 v100, s[20:23], s63 offen offset:0 lds
    v_mfma_f32_16x16x32_bf16 v[140:143], a[132:135], a[28:31], v[140:143]
    buffer_load_dwordx4 v101, s[20:23], s63 offen offset:1024 lds
    v_mfma_f32_16x16x32_bf16 v[140:143], a[128:131], a[12:15], v[140:143]
    s_waitcnt lgkmcnt(4)
    v_and_b32 v24, 15, v0
    v_mfma_f32_16x16x32_bf16 v[156:159], a[136:139], a[12:15], v[156:159]
    ds_read_b64_tr_b16 a[152:153], v15 offset:0
    v_mfma_f32_16x16x32_bf16 v[156:159], a[140:143], a[28:31], v[156:159]
    ds_read_b64_tr_b16 a[154:155], v15 offset:2048
    v_mfma_f32_16x16x32_bf16 v[152:155], a[140:143], a[24:27], v[152:155]
    v_lshlrev_b32 v25, 8, v24
    v_bfe_u32 v31, v0, 4, 1
    v_mfma_f32_16x16x32_bf16 v[152:155], a[136:139], a[8:11], v[152:155]
    ds_read_b64_tr_b16 a[156:157], v15 offset:4096
    v_mfma_f32_16x16x32_bf16 v[148:151], a[136:139], a[4:7], v[148:151]
    ds_read_b64_tr_b16 a[158:159], v15 offset:6144
    v_mfma_f32_16x16x32_bf16 v[148:151], a[140:143], a[20:23], v[148:151]
    buffer_load_dwordx4 v102, s[20:23], s63 offen offset:2048 lds
    v_mfma_f32_16x16x32_bf16 v[144:147], a[140:143], a[16:19], v[144:147]
    buffer_load_dwordx4 v103, s[20:23], s63 offen offset:3072 lds
    v_mfma_f32_16x16x32_bf16 v[144:147], a[136:139], a[0:3], v[144:147]
    s_waitcnt lgkmcnt(4)
    v_lshl_add_u32 v25, v31, 3, v25
    v_mfma_f32_16x16x32_bf16 v[160:163], a[144:147], a[0:3], v[160:163]
    ds_read_b64_tr_b16 a[128:129], v12 offset:8192
    v_mfma_f32_16x16x32_bf16 v[160:163], a[148:151], a[16:19], v[160:163]
    ds_read_b64_tr_b16 a[130:131], v12 offset:10240
    v_mfma_f32_16x16x32_bf16 v[164:167], a[148:151], a[20:23], v[164:167]
    v_add_u32 v25, s67, v25
    v_lshrrev_b32 v31, 5, v0
    v_mfma_f32_16x16x32_bf16 v[164:167], a[144:147], a[4:7], v[164:167]
    ds_read_b64_tr_b16 a[132:133], v12 offset:12288
    v_mfma_f32_16x16x32_bf16 v[168:171], a[144:147], a[8:11], v[168:171]
    ds_read_b64_tr_b16 a[134:135], v12 offset:14336
    s_add_u32 m0, s65, 106496
    v_mfma_f32_16x16x32_bf16 v[168:171], a[148:151], a[24:27], v[168:171]
    buffer_load_dwordx4 v104, s[36:39], s64 offen offset:0 lds
    v_mfma_f32_16x16x32_bf16 v[172:175], a[148:151], a[28:31], v[172:175]
    buffer_load_dwordx4 v105, s[36:39], s64 offen offset:1024 lds
    v_mfma_f32_16x16x32_bf16 v[172:175], a[144:147], a[12:15], v[172:175]
    s_waitcnt lgkmcnt(4)
    v_xor_b32 v24, v24, v31
    v_mfma_f32_16x16x32_bf16 v[188:191], a[152:155], a[12:15], v[188:191]
    ds_read_b64_tr_b16 a[136:137], v13 offset:8192
    v_mfma_f32_16x16x32_bf16 v[188:191], a[156:159], a[28:31], v[188:191]
    ds_read_b64_tr_b16 a[138:139], v13 offset:10240
    v_mfma_f32_16x16x32_bf16 v[184:187], a[156:159], a[24:27], v[184:187]
    v_xor_b32 v31, 0, v24
    v_lshl_add_u32 v116, v31, 4, v25
    v_mfma_f32_16x16x32_bf16 v[184:187], a[152:155], a[8:11], v[184:187]
    ds_read_b64_tr_b16 a[140:141], v13 offset:12288
    v_mfma_f32_16x16x32_bf16 v[180:183], a[152:155], a[4:7], v[180:183]
    ds_read_b64_tr_b16 a[142:143], v13 offset:14336
    v_mfma_f32_16x16x32_bf16 v[180:183], a[156:159], a[20:23], v[180:183]
    buffer_load_dwordx4 v106, s[36:39], s64 offen offset:2048 lds
    v_mfma_f32_16x16x32_bf16 v[176:179], a[156:159], a[16:19], v[176:179]
    buffer_load_dwordx4 v107, s[36:39], s64 offen offset:3072 lds
    v_mfma_f32_16x16x32_bf16 v[176:179], a[152:155], a[0:3], v[176:179]
    s_waitcnt lgkmcnt(4)
    v_xor_b32 v31, 2, v24
    v_mfma_f32_16x16x32_bf16 v[192:195], a[128:131], a[0:3], v[192:195]
    ds_read_b64_tr_b16 a[144:145], v14 offset:8192
    v_mfma_f32_16x16x32_bf16 v[192:195], a[132:135], a[16:19], v[192:195]
    ds_read_b64_tr_b16 a[146:147], v14 offset:10240
    v_mfma_f32_16x16x32_bf16 v[196:199], a[132:135], a[20:23], v[196:199]
    v_lshl_add_u32 v117, v31, 4, v25
    v_xor_b32 v31, 4, v24
    v_mfma_f32_16x16x32_bf16 v[196:199], a[128:131], a[4:7], v[196:199]
    ds_read_b64_tr_b16 a[148:149], v14 offset:12288
    v_mfma_f32_16x16x32_bf16 v[200:203], a[128:131], a[8:11], v[200:203]
    ds_read_b64_tr_b16 a[150:151], v14 offset:14336
    v_mfma_f32_16x16x32_bf16 v[200:203], a[132:135], a[24:27], v[200:203]
    buffer_load_dwordx4 a[96:99], v108, s[16:19], s61 offen sc1
    v_mfma_f32_16x16x32_bf16 v[204:207], a[132:135], a[28:31], v[204:207]
    buffer_load_dwordx4 a[100:103], v109, s[16:19], s61 offen sc1
    s_add_u32 s63, s63, 131072
    v_mfma_f32_16x16x32_bf16 v[204:207], a[128:131], a[12:15], v[204:207]
    s_add_u32 s64, s64, s47
    s_waitcnt lgkmcnt(4)
    v_mfma_f32_16x16x32_bf16 v[220:223], a[136:139], a[12:15], v[220:223]
    ds_read_b64_tr_b16 a[152:153], v15 offset:8192
    v_mfma_f32_16x16x32_bf16 v[220:223], a[140:143], a[28:31], v[220:223]
    ds_read_b64_tr_b16 a[154:155], v15 offset:10240
    v_mfma_f32_16x16x32_bf16 v[216:219], a[140:143], a[24:27], v[216:219]
    v_lshl_add_u32 v118, v31, 4, v25
    v_xor_b32 v31, 6, v24
    v_mfma_f32_16x16x32_bf16 v[216:219], a[136:139], a[8:11], v[216:219]
    ds_read_b64_tr_b16 a[156:157], v15 offset:12288
    v_mfma_f32_16x16x32_bf16 v[212:215], a[136:139], a[4:7], v[212:215]
    ds_read_b64_tr_b16 a[158:159], v15 offset:14336
    v_mfma_f32_16x16x32_bf16 v[212:215], a[140:143], a[20:23], v[212:215]
    buffer_load_dwordx4 a[104:107], v110, s[16:19], s61 offen sc1
    v_mfma_f32_16x16x32_bf16 v[208:211], a[140:143], a[16:19], v[208:211]
    buffer_load_dwordx4 a[108:111], v111, s[16:19], s61 offen sc1
    v_mfma_f32_16x16x32_bf16 v[208:211], a[136:139], a[0:3], v[208:211]
    s_waitcnt lgkmcnt(4)
    v_lshl_add_u32 v119, v31, 4, v25
    v_mfma_f32_16x16x32_bf16 v[224:227], a[144:147], a[0:3], v[224:227]
    v_xor_b32 v31, 8, v24
    v_lshl_add_u32 v120, v31, 4, v25
    v_mfma_f32_16x16x32_bf16 v[224:227], a[148:151], a[16:19], v[224:227]
    v_xor_b32 v31, 10, v24
    v_lshl_add_u32 v121, v31, 4, v25
    v_mfma_f32_16x16x32_bf16 v[228:231], a[148:151], a[20:23], v[228:231]
    v_xor_b32 v31, 12, v24
    v_lshl_add_u32 v122, v31, 4, v25
    v_mfma_f32_16x16x32_bf16 v[228:231], a[144:147], a[4:7], v[228:231]
    v_xor_b32 v31, 14, v24
    v_lshl_add_u32 v123, v31, 4, v25
    v_mfma_f32_16x16x32_bf16 v[232:235], a[144:147], a[8:11], v[232:235]
    s_lshl_b32 s3, s44, 14
    v_add_u32 v23, s3, v1
    s_xor_b32 s3, s3, 0x8000
    v_add_u32 v31, s3, v1
    v_mfma_f32_16x16x32_bf16 v[232:235], a[148:151], a[24:27], v[232:235]
    buffer_load_dwordx4 a[112:115], v112, s[16:19], s62 offen sc1
    v_mfma_f32_16x16x32_bf16 v[236:239], a[148:151], a[28:31], v[236:239]
    buffer_load_dwordx4 a[116:119], v113, s[16:19], s62 offen sc1
    v_mfma_f32_16x16x32_bf16 v[236:239], a[144:147], a[12:15], v[236:239]
    s_waitcnt vmcnt(30) lgkmcnt(0)
    s_barrier
    v_mfma_f32_16x16x32_bf16 v[252:255], a[152:155], a[12:15], v[252:255]
    ds_read_b64_tr_b16 a[128:129], v12 offset:32768
    v_mfma_f32_16x16x32_bf16 v[252:255], a[156:159], a[28:31], v[252:255]
    ds_read_b64_tr_b16 a[130:131], v12 offset:34816
    v_mfma_f32_16x16x32_bf16 v[248:251], a[156:159], a[24:27], v[248:251]
    ds_read_b64_tr_b16 a[132:133], v12 offset:36864
    v_mfma_f32_16x16x32_bf16 v[248:251], a[152:155], a[8:11], v[248:251]
    ds_read_b64_tr_b16 a[134:135], v12 offset:38912
    v_mfma_f32_16x16x32_bf16 v[244:247], a[152:155], a[4:7], v[244:247]
    ds_read_b64_tr_b16 a[136:137], v13 offset:32768
    v_mfma_f32_16x16x32_bf16 v[244:247], a[156:159], a[20:23], v[244:247]
    buffer_load_dwordx4 a[120:123], v114, s[16:19], s62 offen sc1
    ds_read_b64_tr_b16 a[138:139], v13 offset:34816
    v_mfma_f32_16x16x32_bf16 v[240:243], a[156:159], a[16:19], v[240:243]
    buffer_load_dwordx4 a[124:127], v115, s[16:19], s62 offen sc1
    ds_read_b64_tr_b16 a[140:141], v13 offset:36864
    v_mfma_f32_16x16x32_bf16 v[240:243], a[152:155], a[0:3], v[240:243]
    s_add_u32 s61, s61, 10240
    s_add_u32 s62, s62, 10240
    ds_read_b64_tr_b16 a[142:143], v13 offset:38912
    s_waitcnt lgkmcnt(4)
    v_mfma_f32_16x16x32_bf16 v[128:131], a[128:131], a[32:35], v[128:131]
    ds_read_b64_tr_b16 a[144:145], v14 offset:32768
    v_mfma_f32_16x16x32_bf16 v[128:131], a[132:135], a[48:51], v[128:131]
    ds_read_b64_tr_b16 a[146:147], v14 offset:34816
    v_mfma_f32_16x16x32_bf16 v[132:135], a[132:135], a[52:55], v[132:135]
    v_mfma_f32_16x16x32_bf16 v[132:135], a[128:131], a[36:39], v[132:135]
    ds_read_b64_tr_b16 a[148:149], v14 offset:36864
    v_mfma_f32_16x16x32_bf16 v[136:139], a[128:131], a[40:43], v[136:139]
    ds_read_b64_tr_b16 a[150:151], v14 offset:38912
    v_mfma_f32_16x16x32_bf16 v[136:139], a[132:135], a[56:59], v[136:139]
    ds_read_b64 v[96:97], v116 offset:0
    ds_read_b64 v[98:99], v117 offset:0
    v_mfma_f32_16x16x32_bf16 v[140:143], a[132:135], a[60:63], v[140:143]
    ds_read_b64 v[100:101], v118 offset:0
    ds_read_b64 v[102:103], v119 offset:0
    v_mfma_f32_16x16x32_bf16 v[140:143], a[128:131], a[44:47], v[140:143]
    s_waitcnt lgkmcnt(4)
    v_mfma_f32_16x16x32_bf16 v[156:159], a[136:139], a[44:47], v[156:159]
    ds_read_b64_tr_b16 a[152:153], v15 offset:32768
    v_mfma_f32_16x16x32_bf16 v[156:159], a[140:143], a[60:63], v[156:159]
    ds_read_b64_tr_b16 a[154:155], v15 offset:34816
    v_mfma_f32_16x16x32_bf16 v[152:155], a[140:143], a[56:59], v[152:155]
    v_mfma_f32_16x16x32_bf16 v[152:155], a[136:139], a[40:43], v[152:155]
    ds_read_b64_tr_b16 a[156:157], v15 offset:36864
    v_mfma_f32_16x16x32_bf16 v[148:151], a[136:139], a[36:39], v[148:151]
    ds_read_b64_tr_b16 a[158:159], v15 offset:38912
    v_mfma_f32_16x16x32_bf16 v[148:151], a[140:143], a[52:55], v[148:151]
    ds_read_b64 v[104:105], v120 offset:0
    ds_read_b64 v[106:107], v121 offset:0
    v_mfma_f32_16x16x32_bf16 v[144:147], a[140:143], a[48:51], v[144:147]
    ds_read_b64 v[108:109], v122 offset:0
    ds_read_b64 v[110:111], v123 offset:0
    v_mfma_f32_16x16x32_bf16 v[144:147], a[136:139], a[32:35], v[144:147]
    s_waitcnt lgkmcnt(4)
    v_mfma_f32_16x16x32_bf16 v[160:163], a[144:147], a[32:35], v[160:163]
    ds_read_b64_tr_b16 a[128:129], v12 offset:40960
    v_mfma_f32_16x16x32_bf16 v[160:163], a[148:151], a[48:51], v[160:163]
    ds_read_b64_tr_b16 a[130:131], v12 offset:43008
    v_mfma_f32_16x16x32_bf16 v[164:167], a[148:151], a[52:55], v[164:167]
    v_mfma_f32_16x16x32_bf16 v[164:167], a[144:147], a[36:39], v[164:167]
    ds_read_b64_tr_b16 a[132:133], v12 offset:45056
    v_mfma_f32_16x16x32_bf16 v[168:171], a[144:147], a[40:43], v[168:171]
    ds_read_b64_tr_b16 a[134:135], v12 offset:47104
    v_mfma_f32_16x16x32_bf16 v[168:171], a[148:151], a[56:59], v[168:171]
    v_mfma_f32_16x16x32_bf16 v[172:175], a[148:151], a[60:63], v[172:175]
    v_mfma_f32_16x16x32_bf16 v[172:175], a[144:147], a[44:47], v[172:175]
    s_waitcnt lgkmcnt(4)
    v_mfma_f32_16x16x32_bf16 v[188:191], a[152:155], a[44:47], v[188:191]
    ds_read_b64_tr_b16 a[136:137], v13 offset:40960
    v_mfma_f32_16x16x32_bf16 v[188:191], a[156:159], a[60:63], v[188:191]
    ds_read_b64_tr_b16 a[138:139], v13 offset:43008
    v_mfma_f32_16x16x32_bf16 v[184:187], a[156:159], a[56:59], v[184:187]
    v_mfma_f32_16x16x32_bf16 v[184:187], a[152:155], a[40:43], v[184:187]
    ds_read_b64_tr_b16 a[140:141], v13 offset:45056
    v_mfma_f32_16x16x32_bf16 v[180:183], a[152:155], a[36:39], v[180:183]
    ds_read_b64_tr_b16 a[142:143], v13 offset:47104
    v_mfma_f32_16x16x32_bf16 v[180:183], a[156:159], a[52:55], v[180:183]
    v_mfma_f32_16x16x32_bf16 v[176:179], a[156:159], a[48:51], v[176:179]
    v_mfma_f32_16x16x32_bf16 v[176:179], a[152:155], a[32:35], v[176:179]
    s_waitcnt lgkmcnt(4)
    v_mfma_f32_16x16x32_bf16 v[192:195], a[128:131], a[32:35], v[192:195]
    ds_read_b64_tr_b16 a[144:145], v14 offset:40960
    v_mfma_f32_16x16x32_bf16 v[192:195], a[132:135], a[48:51], v[192:195]
    ds_read_b64_tr_b16 a[146:147], v14 offset:43008
    v_mfma_f32_16x16x32_bf16 v[196:199], a[132:135], a[52:55], v[196:199]
    v_lshlrev_b32 v32, 16, v96
    v_and_b32 v33, 0xffff0000, v96
    v_mfma_f32_16x16x32_bf16 v[196:199], a[128:131], a[36:39], v[196:199]
    ds_read_b64_tr_b16 a[148:149], v14 offset:45056
    v_mfma_f32_16x16x32_bf16 v[200:203], a[128:131], a[40:43], v[200:203]
    ds_read_b64_tr_b16 a[150:151], v14 offset:47104
    v_mfma_f32_16x16x32_bf16 v[200:203], a[132:135], a[56:59], v[200:203]
    v_lshlrev_b32 v34, 16, v97
    v_and_b32 v35, 0xffff0000, v97
    v_mfma_f32_16x16x32_bf16 v[204:207], a[132:135], a[60:63], v[204:207]
    v_lshlrev_b32 v36, 16, v98
    v_and_b32 v37, 0xffff0000, v98
    v_mfma_f32_16x16x32_bf16 v[204:207], a[128:131], a[44:47], v[204:207]
    s_waitcnt lgkmcnt(4)
    v_lshlrev_b32 v38, 16, v99
    v_mfma_f32_16x16x32_bf16 v[220:223], a[136:139], a[44:47], v[220:223]
    ds_read_b64_tr_b16 a[152:153], v15 offset:40960
    v_mfma_f32_16x16x32_bf16 v[220:223], a[140:143], a[60:63], v[220:223]
    ds_read_b64_tr_b16 a[154:155], v15 offset:43008
    v_mfma_f32_16x16x32_bf16 v[216:219], a[140:143], a[56:59], v[216:219]
    v_and_b32 v39, 0xffff0000, v99
    v_lshlrev_b32 v40, 16, v100
    v_mfma_f32_16x16x32_bf16 v[216:219], a[136:139], a[40:43], v[216:219]
    ds_read_b64_tr_b16 a[156:157], v15 offset:45056
    v_mfma_f32_16x16x32_bf16 v[212:215], a[136:139], a[36:39], v[212:215]
    ds_read_b64_tr_b16 a[158:159], v15 offset:47104
    v_mfma_f32_16x16x32_bf16 v[212:215], a[140:143], a[52:55], v[212:215]
    v_and_b32 v41, 0xffff0000, v100
    v_lshlrev_b32 v42, 16, v101
    v_mfma_f32_16x16x32_bf16 v[208:211], a[140:143], a[48:51], v[208:211]
    v_and_b32 v43, 0xffff0000, v101
    v_lshlrev_b32 v44, 16, v102
    v_mfma_f32_16x16x32_bf16 v[208:211], a[136:139], a[32:35], v[208:211]
    s_waitcnt lgkmcnt(4)
    v_and_b32 v45, 0xffff0000, v102
    v_mfma_f32_16x16x32_bf16 v[224:227], a[144:147], a[32:35], v[224:227]
    v_lshlrev_b32 v46, 16, v103
    v_and_b32 v47, 0xffff0000, v103
    v_mfma_f32_16x16x32_bf16 v[224:227], a[148:151], a[48:51], v[224:227]
    v_lshlrev_b32 v48, 16, v104
    v_and_b32 v49, 0xffff0000, v104
    v_mfma_f32_16x16x32_bf16 v[228:231], a[148:151], a[52:55], v[228:231]
    v_lshlrev_b32 v50, 16, v105
    v_and_b32 v51, 0xffff0000, v105
    v_mfma_f32_16x16x32_bf16 v[228:231], a[144:147], a[36:39], v[228:231]
    v_lshlrev_b32 v52, 16, v106
    v_and_b32 v53, 0xffff0000, v106
    v_mfma_f32_16x16x32_bf16 v[232:235], a[144:147], a[40:43], v[232:235]
    v_lshlrev_b32 v54, 16, v107
    v_and_b32 v55, 0xffff0000, v107
    v_mfma_f32_16x16x32_bf16 v[232:235], a[148:151], a[56:59], v[232:235]
    v_lshlrev_b32 v56, 16, v108
    v_and_b32 v57, 0xffff0000, v108
    v_mfma_f32_16x16x32_bf16 v[236:239], a[148:151], a[60:63], v[236:239]
    v_lshlrev_b32 v58, 16, v109
    v_and_b32 v59, 0xffff0000, v109
    v_lshlrev_b32 v60, 16, v110
    v_and_b32 v61, 0xffff0000, v110
    v_lshlrev_b32 v62, 16, v111
    v_and_b32 v63, 0xffff0000, v111
    v_mfma_f32_16x16x32_bf16 v[236:239], a[144:147], a[44:47], v[236:239]
    s_waitcnt vmcnt(16) lgkmcnt(0)
    s_barrier
    v_mfma_f32_16x16x32_bf16 v[252:255], a[152:155], a[44:47], v[252:255]
    ds_read_b64_tr_b16 a[128:129], v16 offset:0
    v_mfma_f32_16x16x32_bf16 v[252:255], a[156:159], a[60:63], v[252:255]
    ds_read_b64_tr_b16 a[130:131], v16 offset:2048
    v_mfma_f32_16x16x32_bf16 v[248:251], a[156:159], a[56:59], v[248:251]
    ds_read_b64_tr_b16 a[132:133], v16 offset:4096
    v_mfma_f32_16x16x32_bf16 v[248:251], a[152:155], a[40:43], v[248:251]
    ds_read_b64_tr_b16 a[134:135], v16 offset:6144
    v_mfma_f32_16x16x32_bf16 v[244:247], a[152:155], a[36:39], v[244:247]
    ds_read_b64_tr_b16 a[136:137], v17 offset:0
    v_mfma_f32_16x16x32_bf16 v[244:247], a[156:159], a[52:55], v[244:247]
    ds_read_b64_tr_b16 a[138:139], v17 offset:2048
    v_mfma_f32_16x16x32_bf16 v[240:243], a[156:159], a[48:51], v[240:243]
    ds_read_b64_tr_b16 a[140:141], v17 offset:4096
    v_mfma_f32_16x16x32_bf16 v[240:243], a[152:155], a[32:35], v[240:243]
    ds_read_b64_tr_b16 a[142:143], v17 offset:6144
    s_waitcnt lgkmcnt(4)
    v_mfma_f32_16x16x32_bf16 v[128:131], a[128:131], a[64:67], v[128:131]
    ds_read_b64_tr_b16 a[144:145], v2 offset:0
    v_mfma_f32_16x16x32_bf16 v[128:131], a[132:135], a[80:83], v[128:131]
    ds_read_b64_tr_b16 a[146:147], v2 offset:2048
    v_mfma_f32_16x16x32_bf16 v[132:135], a[132:135], a[84:87], v[132:135]
    v_mfma_f32_16x16x32_bf16 v[132:135], a[128:131], a[68:71], v[132:135]
    ds_read_b64_tr_b16 a[148:149], v2 offset:4096
    v_mfma_f32_16x16x32_bf16 v[136:139], a[128:131], a[72:75], v[136:139]
    ds_read_b64_tr_b16 a[150:151], v2 offset:6144
    v_mfma_f32_16x16x32_bf16 v[136:139], a[132:135], a[88:91], v[136:139]
    ds_read_b64 v[96:97], v116 offset:4096
    ds_read_b64 v[98:99], v117 offset:4096
    v_mfma_f32_16x16x32_bf16 v[140:143], a[132:135], a[92:95], v[140:143]
    ds_read_b64 v[100:101], v118 offset:4096
    ds_read_b64 v[102:103], v119 offset:4096
    v_mfma_f32_16x16x32_bf16 v[140:143], a[128:131], a[76:79], v[140:143]
    s_waitcnt lgkmcnt(4)
    v_mfma_f32_16x16x32_bf16 v[156:159], a[136:139], a[76:79], v[156:159]
    ds_read_b64_tr_b16 a[152:153], v3 offset:0
    v_mfma_f32_16x16x32_bf16 v[156:159], a[140:143], a[92:95], v[156:159]
    ds_read_b64_tr_b16 a[154:155], v3 offset:2048
    v_mfma_f32_16x16x32_bf16 v[152:155], a[140:143], a[88:91], v[152:155]
    buffer_load_dwordx2 v[20:21], v22, s[12:15], 0 offen sc1
    v_mfma_f32_16x16x32_bf16 v[152:155], a[136:139], a[72:75], v[152:155]
    ds_read_b64_tr_b16 a[156:157], v3 offset:4096
    v_mfma_f32_16x16x32_bf16 v[148:151], a[136:139], a[68:71], v[148:151]
    ds_read_b64_tr_b16 a[158:159], v3 offset:6144
    v_mfma_f32_16x16x32_bf16 v[148:151], a[140:143], a[84:87], v[148:151]
    ds_read_b64 v[104:105], v120 offset:4096
    ds_read_b64 v[106:107], v121 offset:4096
    v_mfma_f32_16x16x32_bf16 v[144:147], a[140:143], a[80:83], v[144:147]
    ds_read_b64 v[108:109], v122 offset:4096
    ds_read_b64 v[110:111], v123 offset:4096
    v_mfma_f32_16x16x32_bf16 v[144:147], a[136:139], a[64:67], v[144:147]
    s_waitcnt lgkmcnt(4)
    v_mfma_f32_16x16x32_bf16 v[160:163], a[144:147], a[64:67], v[160:163]
    ds_read_b64_tr_b16 a[128:129], v16 offset:8192
    v_mfma_f32_16x16x32_bf16 v[160:163], a[148:151], a[80:83], v[160:163]
    ds_read_b64_tr_b16 a[130:131], v16 offset:10240
    v_mfma_f32_16x16x32_bf16 v[164:167], a[148:151], a[84:87], v[164:167]
    v_mfma_f32_16x16x32_bf16 v[164:167], a[144:147], a[68:71], v[164:167]
    ds_read_b64_tr_b16 a[132:133], v16 offset:12288
    v_mfma_f32_16x16x32_bf16 v[168:171], a[144:147], a[72:75], v[168:171]
    ds_read_b64_tr_b16 a[134:135], v16 offset:14336
    v_mfma_f32_16x16x32_bf16 v[168:171], a[148:151], a[88:91], v[168:171]
    v_mfma_f32_16x16x32_bf16 v[172:175], a[148:151], a[92:95], v[172:175]
    v_mfma_f32_16x16x32_bf16 v[172:175], a[144:147], a[76:79], v[172:175]
    s_waitcnt lgkmcnt(4)
    v_mfma_f32_16x16x32_bf16 v[188:191], a[152:155], a[76:79], v[188:191]
    ds_read_b64_tr_b16 a[136:137], v17 offset:8192
    v_mfma_f32_16x16x32_bf16 v[188:191], a[156:159], a[92:95], v[188:191]
    ds_read_b64_tr_b16 a[138:139], v17 offset:10240
    v_mfma_f32_16x16x32_bf16 v[184:187], a[156:159], a[88:91], v[184:187]
    v_mfma_f32_16x16x32_bf16 v[184:187], a[152:155], a[72:75], v[184:187]
    ds_read_b64_tr_b16 a[140:141], v17 offset:12288
    v_mfma_f32_16x16x32_bf16 v[180:183], a[152:155], a[68:71], v[180:183]
    ds_read_b64_tr_b16 a[142:143], v17 offset:14336
    v_mfma_f32_16x16x32_bf16 v[180:183], a[156:159], a[84:87], v[180:183]
    v_mfma_f32_16x16x32_bf16 v[176:179], a[156:159], a[80:83], v[176:179]
    v_mfma_f32_16x16x32_bf16 v[176:179], a[152:155], a[64:67], v[176:179]
    s_waitcnt lgkmcnt(4)
    v_mfma_f32_16x16x32_bf16 v[192:195], a[128:131], a[64:67], v[192:195]
    ds_read_b64_tr_b16 a[144:145], v2 offset:8192
    v_mfma_f32_16x16x32_bf16 v[192:195], a[132:135], a[80:83], v[192:195]
    ds_read_b64_tr_b16 a[146:147], v2 offset:10240
    v_mfma_f32_16x16x32_bf16 v[196:199], a[132:135], a[84:87], v[196:199]
    v_lshlrev_b32 v64, 16, v96
    v_and_b32 v65, 0xffff0000, v96
    v_mfma_f32_16x16x32_bf16 v[196:199], a[128:131], a[68:71], v[196:199]
    ds_read_b64_tr_b16 a[148:149], v2 offset:12288
    v_mfma_f32_16x16x32_bf16 v[200:203], a[128:131], a[72:75], v[200:203]
    ds_read_b64_tr_b16 a[150:151], v2 offset:14336
    v_mfma_f32_16x16x32_bf16 v[200:203], a[132:135], a[88:91], v[200:203]
    v_lshlrev_b32 v66, 16, v97
    v_and_b32 v67, 0xffff0000, v97
    v_mfma_f32_16x16x32_bf16 v[204:207], a[132:135], a[92:95], v[204:207]
    v_lshlrev_b32 v68, 16, v98
    v_and_b32 v69, 0xffff0000, v98
    v_mfma_f32_16x16x32_bf16 v[204:207], a[128:131], a[76:79], v[204:207]
    s_waitcnt lgkmcnt(4)
    v_lshlrev_b32 v70, 16, v99
    v_mfma_f32_16x16x32_bf16 v[220:223], a[136:139], a[76:79], v[220:223]
    ds_read_b64_tr_b16 a[152:153], v3 offset:8192
    v_mfma_f32_16x16x32_bf16 v[220:223], a[140:143], a[92:95], v[220:223]
    ds_read_b64_tr_b16 a[154:155], v3 offset:10240
    v_mfma_f32_16x16x32_bf16 v[216:219], a[140:143], a[88:91], v[216:219]
    v_and_b32 v71, 0xffff0000, v99
    v_lshlrev_b32 v72, 16, v100
    v_mfma_f32_16x16x32_bf16 v[216:219], a[136:139], a[72:75], v[216:219]
    ds_read_b64_tr_b16 a[156:157], v3 offset:12288
    v_mfma_f32_16x16x32_bf16 v[212:215], a[136:139], a[68:71], v[212:215]
    ds_read_b64_tr_b16 a[158:159], v3 offset:14336
    v_mfma_f32_16x16x32_bf16 v[212:215], a[140:143], a[84:87], v[212:215]
    v_and_b32 v73, 0xffff0000, v100
    v_lshlrev_b32 v74, 16, v101
    v_mfma_f32_16x16x32_bf16 v[208:211], a[140:143], a[80:83], v[208:211]
    v_and_b32 v75, 0xffff0000, v101
    v_lshlrev_b32 v76, 16, v102
    v_mfma_f32_16x16x32_bf16 v[208:211], a[136:139], a[64:67], v[208:211]
    s_waitcnt lgkmcnt(4)
    v_and_b32 v77, 0xffff0000, v102
    v_mfma_f32_16x16x32_bf16 v[224:227], a[144:147], a[64:67], v[224:227]
    v_lshlrev_b32 v78, 16, v103
    v_and_b32 v79, 0xffff0000, v103
    v_mfma_f32_16x16x32_bf16 v[224:227], a[148:151], a[80:83], v[224:227]
    v_lshlrev_b32 v80, 16, v104
    v_and_b32 v81, 0xffff0000, v104
    v_mfma_f32_16x16x32_bf16 v[228:231], a[148:151], a[84:87], v[228:231]
    v_lshlrev_b32 v82, 16, v105
    v_and_b32 v83, 0xffff0000, v105
    v_mfma_f32_16x16x32_bf16 v[228:231], a[144:147], a[68:71], v[228:231]
    v_lshlrev_b32 v84, 16, v106
    v_and_b32 v85, 0xffff0000, v106
    v_mfma_f32_16x16x32_bf16 v[232:235], a[144:147], a[72:75], v[232:235]
    v_lshlrev_b32 v86, 16, v107
    v_and_b32 v87, 0xffff0000, v107
    v_mfma_f32_16x16x32_bf16 v[232:235], a[148:151], a[88:91], v[232:235]
    v_lshlrev_b32 v88, 16, v108
    v_and_b32 v89, 0xffff0000, v108
    v_mfma_f32_16x16x32_bf16 v[236:239], a[148:151], a[92:95], v[236:239]
    v_lshlrev_b32 v90, 16, v109
    v_and_b32 v91, 0xffff0000, v109
    v_lshlrev_b32 v92, 16, v110
    v_and_b32 v93, 0xffff0000, v110
    v_lshlrev_b32 v94, 16, v111
    v_and_b32 v95, 0xffff0000, v111
    v_mfma_f32_16x16x32_bf16 v[236:239], a[144:147], a[76:79], v[236:239]
    s_waitcnt vmcnt(0) lgkmcnt(0)
    s_barrier
    v_mfma_f32_16x16x32_bf16 v[252:255], a[152:155], a[76:79], v[252:255]
    ds_read_b64_tr_b16 a[160:161], v16 offset:32768
    v_mfma_f32_16x16x32_bf16 v[252:255], a[156:159], a[92:95], v[252:255]
    ds_read_b64_tr_b16 a[162:163], v16 offset:34816
    v_mfma_f32_16x16x32_bf16 v[248:251], a[156:159], a[88:91], v[248:251]
    v_cmp_ne_u64 s[74:75], s[54:55], v[20:21]
    ds_read_b64_tr_b16 a[164:165], v16 offset:36864
    v_mfma_f32_16x16x32_bf16 v[248:251], a[152:155], a[72:75], v[248:251]
    ds_read_b64_tr_b16 a[166:167], v16 offset:38912
    v_mfma_f32_16x16x32_bf16 v[244:247], a[152:155], a[68:71], v[244:247]
    s_cmp_eq_u64 s[74:75], 0
    s_cselect_b32 s30, 8192, 0
    ds_read_b64_tr_b16 a[168:169], v17 offset:32768
    v_mfma_f32_16x16x32_bf16 v[244:247], a[156:159], a[84:87], v[244:247]
    ds_read_b64_tr_b16 a[170:171], v17 offset:34816
    v_mfma_f32_16x16x32_bf16 v[240:243], a[156:159], a[80:83], v[240:243]
    ds_read_b64_tr_b16 a[172:173], v17 offset:36864
    v_mfma_f32_16x16x32_bf16 v[240:243], a[152:155], a[64:67], v[240:243]
    ds_read_b64_tr_b16 a[174:175], v17 offset:38912
    s_waitcnt lgkmcnt(4)
    v_mfma_f32_16x16x32_bf16 v[136:139], a[160:163], a[104:107], v[136:139]
    ds_read_b64_tr_b16 a[176:177], v2 offset:32768
    v_mfma_f32_16x16x32_bf16 v[136:139], a[164:167], a[120:123], v[136:139]
    ds_read_b64_tr_b16 a[178:179], v2 offset:34816
    buffer_load_dwordx4 v[96:99], v1, s[28:31], 0 offen offset:0 sc1
    v_mfma_f32_16x16x32_bf16 v[140:143], a[164:167], a[124:127], v[140:143]
    ds_read_b64_tr_b16 a[180:181], v2 offset:36864
    v_mfma_f32_16x16x32_bf16 v[140:143], a[160:163], a[108:111], v[140:143]
    ds_read_b64_tr_b16 a[182:183], v2 offset:38912
    s_waitcnt lgkmcnt(4)
    v_mfma_f32_16x16x32_bf16 v[156:159], a[168:171], a[108:111], v[156:159]
    ds_read_b64_tr_b16 a[184:185], v3 offset:32768
    buffer_load_dwordx4 v[100:103], v1, s[28:31], 0 offen offset:1024 sc1
    v_mfma_f32_16x16x32_bf16 v[156:159], a[172:175], a[124:127], v[156:159]
    ds_read_b64_tr_b16 a[186:187], v3 offset:34816
    v_mfma_f32_16x16x32_bf16 v[152:155], a[172:175], a[120:123], v[152:155]
    ds_read_b64_tr_b16 a[188:189], v3 offset:36864
    v_mfma_f32_16x16x32_bf16 v[152:155], a[168:171], a[104:107], v[152:155]
    ds_read_b64_tr_b16 a[190:191], v3 offset:38912
    s_waitcnt lgkmcnt(4)
    buffer_load_dwordx4 v[104:107], v1, s[28:31], 0 offen offset:2048 sc1
    v_mfma_f32_16x16x32_bf16 v[168:171], a[176:179], a[104:107], v[168:171]
    ds_read_b64_tr_b16 a[192:193], v16 offset:40960
    v_mfma_f32_16x16x32_bf16 v[168:171], a[180:183], a[120:123], v[168:171]
    ds_read_b64_tr_b16 a[194:195], v16 offset:43008
    v_mfma_f32_16x16x32_bf16 v[172:175], a[180:183], a[124:127], v[172:175]
    ds_read_b64_tr_b16 a[196:197], v16 offset:45056
    buffer_load_dwordx4 v[108:111], v1, s[28:31], 0 offen offset:3072 sc1
    v_mfma_f32_16x16x32_bf16 v[172:175], a[176:179], a[108:111], v[172:175]
    ds_read_b64_tr_b16 a[198:199], v16 offset:47104
    s_waitcnt lgkmcnt(4)
    v_mfma_f32_16x16x32_bf16 v[188:191], a[184:187], a[108:111], v[188:191]
    ds_read_b64_tr_b16 a[200:201], v17 offset:40960
    v_mfma_f32_16x16x32_bf16 v[188:191], a[188:191], a[124:127], v[188:191]
    ds_read_b64_tr_b16 a[202:203], v17 offset:43008
    buffer_load_dwordx4 v[112:115], v1, s[28:31], s49 offen offset:0 sc1
    v_mfma_f32_16x16x32_bf16 v[184:187], a[188:191], a[120:123], v[184:187]
    ds_read_b64_tr_b16 a[204:205], v17 offset:45056
    v_mfma_f32_16x16x32_bf16 v[184:187], a[184:187], a[104:107], v[184:187]
    ds_read_b64_tr_b16 a[206:207], v17 offset:47104
    s_waitcnt lgkmcnt(4)
    v_mfma_f32_16x16x32_bf16 v[200:203], a[192:195], a[104:107], v[200:203]
    ds_read_b64_tr_b16 a[208:209], v2 offset:40960
    buffer_load_dwordx4 v[116:119], v1, s[28:31], s49 offen offset:1024 sc1
    v_mfma_f32_16x16x32_bf16 v[200:203], a[196:199], a[120:123], v[200:203]
    ds_read_b64_tr_b16 a[210:211], v2 offset:43008
    v_mfma_f32_16x16x32_bf16 v[204:207], a[196:199], a[124:127], v[204:207]
    ds_read_b64_tr_b16 a[212:213], v2 offset:45056
    v_mfma_f32_16x16x32_bf16 v[204:207], a[192:195], a[108:111], v[204:207]
    ds_read_b64_tr_b16 a[214:215], v2 offset:47104
    s_waitcnt lgkmcnt(4)
    buffer_load_dwordx4 v[120:123], v1, s[28:31], s49 offen offset:2048 sc1
    v_mfma_f32_16x16x32_bf16 v[220:223], a[200:203], a[108:111], v[220:223]
    ds_read_b64_tr_b16 a[216:217], v3 offset:40960
    v_mfma_f32_16x16x32_bf16 v[220:223], a[204:207], a[124:127], v[220:223]
    ds_read_b64_tr_b16 a[218:219], v3 offset:43008
    v_mfma_f32_16x16x32_bf16 v[216:219], a[204:207], a[120:123], v[216:219]
    ds_read_b64_tr_b16 a[220:221], v3 offset:45056
    buffer_load_dwordx4 v[124:127], v1, s[28:31], s49 offen offset:3072 sc1
    v_mfma_f32_16x16x32_bf16 v[216:219], a[200:203], a[104:107], v[216:219]
    ds_read_b64_tr_b16 a[222:223], v3 offset:47104
    s_waitcnt lgkmcnt(4)
    v_mfma_f32_16x16x32_bf16 v[232:235], a[208:211], a[104:107], v[232:235]
    v_mfma_f32_16x16x32_bf16 v[232:235], a[212:215], a[120:123], v[232:235]
    v_mfma_f32_16x16x32_bf16 v[236:239], a[212:215], a[124:127], v[236:239]
    v_mfma_f32_16x16x32_bf16 v[236:239], a[208:211], a[108:111], v[236:239]
    s_waitcnt lgkmcnt(0)
    v_mfma_f32_16x16x32_bf16 v[252:255], a[216:219], a[108:111], v[252:255]
    v_mfma_f32_16x16x32_bf16 v[252:255], a[220:223], a[124:127], v[252:255]
    v_mfma_f32_16x16x32_bf16 v[248:251], a[220:223], a[120:123], v[248:251]
    v_mfma_f32_16x16x32_bf16 v[248:251], a[216:219], a[104:107], v[248:251]
    v_mfma_f32_16x16x32_bf16 v[128:131], a[160:163], a[96:99], v[128:131]
    ds_write_b128 v23, v[136:139] offset:0
    v_mfma_f32_16x16x32_bf16 v[128:131], a[164:167], a[112:115], v[128:131]
    v_mfma_f32_16x16x32_bf16 v[132:135], a[164:167], a[116:119], v[132:135]
    ds_write_b128 v23, v[140:143] offset:8192
    v_mfma_f32_16x16x32_bf16 v[132:135], a[160:163], a[100:103], v[132:135]
    v_mfma_f32_16x16x32_bf16 v[148:151], a[168:171], a[100:103], v[148:151]
    ds_write_b128 v23, v[152:155] offset:1024
    v_mfma_f32_16x16x32_bf16 v[148:151], a[172:175], a[116:119], v[148:151]
    v_mfma_f32_16x16x32_bf16 v[144:147], a[172:175], a[112:115], v[144:147]
    ds_write_b128 v23, v[156:159] offset:9216
    v_mfma_f32_16x16x32_bf16 v[144:147], a[168:171], a[96:99], v[144:147]
    v_mfma_f32_16x16x32_bf16 v[160:163], a[176:179], a[96:99], v[160:163]
    ds_write_b128 v23, v[168:171] offset:2048
    v_mfma_f32_16x16x32_bf16 v[160:163], a[180:183], a[112:115], v[160:163]
    v_mfma_f32_16x16x32_bf16 v[164:167], a[180:183], a[116:119], v[164:167]
    ds_write_b128 v23, v[172:175] offset:10240
    v_mfma_f32_16x16x32_bf16 v[164:167], a[176:179], a[100:103], v[164:167]
    v_mfma_f32_16x16x32_bf16 v[180:183], a[184:187], a[100:103], v[180:183]
    ds_write_b128 v23, v[184:187] offset:3072
    v_mfma_f32_16x16x32_bf16 v[180:183], a[188:191], a[116:119], v[180:183]
    v_mfma_f32_16x16x32_bf16 v[176:179], a[188:191], a[112:115], v[176:179]
    ds_write_b128 v23, v[188:191] offset:11264
    v_mfma_f32_16x16x32_bf16 v[176:179], a[184:187], a[96:99], v[176:179]
    v_mfma_f32_16x16x32_bf16 v[192:195], a[192:195], a[96:99], v[192:195]
    ds_write_b128 v23, v[200:203] offset:4096
    v_mfma_f32_16x16x32_bf16 v[192:195], a[196:199], a[112:115], v[192:195]
    v_mfma_f32_16x16x32_bf16 v[196:199], a[196:199], a[116:119], v[196:199]
    ds_write_b128 v23, v[204:207] offset:12288
    v_mfma_f32_16x16x32_bf16 v[196:199], a[192:195], a[100:103], v[196:199]
    v_mfma_f32_16x16x32_bf16 v[212:215], a[200:203], a[100:103], v[212:215]
    ds_write_b128 v23, v[216:219] offset:5120
    v_mfma_f32_16x16x32_bf16 v[212:215], a[204:207], a[116:119], v[212:215]
    v_mfma_f32_16x16x32_bf16 v[208:211], a[204:207], a[112:115], v[208:211]
    ds_write_b128 v23, v[220:223] offset:13312
    v_mfma_f32_16x16x32_bf16 v[208:211], a[200:203], a[96:99], v[208:211]
    v_mfma_f32_16x16x32_bf16 v[224:227], a[208:211], a[96:99], v[224:227]
    ds_write_b128 v23, v[232:235] offset:6144
    v_mfma_f32_16x16x32_bf16 v[224:227], a[212:215], a[112:115], v[224:227]
    v_mfma_f32_16x16x32_bf16 v[228:231], a[212:215], a[116:119], v[228:231]
    ds_write_b128 v23, v[236:239] offset:14336
    v_mfma_f32_16x16x32_bf16 v[228:231], a[208:211], a[100:103], v[228:231]
    v_mfma_f32_16x16x32_bf16 v[244:247], a[216:219], a[100:103], v[244:247]
    ds_write_b128 v23, v[248:251] offset:7168
    v_mfma_f32_16x16x32_bf16 v[244:247], a[220:223], a[116:119], v[244:247]
    v_mfma_f32_16x16x32_bf16 v[240:243], a[220:223], a[112:115], v[240:243]
    ds_write_b128 v23, v[252:255] offset:15360
    v_mfma_f32_16x16x32_bf16 v[240:243], a[216:219], a[96:99], v[240:243]
    s_mov_b32 s30, 8192
    s_cmp_eq_u32 s56, 0
    s_waitcnt lgkmcnt(0)
    s_barrier
    s_cbranch_scc1 L_fin_s
    ds_read_b128 v[136:139], v31 offset:0
    ds_read_b128 v[152:155], v31 offset:1024
    ds_read_b128 v[168:171], v31 offset:2048
    ds_read_b128 v[184:187], v31 offset:3072
    ds_read_b128 v[200:203], v31 offset:4096
    ds_read_b128 v[216:219], v31 offset:5120
    ds_read_b128 v[232:235], v31 offset:6144
    ds_read_b128 v[248:251], v31 offset:7168
    ds_read_b128 v[140:143], v31 offset:8192
    ds_read_b128 v[156:159], v31 offset:9216
    ds_read_b128 v[172:175], v31 offset:10240
    ds_read_b128 v[188:191], v31 offset:11264
    ds_read_b128 v[204:207], v31 offset:12288
    ds_read_b128 v[220:223], v31 offset:13312
    ds_read_b128 v[236:239], v31 offset:14336
    ds_read_b128 v[252:255], v31 offset:15360
    s_waitcnt lgkmcnt(15)
    v_pk_add_f32 v[128:129], v[128:129], v[136:137]
    v_pk_add_f32 v[130:131], v[130:131], v[138:139]
    s_waitcnt lgkmcnt(14)
    v_pk_add_f32 v[144:145], v[144:145], v[152:153]
    v_pk_add_f32 v[146:147], v[146:147], v[154:155]
    s_waitcnt lgkmcnt(13)
    v_pk_add_f32 v[160:161], v[160:161], v[168:169]
    v_pk_add_f32 v[162:163], v[162:163], v[170:171]
    s_waitcnt lgkmcnt(12)
    v_pk_add_f32 v[176:177], v[176:177], v[184:185]
    v_pk_add_f32 v[178:179], v[178:179], v[186:187]
    s_waitcnt lgkmcnt(11)
    v_pk_add_f32 v[192:193], v[192:193], v[200:201]
    v_pk_add_f32 v[194:195], v[194:195], v[202:203]
    s_waitcnt lgkmcnt(10)
    v_pk_add_f32 v[208:209], v[208:209], v[216:217]
    v_pk_add_f32 v[210:211], v[210:211], v[218:219]
    s_waitcnt lgkmcnt(9)
    v_pk_add_f32 v[224:225], v[224:225], v[232:233]
    v_pk_add_f32 v[226:227], v[226:227], v[234:235]
    s_waitcnt lgkmcnt(8)
    v_pk_add_f32 v[240:241], v[240:241], v[248:249]
    v_pk_add_f32 v[242:243], v[242:243], v[250:251]
    s_waitcnt lgkmcnt(7)
    v_pk_add_f32 v[132:133], v[132:133], v[140:141]
    v_pk_add_f32 v[134:135], v[134:135], v[142:143]
    s_waitcnt lgkmcnt(6)
    v_pk_add_f32 v[148:149], v[148:149], v[156:157]
    v_pk_add_f32 v[150:151], v[150:151], v[158:159]
    s_waitcnt lgkmcnt(5)
    v_pk_add_f32 v[164:165], v[164:165], v[172:173]
    v_pk_add_f32 v[166:167], v[166:167], v[174:175]
    s_waitcnt lgkmcnt(4)
    v_pk_add_f32 v[180:181], v[180:181], v[188:189]
    v_pk_add_f32 v[182:183], v[182:183], v[190:191]
    s_waitcnt lgkmcnt(3)
    v_pk_add_f32 v[196:197], v[196:197], v[204:205]
    v_pk_add_f32 v[198:199], v[198:199], v[206:207]
    s_waitcnt lgkmcnt(2)
    v_pk_add_f32 v[212:213], v[212:213], v[220:221]
    v_pk_add_f32 v[214:215], v[214:215], v[222:223]
    s_waitcnt lgkmcnt(1)
    v_pk_add_f32 v[228:229], v[228:229], v[236:237]
    v_pk_add_f32 v[230:231], v[230:231], v[238:239]
    s_waitcnt lgkmcnt(0)
    v_pk_add_f32 v[244:245], v[244:245], v[252:253]
    v_pk_add_f32 v[246:247], v[246:247], v[254:255]
    s_waitcnt vmcnt(0)
    s_mov_b32 s8, 0xbfb8aa3b
    s_mov_b32 s9, 0xbfb8aa3b
    v_pk_mul_f32 v[136:137], v[128:129], s[8:9]
    v_pk_mul_f32 v[138:139], v[130:131], s[8:9]
    v_pk_mul_f32 v[152:153], v[144:145], s[8:9]
    v_pk_mul_f32 v[154:155], v[146:147], s[8:9]
    v_pk_mul_f32 v[168:169], v[160:161], s[8:9]
    v_pk_mul_f32 v[170:171], v[162:163], s[8:9]
    v_pk_mul_f32 v[184:185], v[176:177], s[8:9]
    v_pk_mul_f32 v[186:187], v[178:179], s[8:9]
    v_exp_f32 v136, v136
    v_exp_f32 v137, v137
    v_exp_f32 v138, v138
    v_exp_f32 v139, v139
    v_exp_f32 v152, v152
    v_exp_f32 v153, v153
    v_exp_f32 v154, v154
    v_exp_f32 v155, v155
    v_exp_f32 v168, v168
    v_exp_f32 v169, v169
    v_exp_f32 v170, v170
    v_exp_f32 v171, v171
    v_exp_f32 v184, v184
    v_exp_f32 v185, v185
    v_exp_f32 v186, v186
    v_exp_f32 v187, v187
    s_nop 0
    v_pk_add_f32 v[136:137], v[136:137], 1.0 op_sel_hi:[1,0]
    v_pk_add_f32 v[138:139], v[138:139], 1.0 op_sel_hi:[1,0]
    v_pk_add_f32 v[152:153], v[152:153], 1.0 op_sel_hi:[1,0]
    v_pk_add_f32 v[154:155], v[154:155], 1.0 op_sel_hi:[1,0]
    v_pk_add_f32 v[168:169], v[168:169], 1.0 op_sel_hi:[1,0]
    v_pk_add_f32 v[170:171], v[170:171], 1.0 op_sel_hi:[1,0]
    v_pk_add_f32 v[184:185], v[184:185], 1.0 op_sel_hi:[1,0]
    v_pk_add_f32 v[186:187], v[186:187], 1.0 op_sel_hi:[1,0]
    v_rcp_f32 v136, v136
    v_rcp_f32 v137, v137
    v_rcp_f32 v138, v138
    v_rcp_f32 v139, v139
    v_rcp_f32 v152, v152
    v_rcp_f32 v153, v153
    v_rcp_f32 v154, v154
    v_rcp_f32 v155, v155
    v_rcp_f32 v168, v168
    v_rcp_f32 v169, v169
    v_rcp_f32 v170, v170
    v_rcp_f32 v171, v171
    v_rcp_f32 v184, v184
    v_rcp_f32 v185, v185
    v_rcp_f32 v186, v186
    v_rcp_f32 v187, v187
    s_nop 0
    v_pk_mul_f32 v[128:129], v[128:129], v[136:137]
    v_pk_mul_f32 v[130:131], v[130:131], v[138:139]
    v_pk_mul_f32 v[144:145], v[144:145], v[152:153]
    v_pk_mul_f32 v[146:147], v[146:147], v[154:155]
    v_pk_mul_f32 v[160:161], v[160:161], v[168:169]
    v_pk_mul_f32 v[162:163], v[162:163], v[170:171]
    v_pk_mul_f32 v[176:177], v[176:177], v[184:185]
    v_pk_mul_f32 v[178:179], v[178:179], v[186:187]
    v_cvt_pk_bf16_f32 v96, v128, v129
    v_cvt_pk_bf16_f32 v97, v130, v131
    v_cvt_pk_bf16_f32 v98, v144, v145
    v_cvt_pk_bf16_f32 v99, v146, v147
    v_cvt_pk_bf16_f32 v100, v160, v161
    v_cvt_pk_bf16_f32 v101, v162, v163
    v_cvt_pk_bf16_f32 v102, v176, v177
    v_cvt_pk_bf16_f32 v103, v178, v179
    buffer_store_dwordx4 v[96:99], v1, s[28:31], 0 offen offset:0 sc1
    buffer_store_dwordx4 v[100:103], v1, s[28:31], 0 offen offset:1024 sc1
    v_pk_mul_f32 v[200:201], v[192:193], s[8:9]
    v_pk_mul_f32 v[202:203], v[194:195], s[8:9]
    v_pk_mul_f32 v[216:217], v[208:209], s[8:9]
    v_pk_mul_f32 v[218:219], v[210:211], s[8:9]
    v_pk_mul_f32 v[232:233], v[224:225], s[8:9]
    v_pk_mul_f32 v[234:235], v[226:227], s[8:9]
    v_pk_mul_f32 v[248:249], v[240:241], s[8:9]
    v_pk_mul_f32 v[250:251], v[242:243], s[8:9]
    v_exp_f32 v200, v200
    v_exp_f32 v201, v201
    v_exp_f32 v202, v202
    v_exp_f32 v203, v203
    v_exp_f32 v216, v216
    v_exp_f32 v217, v217
    v_exp_f32 v218, v218
    v_exp_f32 v219, v219
    v_exp_f32 v232, v232
    v_exp_f32 v233, v233
    v_exp_f32 v234, v234
    v_exp_f32 v235, v235
    v_exp_f32 v248, v248
    v_exp_f32 v249, v249
    v_exp_f32 v250, v250
    v_exp_f32 v251, v251
    s_nop 0
    v_pk_add_f32 v[200:201], v[200:201], 1.0 op_sel_hi:[1,0]
    v_pk_add_f32 v[202:203], v[202:203], 1.0 op_sel_hi:[1,0]
    v_pk_add_f32 v[216:217], v[216:217], 1.0 op_sel_hi:[1,0]
    v_pk_add_f32 v[218:219], v[218:219], 1.0 op_sel_hi:[1,0]
    v_pk_add_f32 v[232:233], v[232:233], 1.0 op_sel_hi:[1,0]
    v_pk_add_f32 v[234:235], v[234:235], 1.0 op_sel_hi:[1,0]
    v_pk_add_f32 v[248:249], v[248:249], 1.0 op_sel_hi:[1,0]
    v_pk_add_f32 v[250:251], v[250:251], 1.0 op_sel_hi:[1,0]
    v_rcp_f32 v200, v200
    v_rcp_f32 v201, v201
    v_rcp_f32 v202, v202
    v_rcp_f32 v203, v203
    v_rcp_f32 v216, v216
    v_rcp_f32 v217, v217
    v_rcp_f32 v218, v218
    v_rcp_f32 v219, v219
    v_rcp_f32 v232, v232
    v_rcp_f32 v233, v233
    v_rcp_f32 v234, v234
    v_rcp_f32 v235, v235
    v_rcp_f32 v248, v248
    v_rcp_f32 v249, v249
    v_rcp_f32 v250, v250
    v_rcp_f32 v251, v251
    s_nop 0
    v_pk_mul_f32 v[192:193], v[192:193], v[200:201]
    v_pk_mul_f32 v[194:195], v[194:195], v[202:203]
    v_pk_mul_f32 v[208:209], v[208:209], v[216:217]
    v_pk_mul_f32 v[210:211], v[210:211], v[218:219]
    v_pk_mul_f32 v[224:225], v[224:225], v[232:233]
    v_pk_mul_f32 v[226:227], v[226:227], v[234:235]
    v_pk_mul_f32 v[240:241], v[240:241], v[248:249]
    v_pk_mul_f32 v[242:243], v[242:243], v[250:251]
    v_cvt_pk_bf16_f32 v104, v192, v193
    v_cvt_pk_bf16_f32 v105, v194, v195
    v_cvt_pk_bf16_f32 v106, v208, v209
    v_cvt_pk_bf16_f32 v107, v210, v211
    v_cvt_pk_bf16_f32 v108, v224, v225
    v_cvt_pk_bf16_f32 v109, v226, v227
    v_cvt_pk_bf16_f32 v110, v240, v241
    v_cvt_pk_bf16_f32 v111, v242, v243
    buffer_store_dwordx4 v[104:107], v1, s[28:31], 0 offen offset:2048 sc1
    buffer_store_dwordx4 v[108:111], v1, s[28:31], 0 offen offset:3072 sc1
    v_pk_mul_f32 v[140:141], v[132:133], s[8:9]
    v_pk_mul_f32 v[142:143], v[134:135], s[8:9]
    v_pk_mul_f32 v[156:157], v[148:149], s[8:9]
    v_pk_mul_f32 v[158:159], v[150:151], s[8:9]
    v_pk_mul_f32 v[172:173], v[164:165], s[8:9]
    v_pk_mul_f32 v[174:175], v[166:167], s[8:9]
    v_pk_mul_f32 v[188:189], v[180:181], s[8:9]
    v_pk_mul_f32 v[190:191], v[182:183], s[8:9]
    v_exp_f32 v140, v140
    v_exp_f32 v141, v141
    v_exp_f32 v142, v142
    v_exp_f32 v143, v143
    v_exp_f32 v156, v156
    v_exp_f32 v157, v157
    v_exp_f32 v158, v158
    v_exp_f32 v159, v159
    v_exp_f32 v172, v172
    v_exp_f32 v173, v173
    v_exp_f32 v174, v174
    v_exp_f32 v175, v175
    v_exp_f32 v188, v188
    v_exp_f32 v189, v189
    v_exp_f32 v190, v190
    v_exp_f32 v191, v191
    s_nop 0
    v_pk_add_f32 v[140:141], v[140:141], 1.0 op_sel_hi:[1,0]
    v_pk_add_f32 v[142:143], v[142:143], 1.0 op_sel_hi:[1,0]
    v_pk_add_f32 v[156:157], v[156:157], 1.0 op_sel_hi:[1,0]
    v_pk_add_f32 v[158:159], v[158:159], 1.0 op_sel_hi:[1,0]
    v_pk_add_f32 v[172:173], v[172:173], 1.0 op_sel_hi:[1,0]
    v_pk_add_f32 v[174:175], v[174:175], 1.0 op_sel_hi:[1,0]
    v_pk_add_f32 v[188:189], v[188:189], 1.0 op_sel_hi:[1,0]
    v_pk_add_f32 v[190:191], v[190:191], 1.0 op_sel_hi:[1,0]
    v_rcp_f32 v140, v140
    v_rcp_f32 v141, v141
    v_rcp_f32 v142, v142
    v_rcp_f32 v143, v143
    v_rcp_f32 v156, v156
    v_rcp_f32 v157, v157
    v_rcp_f32 v158, v158
    v_rcp_f32 v159, v159
    v_rcp_f32 v172, v172
    v_rcp_f32 v173, v173
    v_rcp_f32 v174, v174
    v_rcp_f32 v175, v175
    v_rcp_f32 v188, v188
    v_rcp_f32 v189, v189
    v_rcp_f32 v190, v190
    v_rcp_f32 v191, v191
    s_nop 0
    v_pk_mul_f32 v[132:133], v[132:133], v[140:141]
    v_pk_mul_f32 v[134:135], v[134:135], v[142:143]
    v_pk_mul_f32 v[148:149], v[148:149], v[156:157]
    v_pk_mul_f32 v[150:151], v[150:151], v[158:159]
    v_pk_mul_f32 v[164:165], v[164:165], v[172:173]
    v_pk_mul_f32 v[166:167], v[166:167], v[174:175]
    v_pk_mul_f32 v[180:181], v[180:181], v[188:189]
    v_pk_mul_f32 v[182:183], v[182:183], v[190:191]
    v_cvt_pk_bf16_f32 v112, v132, v133
    v_cvt_pk_bf16_f32 v113, v134, v135
    v_cvt_pk_bf16_f32 v114, v148, v149
    v_cvt_pk_bf16_f32 v115, v150, v151
    v_cvt_pk_bf16_f32 v116, v164, v165
    v_cvt_pk_bf16_f32 v117, v166, v167
    v_cvt_pk_bf16_f32 v118, v180, v181
    v_cvt_pk_bf16_f32 v119, v182, v183
    buffer_store_dwordx4 v[112:115], v1, s[28:31], s49 offen offset:0 sc1
    buffer_store_dwordx4 v[116:119], v1, s[28:31], s49 offen offset:1024 sc1
    v_pk_mul_f32 v[204:205], v[196:197], s[8:9]
    v_pk_mul_f32 v[206:207], v[198:199], s[8:9]
    v_pk_mul_f32 v[220:221], v[212:213], s[8:9]
    v_pk_mul_f32 v[222:223], v[214:215], s[8:9]
    v_pk_mul_f32 v[236:237], v[228:229], s[8:9]
    v_pk_mul_f32 v[238:239], v[230:231], s[8:9]
    v_pk_mul_f32 v[252:253], v[244:245], s[8:9]
    v_pk_mul_f32 v[254:255], v[246:247], s[8:9]
    v_exp_f32 v204, v204
    v_exp_f32 v205, v205
    v_exp_f32 v206, v206
    v_exp_f32 v207, v207
    v_exp_f32 v220, v220
    v_exp_f32 v221, v221
    v_exp_f32 v222, v222
    v_exp_f32 v223, v223
    v_exp_f32 v236, v236
    v_exp_f32 v237, v237
    v_exp_f32 v238, v238
    v_exp_f32 v239, v239
    v_exp_f32 v252, v252
    v_exp_f32 v253, v253
    v_exp_f32 v254, v254
    v_exp_f32 v255, v255
    s_nop 0
    v_pk_add_f32 v[204:205], v[204:205], 1.0 op_sel_hi:[1,0]
    v_pk_add_f32 v[206:207], v[206:207], 1.0 op_sel_hi:[1,0]
    v_pk_add_f32 v[220:221], v[220:221], 1.0 op_sel_hi:[1,0]
    v_pk_add_f32 v[222:223], v[222:223], 1.0 op_sel_hi:[1,0]
    v_pk_add_f32 v[236:237], v[236:237], 1.0 op_sel_hi:[1,0]
    v_pk_add_f32 v[238:239], v[238:239], 1.0 op_sel_hi:[1,0]
    v_pk_add_f32 v[252:253], v[252:253], 1.0 op_sel_hi:[1,0]
    v_pk_add_f32 v[254:255], v[254:255], 1.0 op_sel_hi:[1,0]
    v_rcp_f32 v204, v204
    v_rcp_f32 v205, v205
    v_rcp_f32 v206, v206
    v_rcp_f32 v207, v207
    v_rcp_f32 v220, v220
    v_rcp_f32 v221, v221
    v_rcp_f32 v222, v222
    v_rcp_f32 v223, v223
    v_rcp_f32 v236, v236
    v_rcp_f32 v237, v237
    v_rcp_f32 v238, v238
    v_rcp_f32 v239, v239
    v_rcp_f32 v252, v252
    v_rcp_f32 v253, v253
    v_rcp_f32 v254, v254
    v_rcp_f32 v255, v255
    s_nop 0
    v_pk_mul_f32 v[196:197], v[196:197], v[204:205]
    v_pk_mul_f32 v[198:199], v[198:199], v[206:207]
    v_pk_mul_f32 v[212:213], v[212:213], v[220:221]
    v_pk_mul_f32 v[214:215], v[214:215], v[222:223]
    v_pk_mul_f32 v[228:229], v[228:229], v[236:237]
    v_pk_mul_f32 v[230:231], v[230:231], v[238:239]
    v_pk_mul_f32 v[244:245], v[244:245], v[252:253]
    v_pk_mul_f32 v[246:247], v[246:247], v[254:255]
    v_cvt_pk_bf16_f32 v120, v196, v197
    v_cvt_pk_bf16_f32 v121, v198, v199
    v_cvt_pk_bf16_f32 v122, v212, v213
    v_cvt_pk_bf16_f32 v123, v214, v215
    v_cvt_pk_bf16_f32 v124, v228, v229
    v_cvt_pk_bf16_f32 v125, v230, v231
    v_cvt_pk_bf16_f32 v126, v244, v245
    v_cvt_pk_bf16_f32 v127, v246, v247
    buffer_store_dwordx4 v[120:123], v1, s[28:31], s49 offen offset:2048 sc1
    buffer_store_dwordx4 v[124:127], v1, s[28:31], s49 offen offset:3072 sc1
    s_waitcnt vmcnt(0)
    s_mov_b64 exec, 1
    buffer_store_dwordx2 v[26:27], v22, s[12:15], 0 offen sc1
    s_branch L_fin
L_fin_s:
    ds_read_b128 v[136:139], v31 offset:0
    ds_read_b128 v[152:155], v31 offset:1024
    ds_read_b128 v[168:171], v31 offset:2048
    ds_read_b128 v[184:187], v31 offset:3072
    ds_read_b128 v[200:203], v31 offset:4096
    ds_read_b128 v[216:219], v31 offset:5120
    ds_read_b128 v[232:235], v31 offset:6144
    ds_read_b128 v[248:251], v31 offset:7168
    s_cmp_lg_u64 s[74:75], 0
    s_cbranch_scc1 L_x
L_x_back:
    s_waitcnt vmcnt(4)
    v_lshlrev_b32 v140, 16, v96
    v_and_b32 v141, 0xffff0000, v96
    v_lshlrev_b32 v142, 16, v97
    v_and_b32 v143, 0xffff0000, v97
    v_lshlrev_b32 v156, 16, v98
    v_and_b32 v157, 0xffff0000, v98
    v_lshlrev_b32 v158, 16, v99
    v_and_b32 v159, 0xffff0000, v99
    v_lshlrev_b32 v172, 16, v100
    v_and_b32 v173, 0xffff0000, v100
    v_lshlrev_b32 v174, 16, v101
    v_and_b32 v175, 0xffff0000, v101
    v_lshlrev_b32 v188, 16, v102
    v_and_b32 v189, 0xffff0000, v102
    v_lshlrev_b32 v190, 16, v103
    v_and_b32 v191, 0xffff0000, v103
    v_lshlrev_b32 v204, 16, v104
    v_and_b32 v205, 0xffff0000, v104
    v_lshlrev_b32 v206, 16, v105
    v_and_b32 v207, 0xffff0000, v105
    v_lshlrev_b32 v220, 16, v106
    v_and_b32 v221, 0xffff0000, v106
    v_lshlrev_b32 v222, 16, v107
    v_and_b32 v223, 0xffff0000, v107
    v_lshlrev_b32 v236, 16, v108
    v_and_b32 v237, 0xffff0000, v108
    v_lshlrev_b32 v238, 16, v109
    v_and_b32 v239, 0xffff0000, v109
    v_lshlrev_b32 v252, 16, v110
    v_and_b32 v253, 0xffff0000, v110
    v_lshlrev_b32 v254, 16, v111
    v_and_b32 v255, 0xffff0000, v111
    s_waitcnt lgkmcnt(0)
    v_pk_add_f32 v[128:129], v[128:129], v[136:137]
    v_pk_add_f32 v[130:131], v[130:131], v[138:139]
    v_pk_add_f32 v[144:145], v[144:145], v[152:153]
    v_pk_add_f32 v[146:147], v[146:147], v[154:155]
    v_pk_add_f32 v[160:161], v[160:161], v[168:169]
    v_pk_add_f32 v[162:163], v[162:163], v[170:171]
    v_pk_add_f32 v[176:177], v[176:177], v[184:185]
    v_pk_add_f32 v[178:179], v[178:179], v[186:187]
    v_pk_add_f32 v[192:193], v[192:193], v[200:201]
    v_pk_add_f32 v[194:195], v[194:195], v[202:203]
    v_pk_add_f32 v[208:209], v[208:209], v[216:217]
    v_pk_add_f32 v[210:211], v[210:211], v[218:219]
    v_pk_add_f32 v[224:225], v[224:225], v[232:233]
    v_pk_add_f32 v[226:227], v[226:227], v[234:235]
    v_pk_add_f32 v[240:241], v[240:241], v[248:249]
    v_pk_add_f32 v[242:243], v[242:243], v[250:251]
    ds_read_b128 v[136:139], v31 offset:8192
    ds_read_b128 v[152:155], v31 offset:9216
    ds_read_b128 v[168:171], v31 offset:10240
    ds_read_b128 v[184:187], v31 offset:11264
    ds_read_b128 v[200:203], v31 offset:12288
    ds_read_b128 v[216:219], v31 offset:13312
    ds_read_b128 v[232:235], v31 offset:14336
    ds_read_b128 v[248:251], v31 offset:15360
    v_pk_fma_f32 v[128:129], v[128:129], v[140:141], v[32:33]
    v_pk_fma_f32 v[130:131], v[130:131], v[142:143], v[34:35]
    v_pk_fma_f32 v[144:145], v[144:145], v[156:157], v[36:37]
    v_pk_fma_f32 v[146:147], v[146:147], v[158:159], v[38:39]
    v_pk_fma_f32 v[160:161], v[160:161], v[172:173], v[40:41]
    v_pk_fma_f32 v[162:163], v[162:163], v[174:175], v[42:43]
    v_pk_fma_f32 v[176:177], v[176:177], v[188:189], v[44:45]
    v_pk_fma_f32 v[178:179], v[178:179], v[190:191], v[46:47]
    v_pk_fma_f32 v[192:193], v[192:193], v[204:205], v[48:49]
    v_pk_fma_f32 v[194:195], v[194:195], v[206:207], v[50:51]
    v_pk_fma_f32 v[208:209], v[208:209], v[220:221], v[52:53]
    v_pk_fma_f32 v[210:211], v[210:211], v[222:223], v[54:55]
    v_pk_fma_f32 v[224:225], v[224:225], v[236:237], v[56:57]
    v_pk_fma_f32 v[226:227], v[226:227], v[238:239], v[58:59]
    v_pk_fma_f32 v[240:241], v[240:241], v[252:253], v[60:61]
    v_pk_fma_f32 v[242:243], v[242:243], v[254:255], v[62:63]
    v_cvt_pk_bf16_f32 v128, v128, v129
    v_cvt_pk_bf16_f32 v129, v130, v131
    v_cvt_pk_bf16_f32 v144, v144, v145
    v_cvt_pk_bf16_f32 v145, v146, v147
    v_cvt_pk_bf16_f32 v160, v160, v161
    ds_write_b64 v29, v[128:129] offset:0
    v_cvt_pk_bf16_f32 v161, v162, v163
    v_cvt_pk_bf16_f32 v176, v176, v177
    v_cvt_pk_bf16_f32 v177, v178, v179
    ds_write_b64 v29, v[144:145] offset:32
    v_cvt_pk_bf16_f32 v192, v192, v193
    v_cvt_pk_bf16_f32 v193, v194, v195
    v_cvt_pk_bf16_f32 v208, v208, v209
    ds_write_b64 v29, v[160:161] offset:64
    v_cvt_pk_bf16_f32 v209, v210, v211
    v_cvt_pk_bf16_f32 v224, v224, v225
    v_cvt_pk_bf16_f32 v225, v226, v227
    ds_write_b64 v29, v[176:177] offset:96
    v_cvt_pk_bf16_f32 v240, v240, v241
    v_cvt_pk_bf16_f32 v241, v242, v243
    s_waitcnt vmcnt(0)
    ds_write_b64 v29, v[192:193] offset:128
    v_lshlrev_b32 v140, 16, v112
    v_and_b32 v141, 0xffff0000, v112
    v_lshlrev_b32 v142, 16, v113
    ds_write_b64 v29, v[208:209] offset:160
    v_and_b32 v143, 0xffff0000, v113
    v_lshlrev_b32 v156, 16, v114
    v_and_b32 v157, 0xffff0000, v114
    ds_write_b64 v29, v[224:225] offset:192
    v_lshlrev_b32 v158, 16, v115
    v_and_b32 v159, 0xffff0000, v115
    v_lshlrev_b32 v172, 16, v116
    ds_write_b64 v29, v[240:241] offset:224
    v_and_b32 v173, 0xffff0000, v116
    v_lshlrev_b32 v174, 16, v117
    v_and_b32 v175, 0xffff0000, v117
    v_lshlrev_b32 v188, 16, v118
    v_and_b32 v189, 0xffff0000, v118
    v_lshlrev_b32 v190, 16, v119
    v_and_b32 v191, 0xffff0000, v119
    v_lshlrev_b32 v204, 16, v120
    v_and_b32 v205, 0xffff0000, v120
    v_lshlrev_b32 v206, 16, v121
    v_and_b32 v207, 0xffff0000, v121
    v_lshlrev_b32 v220, 16, v122
    v_and_b32 v221, 0xffff0000, v122
    v_lshlrev_b32 v222, 16, v123
    v_and_b32 v223, 0xffff0000, v123
    v_lshlrev_b32 v236, 16, v124
    v_and_b32 v237, 0xffff0000, v124
    v_lshlrev_b32 v238, 16, v125
    v_and_b32 v239, 0xffff0000, v125
    v_lshlrev_b32 v252, 16, v126
    v_and_b32 v253, 0xffff0000, v126
    v_lshlrev_b32 v254, 16, v127
    v_and_b32 v255, 0xffff0000, v127
    s_waitcnt lgkmcnt(0)
    ds_read_b128 v[32:35], v30 offset:0
    ds_read_b128 v[36:39], v30 offset:1088
    ds_read_b128 v[40:43], v30 offset:2176
    ds_read_b128 v[44:47], v30 offset:3264
    v_pk_add_f32 v[132:133], v[132:133], v[136:137]
    v_pk_add_f32 v[134:135], v[134:135], v[138:139]
    v_pk_add_f32 v[148:149], v[148:149], v[152:153]
    v_pk_add_f32 v[150:151], v[150:151], v[154:155]
    v_pk_add_f32 v[164:165], v[164:165], v[168:169]
    v_pk_add_f32 v[166:167], v[166:167], v[170:171]
    v_pk_add_f32 v[180:181], v[180:181], v[184:185]
    v_pk_add_f32 v[182:183], v[182:183], v[186:187]
    v_pk_add_f32 v[196:197], v[196:197], v[200:201]
    v_pk_add_f32 v[198:199], v[198:199], v[202:203]
    v_pk_add_f32 v[212:213], v[212:213], v[216:217]
    v_pk_add_f32 v[214:215], v[214:215], v[218:219]
    v_pk_add_f32 v[228:229], v[228:229], v[232:233]
    v_pk_add_f32 v[230:231], v[230:231], v[234:235]
    v_pk_add_f32 v[244:245], v[244:245], v[248:249]
    v_pk_add_f32 v[246:247], v[246:247], v[250:251]
    v_pk_fma_f32 v[132:133], v[132:133], v[140:141], v[64:65]
    v_pk_fma_f32 v[134:135], v[134:135], v[142:143], v[66:67]
    v_pk_fma_f32 v[148:149], v[148:149], v[156:157], v[68:69]
    v_pk_fma_f32 v[150:151], v[150:151], v[158:159], v[70:71]
    v_pk_fma_f32 v[164:165], v[164:165], v[172:173], v[72:73]
    v_pk_fma_f32 v[166:167], v[166:167], v[174:175], v[74:75]
    v_pk_fma_f32 v[180:181], v[180:181], v[188:189], v[76:77]
    v_pk_fma_f32 v[182:183], v[182:183], v[190:191], v[78:79]
    v_pk_fma_f32 v[196:197], v[196:197], v[204:205], v[80:81]
    v_pk_fma_f32 v[198:199], v[198:199], v[206:207], v[82:83]
    v_pk_fma_f32 v[212:213], v[212:213], v[220:221], v[84:85]
    v_pk_fma_f32 v[214:215], v[214:215], v[222:223], v[86:87]
    v_pk_fma_f32 v[228:229], v[228:229], v[236:237], v[88:89]
    v_pk_fma_f32 v[230:231], v[230:231], v[238:239], v[90:91]
    v_pk_fma_f32 v[244:245], v[244:245], v[252:253], v[92:93]
    v_pk_fma_f32 v[246:247], v[246:247], v[254:255], v[94:95]
    s_mov_b32 s3, 0
    s_waitcnt lgkmcnt(3)
    buffer_store_dwordx4 v[32:35], v28, s[4:7], s3 offen sc1
    s_mov_b32 s3, 8192
    s_waitcnt lgkmcnt(2)
    buffer_store_dwordx4 v[36:39], v28, s[4:7], s3 offen sc1
    s_mov_b32 s3, 16384
    s_waitcnt lgkmcnt(1)
    buffer_store_dwordx4 v[40:43], v28, s[4:7], s3 offen sc1
    s_mov_b32 s3, 24576
    s_waitcnt lgkmcnt(0)
    buffer_store_dwordx4 v[44:47], v28, s[4:7], s3 offen sc1
    v_cvt_pk_bf16_f32 v132, v132, v133
    v_cvt_pk_bf16_f32 v133, v134, v135
    v_cvt_pk_bf16_f32 v148, v148, v149
    v_cvt_pk_bf16_f32 v149, v150, v151
    v_cvt_pk_bf16_f32 v164, v164, v165
    ds_write_b64 v29, v[132:133] offset:4352
    v_cvt_pk_bf16_f32 v165, v166, v167
    v_cvt_pk_bf16_f32 v180, v180, v181
    ds_write_b64 v29, v[148:149] offset:4384
    v_cvt_pk_bf16_f32 v181, v182, v183
    v_cvt_pk_bf16_f32 v196, v196, v197
    ds_write_b64 v29, v[164:165] offset:4416
    v_cvt_pk_bf16_f32 v197, v198, v199
    v_cvt_pk_bf16_f32 v212, v212, v213
    ds_write_b64 v29, v[180:181] offset:4448
    v_cvt_pk_bf16_f32 v213, v214, v215
    v_cvt_pk_bf16_f32 v228, v228, v229
    ds_write_b64 v29, v[196:197] offset:4480
    v_cvt_pk_bf16_f32 v229, v230, v231
    v_cvt_pk_bf16_f32 v244, v244, v245
    ds_write_b64 v29, v[212:213] offset:4512
    v_cvt_pk_bf16_f32 v245, v246, v247
    ds_write_b64 v29, v[228:229] offset:4544
    ds_write_b64 v29, v[244:245] offset:4576
    s_waitcnt lgkmcnt(0)
    ds_read_b128 v[48:51], v30 offset:4352
    ds_read_b128 v[52:55], v30 offset:5440
    ds_read_b128 v[56:59], v30 offset:6528
    ds_read_b128 v[60:63], v30 offset:7616
    s_mov_b32 s3, 32768
    s_waitcnt lgkmcnt(3)
    buffer_store_dwordx4 v[48:51], v28, s[4:7], s3 offen sc1
    s_mov_b32 s3, 40960
    s_waitcnt lgkmcnt(2)
    buffer_store_dwordx4 v[52:55], v28, s[4:7], s3 offen sc1
    s_mov_b32 s3, 49152
    s_waitcnt lgkmcnt(1)
    buffer_store_dwordx4 v[56:59], v28, s[4:7], s3 offen sc1
    s_mov_b32 s3, 57344
    s_waitcnt lgkmcnt(0)
    buffer_store_dwordx4 v[60:63], v28, s[4:7], s3 offen sc1
L_fin:
L_done:
    s_endpgm
L_h:
    s_mov_b32 s3, 16384
L_h_l:
    buffer_load_dwordx4 v[18:21], v1, s[12:15], 0 offen offset:256 sc1
    buffer_load_dwordx4 v[28:31], v1, s[12:15], 0 offen offset:1280 sc1
    s_waitcnt vmcnt(0)
    v_cmp_ne_u64 vcc, s[54:55], v[18:19]
    v_cmp_ne_u64 s[8:9], s[54:55], v[20:21]
    v_cmp_ne_u64 s[74:75], s[54:55], v[28:29]
    s_or_b64 s[8:9], s[8:9], vcc
    v_cmp_ne_u64 vcc, s[54:55], v[30:31]
    s_or_b64 s[8:9], s[8:9], s[74:75]
    s_or_b64 vcc, vcc, s[8:9]
    s_sub_u32 s3, s3, 1
    s_cmp_eq_u32 s3, 0
    s_cbranch_scc1 L_h_ok
    s_cbranch_vccnz L_h_l
    s_branch L_h_ok
L_x:
L_x2:
    s_mov_b32 s3, 16384
L_x2_l:
    buffer_load_dwordx2 v[24:25], v22, s[12:15], 0 offen sc1
    s_waitcnt vmcnt(0)
    v_cmp_ne_u64 vcc, s[54:55], v[24:25]
    s_sub_u32 s3, s3, 1
    s_cmp_eq_u32 s3, 0
    s_cbranch_scc1 L_x2_ok
    s_cbranch_vccnz L_x2_l
    s_branch L_x2_ok
L_x2_ok:
    buffer_load_dwordx4 v[96:99], v1, s[28:31], 0 offen offset:0 sc1
    buffer_load_dwordx4 v[100:103], v1, s[28:31], 0 offen offset:1024 sc1
    buffer_load_dwordx4 v[104:107], v1, s[28:31], 0 offen offset:2048 sc1
    buffer_load_dwordx4 v[108:111], v1, s[28:31], 0 offen offset:3072 sc1
    buffer_load_dwordx4 v[112:115], v1, s[28:31], s49 offen offset:0 sc1
    buffer_load_dwordx4 v[116:119], v1, s[28:31], s49 offen offset:1024 sc1
    buffer_load_dwordx4 v[120:123], v1, s[28:31], s49 offen offset:2048 sc1
    buffer_load_dwordx4 v[124:127], v1, s[28:31], s49 offen offset:3072 sc1
    s_branch L_x_back
L_slow:
    v_and_b32 v24, 15, v0
    v_lshrrev_b32 v25, 4, v0
    v_lshlrev_b32 v24, 8, v24
    v_lshl_add_u32 v23, v25, 4, v24
    v_mov_b32 v176, 0xff800000
    v_mov_b32 v177, 0xff800000
    v_mov_b32 v178, 0xff800000
    v_mov_b32 v179, 0xff800000
    s_mov_b32 s3, 0
L_slow1:
    buffer_load_dwordx4 v[32:35], v23, s[28:31], s3 offen offset:0
    buffer_load_dwordx4 v[36:39], v23, s[28:31], s3 offen offset:64
    buffer_load_dwordx4 v[40:43], v23, s[28:31], s3 offen offset:128
    buffer_load_dwordx4 v[44:47], v23, s[28:31], s3 offen offset:192
    s_waitcnt vmcnt(0)
    v_mfma_f32_16x16x32_bf16 v[64:67], v[32:35], a[128:131], 0
    v_mfma_f32_16x16x32_bf16 v[64:67], v[36:39], a[132:135], v[64:67]
    v_mfma_f32_16x16x32_bf16 v[64:67], v[40:43], a[136:139], v[64:67]
    v_mfma_f32_16x16x32_bf16 v[64:67], v[44:47], a[140:143], v[64:67]
    v_mfma_f32_16x16x32_bf16 v[68:71], v[32:35], a[144:147], 0
    v_mfma_f32_16x16x32_bf16 v[68:71], v[36:39], a[148:151], v[68:71]
    v_mfma_f32_16x16x32_bf16 v[68:71], v[40:43], a[152:155], v[68:71]
    v_mfma_f32_16x16x32_bf16 v[68:71], v[44:47], a[156:159], v[68:71]
    v_mfma_f32_16x16x32_bf16 v[72:75], v[32:35], a[160:163], 0
    v_mfma_f32_16x16x32_bf16 v[72:75], v[36:39], a[164:167], v[72:75]
    v_mfma_f32_16x16x32_bf16 v[72:75], v[40:43], a[168:171], v[72:75]
    v_mfma_f32_16x16x32_bf16 v[72:75], v[44:47], a[172:175], v[72:75]
    v_mfma_f32_16x16x32_bf16 v[76:79], v[32:35], a[176:179], 0
    v_mfma_f32_16x16x32_bf16 v[76:79], v[36:39], a[180:183], v[76:79]
    v_mfma_f32_16x16x32_bf16 v[76:79], v[40:43], a[184:187], v[76:79]
    v_mfma_f32_16x16x32_bf16 v[76:79], v[44:47], a[188:191], v[76:79]
    s_nop 7
    v_max3_f32 v176, v64, v65, v176
    v_max3_f32 v176, v66, v67, v176
    v_max3_f32 v177, v68, v69, v177
    v_max3_f32 v177, v70, v71, v177
    v_max3_f32 v178, v72, v73, v178
    v_max3_f32 v178, v74, v75, v178
    v_max3_f32 v179, v76, v77, v179
    v_max3_f32 v179, v78, v79, v179
    s_add_u32 s3, s3, 4096
    s_cmp_lt_u32 s3, 131072
    s_cbranch_scc1 L_slow1
    v_mov_b32 v180, v176
    v_mov_b32 v181, v177
    v_mov_b32 v182, v178
    v_mov_b32 v183, v179
    s_nop 1
    v_permlane16_swap_b32 v176, v180
    v_permlane16_swap_b32 v177, v181
    v_permlane16_swap_b32 v178, v182
    v_permlane16_swap_b32 v179, v183
    v_max_f32 v176, v176, v180
    v_max_f32 v177, v177, v181
    v_max_f32 v178, v178, v182
    v_max_f32 v179, v179, v183
    v_mov_b32 v180, v176
    v_mov_b32 v181, v177
    v_mov_b32 v182, v178
    v_mov_b32 v183, v179
    s_nop 1
    v_permlane32_swap_b32 v176, v180
    v_permlane32_swap_b32 v177, v181
    v_permlane32_swap_b32 v178, v182
    v_permlane32_swap_b32 v179, v183
    v_max_f32 v176, v176, v180
    v_max_f32 v177, v177, v181
    v_max_f32 v178, v178, v182
    v_max_f32 v179, v179, v183
    v_sub_f32 v224, 0, v176
    v_sub_f32 v225, 0, v176
    v_sub_f32 v226, 0, v176
    v_sub_f32 v227, 0, v176
    v_sub_f32 v228, 0, v177
    v_sub_f32 v229, 0, v177
    v_sub_f32 v230, 0, v177
    v_sub_f32 v231, 0, v177
    v_sub_f32 v232, 0, v178
    v_sub_f32 v233, 0, v178
    v_sub_f32 v234, 0, v178
    v_sub_f32 v235, 0, v178
    v_sub_f32 v236, 0, v179
    v_sub_f32 v237, 0, v179
    v_sub_f32 v238, 0, v179
    v_sub_f32 v239, 0, v179
    v_mov_b32 v192, 0
    v_mov_b32 v193, 0
    v_mov_b32 v194, 0
    v_mov_b32 v195, 0
    v_lshrrev_b32 v24, 4, v0
    v_bfe_u32 v25, v0, 1, 3
    v_and_b32 v20, 1, v0
    v_lshlrev_b32 v20, 4, v20
    v_lshl_add_u32 v20, v24, 8, v20
    v_xor_b32 v21, v24, v25
    v_xor_b32 v24, 4, v21
    v_lshl_add_u32 v21, v21, 5, v20
    v_lshl_add_u32 v20, v24, 5, v20
    s_sub_u32 s8, s67, 131072
    v_add_u32 v184, s8, v244
    v_add_u32 v185, s8, v245
    v_add_u32 v186, s8, v246
    v_add_u32 v187, s8, v247
    v_add_u32 v188, s8, v248
    v_add_u32 v189, s8, v249
    v_add_u32 v190, s8, v250
    v_add_u32 v191, s8, v251
    v_mfma_f32_32x32x16_bf16 a[0:15], v[192:195], v[192:195], 0
    v_mfma_f32_32x32x16_bf16 a[16:31], v[192:195], v[192:195], 0
    v_mfma_f32_32x32x16_bf16 a[32:47], v[192:195], v[192:195], 0
    v_mfma_f32_32x32x16_bf16 a[48:63], v[192:195], v[192:195], 0
    v_mfma_f32_32x32x16_bf16 a[64:79], v[192:195], v[192:195], 0
    v_mfma_f32_32x32x16_bf16 a[80:95], v[192:195], v[192:195], 0
    v_mfma_f32_32x32x16_bf16 a[96:111], v[192:195], v[192:195], 0
    v_mfma_f32_32x32x16_bf16 a[112:127], v[192:195], v[192:195], 0
    v_mfma_f32_32x32x16_bf16 a[224:239], v[192:195], v[192:195], 0
    s_mov_b32 s3, 0
L_slow2:
    s_add_u32 s9, s3, 4096
    buffer_load_dwordx4 v[32:35], v23, s[28:31], s3 offen offset:0
    buffer_load_dwordx4 v[36:39], v23, s[28:31], s3 offen offset:64
    buffer_load_dwordx4 v[40:43], v23, s[28:31], s3 offen offset:128
    buffer_load_dwordx4 v[44:47], v23, s[28:31], s3 offen offset:192
    buffer_load_dwordx4 v[48:51], v23, s[28:31], s9 offen offset:0
    buffer_load_dwordx4 v[52:55], v23, s[28:31], s9 offen offset:64
    buffer_load_dwordx4 v[56:59], v23, s[28:31], s9 offen offset:128
    buffer_load_dwordx4 v[60:63], v23, s[28:31], s9 offen offset:192
    s_add_u32 m0, s67, 0
    s_nop 0
    buffer_load_dwordx4 v21, s[32:35], s3 offen offset:0 lds
    buffer_load_dwordx4 v20, s[32:35], s3 offen offset:1024 lds
    buffer_load_dwordx4 v21, s[32:35], s3 offen offset:2048 lds
    buffer_load_dwordx4 v20, s[32:35], s3 offen offset:3072 lds
    s_add_u32 m0, s67, 4096
    s_nop 0
    buffer_load_dwordx4 v21, s[32:35], s9 offen offset:0 lds
    buffer_load_dwordx4 v20, s[32:35], s9 offen offset:1024 lds
    buffer_load_dwordx4 v21, s[32:35], s9 offen offset:2048 lds
    buffer_load_dwordx4 v20, s[32:35], s9 offen offset:3072 lds
    s_waitcnt vmcnt(0)
    ds_read_b64_tr_b16 v[112:113], v184 offset:32768
    ds_read_b64_tr_b16 v[114:115], v184 offset:36864
    ds_read_b64_tr_b16 v[116:117], v185 offset:32768
    ds_read_b64_tr_b16 v[118:119], v185 offset:36864
    ds_read_b64_tr_b16 v[120:121], v186 offset:32768
    ds_read_b64_tr_b16 v[122:123], v186 offset:36864
    ds_read_b64_tr_b16 v[124:125], v187 offset:32768
    ds_read_b64_tr_b16 v[126:127], v187 offset:36864
    ds_read_b64_tr_b16 v[128:129], v188 offset:32768
    ds_read_b64_tr_b16 v[130:131], v188 offset:36864
    ds_read_b64_tr_b16 v[132:133], v189 offset:32768
    ds_read_b64_tr_b16 v[134:135], v189 offset:36864
    ds_read_b64_tr_b16 v[136:137], v190 offset:32768
    ds_read_b64_tr_b16 v[138:139], v190 offset:36864
    ds_read_b64_tr_b16 v[140:141], v191 offset:32768
    ds_read_b64_tr_b16 v[142:143], v191 offset:36864
    v_mfma_f32_16x16x32_bf16 v[64:67], v[32:35], a[128:131], v[224:227]
    v_mfma_f32_16x16x32_bf16 v[64:67], v[36:39], a[132:135], v[64:67]
    v_mfma_f32_16x16x32_bf16 v[64:67], v[40:43], a[136:139], v[64:67]
    v_mfma_f32_16x16x32_bf16 v[64:67], v[44:47], a[140:143], v[64:67]
    v_mfma_f32_16x16x32_bf16 v[68:71], v[32:35], a[144:147], v[228:231]
    v_mfma_f32_16x16x32_bf16 v[68:71], v[36:39], a[148:151], v[68:71]
    v_mfma_f32_16x16x32_bf16 v[68:71], v[40:43], a[152:155], v[68:71]
    v_mfma_f32_16x16x32_bf16 v[68:71], v[44:47], a[156:159], v[68:71]
    v_mfma_f32_16x16x32_bf16 v[72:75], v[32:35], a[160:163], v[232:235]
    v_mfma_f32_16x16x32_bf16 v[72:75], v[36:39], a[164:167], v[72:75]
    v_mfma_f32_16x16x32_bf16 v[72:75], v[40:43], a[168:171], v[72:75]
    v_mfma_f32_16x16x32_bf16 v[72:75], v[44:47], a[172:175], v[72:75]
    v_mfma_f32_16x16x32_bf16 v[76:79], v[32:35], a[176:179], v[236:239]
    v_mfma_f32_16x16x32_bf16 v[76:79], v[36:39], a[180:183], v[76:79]
    v_mfma_f32_16x16x32_bf16 v[76:79], v[40:43], a[184:187], v[76:79]
    v_mfma_f32_16x16x32_bf16 v[76:79], v[44:47], a[188:191], v[76:79]
    v_mfma_f32_16x16x32_bf16 v[80:83], v[48:51], a[128:131], v[224:227]
    v_mfma_f32_16x16x32_bf16 v[80:83], v[52:55], a[132:135], v[80:83]
    v_mfma_f32_16x16x32_bf16 v[80:83], v[56:59], a[136:139], v[80:83]
    v_mfma_f32_16x16x32_bf16 v[80:83], v[60:63], a[140:143], v[80:83]
    v_mfma_f32_16x16x32_bf16 v[84:87], v[48:51], a[144:147], v[228:231]
    v_mfma_f32_16x16x32_bf16 v[84:87], v[52:55], a[148:151], v[84:87]
    v_mfma_f32_16x16x32_bf16 v[84:87], v[56:59], a[152:155], v[84:87]
    v_mfma_f32_16x16x32_bf16 v[84:87], v[60:63], a[156:159], v[84:87]
    v_mfma_f32_16x16x32_bf16 v[88:91], v[48:51], a[160:163], v[232:235]
    v_mfma_f32_16x16x32_bf16 v[88:91], v[52:55], a[164:167], v[88:91]
    v_mfma_f32_16x16x32_bf16 v[88:91], v[56:59], a[168:171], v[88:91]
    v_mfma_f32_16x16x32_bf16 v[88:91], v[60:63], a[172:175], v[88:91]
    v_mfma_f32_16x16x32_bf16 v[92:95], v[48:51], a[176:179], v[236:239]
    v_mfma_f32_16x16x32_bf16 v[92:95], v[52:55], a[180:183], v[92:95]
    v_mfma_f32_16x16x32_bf16 v[92:95], v[56:59], a[184:187], v[92:95]
    v_mfma_f32_16x16x32_bf16 v[92:95], v[60:63], a[188:191], v[92:95]
    s_nop 7
    v_exp_f32 v64, v64
    v_exp_f32 v65, v65
    v_exp_f32 v66, v66
    v_exp_f32 v67, v67
    v_exp_f32 v68, v68
    v_exp_f32 v69, v69
    v_exp_f32 v70, v70
    v_exp_f32 v71, v71
    v_exp_f32 v72, v72
    v_exp_f32 v73, v73
    v_exp_f32 v74, v74
    v_exp_f32 v75, v75
    v_exp_f32 v76, v76
    v_exp_f32 v77, v77
    v_exp_f32 v78, v78
    v_exp_f32 v79, v79
    v_exp_f32 v80, v80
    v_exp_f32 v81, v81
    v_exp_f32 v82, v82
    v_exp_f32 v83, v83
    v_exp_f32 v84, v84
    v_exp_f32 v85, v85
    v_exp_f32 v86, v86
    v_exp_f32 v87, v87
    v_exp_f32 v88, v88
    v_exp_f32 v89, v89
    v_exp_f32 v90, v90
    v_exp_f32 v91, v91
    v_exp_f32 v92, v92
    v_exp_f32 v93, v93
    v_exp_f32 v94, v94
    v_exp_f32 v95, v95
    s_nop 0
    v_cvt_pk_bf16_f32 v96, v64, v65
    v_cvt_pk_bf16_f32 v97, v66, v67
    v_cvt_pk_bf16_f32 v98, v80, v81
    v_cvt_pk_bf16_f32 v99, v82, v83
    v_cvt_pk_bf16_f32 v100, v68, v69
    v_cvt_pk_bf16_f32 v101, v70, v71
    v_cvt_pk_bf16_f32 v102, v84, v85
    v_cvt_pk_bf16_f32 v103, v86, v87
    v_cvt_pk_bf16_f32 v104, v72, v73
    v_cvt_pk_bf16_f32 v105, v74, v75
    v_cvt_pk_bf16_f32 v106, v88, v89
    v_cvt_pk_bf16_f32 v107, v90, v91
    v_cvt_pk_bf16_f32 v108, v76, v77
    v_cvt_pk_bf16_f32 v109, v78, v79
    v_cvt_pk_bf16_f32 v110, v92, v93
    v_cvt_pk_bf16_f32 v111, v94, v95
    s_waitcnt lgkmcnt(0)
    s_nop 1
    v_mfma_f32_16x16x32_bf16 a[224:227], a[240:243], v[96:99], a[224:227]
    v_mfma_f32_16x16x32_bf16 a[0:3], v[112:115], v[96:99], a[0:3]
    v_mfma_f32_16x16x32_bf16 a[16:19], v[116:119], v[96:99], a[16:19]
    v_mfma_f32_16x16x32_bf16 a[32:35], v[120:123], v[96:99], a[32:35]
    v_mfma_f32_16x16x32_bf16 a[48:51], v[124:127], v[96:99], a[48:51]
    v_mfma_f32_16x16x32_bf16 a[64:67], v[128:131], v[96:99], a[64:67]
    v_mfma_f32_16x16x32_bf16 a[80:83], v[132:135], v[96:99], a[80:83]
    v_mfma_f32_16x16x32_bf16 a[96:99], v[136:139], v[96:99], a[96:99]
    v_mfma_f32_16x16x32_bf16 a[112:115], v[140:143], v[96:99], a[112:115]
    v_mfma_f32_16x16x32_bf16 a[228:231], a[240:243], v[100:103], a[228:231]
    v_mfma_f32_16x16x32_bf16 a[4:7], v[112:115], v[100:103], a[4:7]
    v_mfma_f32_16x16x32_bf16 a[20:23], v[116:119], v[100:103], a[20:23]
    v_mfma_f32_16x16x32_bf16 a[36:39], v[120:123], v[100:103], a[36:39]
    v_mfma_f32_16x16x32_bf16 a[52:55], v[124:127], v[100:103], a[52:55]
    v_mfma_f32_16x16x32_bf16 a[68:71], v[128:131], v[100:103], a[68:71]
    v_mfma_f32_16x16x32_bf16 a[84:87], v[132:135], v[100:103], a[84:87]
    v_mfma_f32_16x16x32_bf16 a[100:103], v[136:139], v[100:103], a[100:103]
    v_mfma_f32_16x16x32_bf16 a[116:119], v[140:143], v[100:103], a[116:119]
    v_mfma_f32_16x16x32_bf16 a[232:235], a[240:243], v[104:107], a[232:235]
    v_mfma_f32_16x16x32_bf16 a[8:11], v[112:115], v[104:107], a[8:11]
    v_mfma_f32_16x16x32_bf16 a[24:27], v[116:119], v[104:107], a[24:27]
    v_mfma_f32_16x16x32_bf16 a[40:43], v[120:123], v[104:107], a[40:43]
    v_mfma_f32_16x16x32_bf16 a[56:59], v[124:127], v[104:107], a[56:59]
    v_mfma_f32_16x16x32_bf16 a[72:75], v[128:131], v[104:107], a[72:75]
    v_mfma_f32_16x16x32_bf16 a[88:91], v[132:135], v[104:107], a[88:91]
    v_mfma_f32_16x16x32_bf16 a[104:107], v[136:139], v[104:107], a[104:107]
    v_mfma_f32_16x16x32_bf16 a[120:123], v[140:143], v[104:107], a[120:123]
    v_mfma_f32_16x16x32_bf16 a[236:239], a[240:243], v[108:111], a[236:239]
    v_mfma_f32_16x16x32_bf16 a[12:15], v[112:115], v[108:111], a[12:15]
    v_mfma_f32_16x16x32_bf16 a[28:31], v[116:119], v[108:111], a[28:31]
    v_mfma_f32_16x16x32_bf16 a[44:47], v[120:123], v[108:111], a[44:47]
    v_mfma_f32_16x16x32_bf16 a[60:63], v[124:127], v[108:111], a[60:63]
    v_mfma_f32_16x16x32_bf16 a[76:79], v[128:131], v[108:111], a[76:79]
    v_mfma_f32_16x16x32_bf16 a[92:95], v[132:135], v[108:111], a[92:95]
    v_mfma_f32_16x16x32_bf16 a[108:111], v[136:139], v[108:111], a[108:111]
    v_mfma_f32_16x16x32_bf16 a[124:127], v[140:143], v[108:111], a[124:127]
    s_add_u32 s3, s3, 8192
    s_cmp_lt_u32 s3, 131072
    s_cbranch_scc1 L_slow2
    s_nop 7
    v_accvgpr_read_b32 v24, a224
    v_rcp_f32 v24, v24
    v_accvgpr_read_b32 v96, a0
    v_accvgpr_read_b32 v97, a1
    v_accvgpr_read_b32 v98, a2
    v_accvgpr_read_b32 v99, a3
    v_accvgpr_read_b32 v112, a16
    v_accvgpr_read_b32 v113, a17
    v_accvgpr_read_b32 v114, a18
    v_accvgpr_read_b32 v115, a19
    v_accvgpr_read_b32 v128, a32
    v_accvgpr_read_b32 v129, a33
    v_accvgpr_read_b32 v130, a34
    v_accvgpr_read_b32 v131, a35
    v_accvgpr_read_b32 v144, a48
    v_accvgpr_read_b32 v145, a49
    v_accvgpr_read_b32 v146, a50
    v_accvgpr_read_b32 v147, a51
    v_pk_mul_f32 v[96:97], v[96:97], v[24:25] op_sel_hi:[1,0]
    v_pk_mul_f32 v[98:99], v[98:99], v[24:25] op_sel_hi:[1,0]
    v_pk_mul_f32 v[112:113], v[112:113], v[24:25] op_sel_hi:[1,0]
    v_pk_mul_f32 v[114:115], v[114:115], v[24:25] op_sel_hi:[1,0]
    v_cvt_pk_bf16_f32 v96, v96, v97
    v_cvt_pk_bf16_f32 v97, v98, v99
    v_cvt_pk_bf16_f32 v98, v112, v113
    v_cvt_pk_bf16_f32 v99, v114, v115
    buffer_store_dwordx4 v[96:99], v4, s[40:43], 0 offen offset:0 sc1
    v_pk_mul_f32 v[128:129], v[128:129], v[24:25] op_sel_hi:[1,0]
    v_pk_mul_f32 v[130:131], v[130:131], v[24:25] op_sel_hi:[1,0]
    v_pk_mul_f32 v[144:145], v[144:145], v[24:25] op_sel_hi:[1,0]
    v_pk_mul_f32 v[146:147], v[146:147], v[24:25] op_sel_hi:[1,0]
    v_cvt_pk_bf16_f32 v128, v128, v129
    v_cvt_pk_bf16_f32 v129, v130, v131
    v_cvt_pk_bf16_f32 v130, v144, v145
    v_cvt_pk_bf16_f32 v131, v146, v147
    buffer_store_dwordx4 v[128:131], v8, s[40:43], s49 offen offset:0 sc1
    v_accvgpr_read_b32 v96, a64
    v_accvgpr_read_b32 v97, a65
    v_accvgpr_read_b32 v98, a66
    v_accvgpr_read_b32 v99, a67
    v_accvgpr_read_b32 v112, a80
    v_accvgpr_read_b32 v113, a81
    v_accvgpr_read_b32 v114, a82
    v_accvgpr_read_b32 v115, a83
    v_accvgpr_read_b32 v128, a96
    v_accvgpr_read_b32 v129, a97
    v_accvgpr_read_b32 v130, a98
    v_accvgpr_read_b32 v131, a99
    v_accvgpr_read_b32 v144, a112
    v_accvgpr_read_b32 v145, a113
    v_accvgpr_read_b32 v146, a114
    v_accvgpr_read_b32 v147, a115
    v_pk_mul_f32 v[96:97], v[96:97], v[24:25] op_sel_hi:[1,0]
    v_pk_mul_f32 v[98:99], v[98:99], v[24:25] op_sel_hi:[1,0]
    v_pk_mul_f32 v[112:113], v[112:113], v[24:25] op_sel_hi:[1,0]
    v_pk_mul_f32 v[114:115], v[114:115], v[24:25] op_sel_hi:[1,0]
    v_cvt_pk_bf16_f32 v96, v96, v97
    v_cvt_pk_bf16_f32 v97, v98, v99
    v_cvt_pk_bf16_f32 v98, v112, v113
    v_cvt_pk_bf16_f32 v99, v114, v115
    buffer_store_dwordx4 v[96:99], v4, s[40:43], s50 offen offset:0 sc1
    v_pk_mul_f32 v[128:129], v[128:129], v[24:25] op_sel_hi:[1,0]
    v_pk_mul_f32 v[130:131], v[130:131], v[24:25] op_sel_hi:[1,0]
    v_pk_mul_f32 v[144:145], v[144:145], v[24:25] op_sel_hi:[1,0]
    v_pk_mul_f32 v[146:147], v[146:147], v[24:25] op_sel_hi:[1,0]
    v_cvt_pk_bf16_f32 v128, v128, v129
    v_cvt_pk_bf16_f32 v129, v130, v131
    v_cvt_pk_bf16_f32 v130, v144, v145
    v_cvt_pk_bf16_f32 v131, v146, v147
    buffer_store_dwordx4 v[128:131], v8, s[40:43], s53 offen offset:0 sc1
    v_accvgpr_read_b32 v24, a228
    v_rcp_f32 v24, v24
    v_accvgpr_read_b32 v100, a4
    v_accvgpr_read_b32 v101, a5
    v_accvgpr_read_b32 v102, a6
    v_accvgpr_read_b32 v103, a7
    v_accvgpr_read_b32 v116, a20
    v_accvgpr_read_b32 v117, a21
    v_accvgpr_read_b32 v118, a22
    v_accvgpr_read_b32 v119, a23
    v_accvgpr_read_b32 v132, a36
    v_accvgpr_read_b32 v133, a37
    v_accvgpr_read_b32 v134, a38
    v_accvgpr_read_b32 v135, a39
    v_accvgpr_read_b32 v148, a52
    v_accvgpr_read_b32 v149, a53
    v_accvgpr_read_b32 v150, a54
    v_accvgpr_read_b32 v151, a55
    v_pk_mul_f32 v[100:101], v[100:101], v[24:25] op_sel_hi:[1,0]
    v_pk_mul_f32 v[102:103], v[102:103], v[24:25] op_sel_hi:[1,0]
    v_pk_mul_f32 v[116:117], v[116:117], v[24:25] op_sel_hi:[1,0]
    v_pk_mul_f32 v[118:119], v[118:119], v[24:25] op_sel_hi:[1,0]
    v_cvt_pk_bf16_f32 v100, v100, v101
    v_cvt_pk_bf16_f32 v101, v102, v103
    v_cvt_pk_bf16_f32 v102, v116, v117
    v_cvt_pk_bf16_f32 v103, v118, v119
    buffer_store_dwordx4 v[100:103], v5, s[40:43], 0 offen offset:1024 sc1
    v_pk_mul_f32 v[132:133], v[132:133], v[24:25] op_sel_hi:[1,0]
    v_pk_mul_f32 v[134:135], v[134:135], v[24:25] op_sel_hi:[1,0]
    v_pk_mul_f32 v[148:149], v[148:149], v[24:25] op_sel_hi:[1,0]
    v_pk_mul_f32 v[150:151], v[150:151], v[24:25] op_sel_hi:[1,0]
    v_cvt_pk_bf16_f32 v132, v132, v133
    v_cvt_pk_bf16_f32 v133, v134, v135
    v_cvt_pk_bf16_f32 v134, v148, v149
    v_cvt_pk_bf16_f32 v135, v150, v151
    buffer_store_dwordx4 v[132:135], v9, s[40:43], s49 offen offset:1024 sc1
    v_accvgpr_read_b32 v100, a68
    v_accvgpr_read_b32 v101, a69
    v_accvgpr_read_b32 v102, a70
    v_accvgpr_read_b32 v103, a71
    v_accvgpr_read_b32 v116, a84
    v_accvgpr_read_b32 v117, a85
    v_accvgpr_read_b32 v118, a86
    v_accvgpr_read_b32 v119, a87
    v_accvgpr_read_b32 v132, a100
    v_accvgpr_read_b32 v133, a101
    v_accvgpr_read_b32 v134, a102
    v_accvgpr_read_b32 v135, a103
    v_accvgpr_read_b32 v148, a116
    v_accvgpr_read_b32 v149, a117
    v_accvgpr_read_b32 v150, a118
    v_accvgpr_read_b32 v151, a119
    v_pk_mul_f32 v[100:101], v[100:101], v[24:25] op_sel_hi:[1,0]
    v_pk_mul_f32 v[102:103], v[102:103], v[24:25] op_sel_hi:[1,0]
    v_pk_mul_f32 v[116:117], v[116:117], v[24:25] op_sel_hi:[1,0]
    v_pk_mul_f32 v[118:119], v[118:119], v[24:25] op_sel_hi:[1,0]
    v_cvt_pk_bf16_f32 v100, v100, v101
    v_cvt_pk_bf16_f32 v101, v102, v103
    v_cvt_pk_bf16_f32 v102, v116, v117
    v_cvt_pk_bf16_f32 v103, v118, v119
    buffer_store_dwordx4 v[100:103], v5, s[40:43], s50 offen offset:1024 sc1
    v_pk_mul_f32 v[132:133], v[132:133], v[24:25] op_sel_hi:[1,0]
    v_pk_mul_f32 v[134:135], v[134:135], v[24:25] op_sel_hi:[1,0]
    v_pk_mul_f32 v[148:149], v[148:149], v[24:25] op_sel_hi:[1,0]
    v_pk_mul_f32 v[150:151], v[150:151], v[24:25] op_sel_hi:[1,0]
    v_cvt_pk_bf16_f32 v132, v132, v133
    v_cvt_pk_bf16_f32 v133, v134, v135
    v_cvt_pk_bf16_f32 v134, v148, v149
    v_cvt_pk_bf16_f32 v135, v150, v151
    buffer_store_dwordx4 v[132:135], v9, s[40:43], s53 offen offset:1024 sc1
    v_accvgpr_read_b32 v24, a232
    v_rcp_f32 v24, v24
    v_accvgpr_read_b32 v104, a8
    v_accvgpr_read_b32 v105, a9
    v_accvgpr_read_b32 v106, a10
    v_accvgpr_read_b32 v107, a11
    v_accvgpr_read_b32 v120, a24
    v_accvgpr_read_b32 v121, a25
    v_accvgpr_read_b32 v122, a26
    v_accvgpr_read_b32 v123, a27
    v_accvgpr_read_b32 v136, a40
    v_accvgpr_read_b32 v137, a41
    v_accvgpr_read_b32 v138, a42
    v_accvgpr_read_b32 v139, a43
    v_accvgpr_read_b32 v152, a56
    v_accvgpr_read_b32 v153, a57
    v_accvgpr_read_b32 v154, a58
    v_accvgpr_read_b32 v155, a59
    v_pk_mul_f32 v[104:105], v[104:105], v[24:25] op_sel_hi:[1,0]
    v_pk_mul_f32 v[106:107], v[106:107], v[24:25] op_sel_hi:[1,0]
    v_pk_mul_f32 v[120:121], v[120:121], v[24:25] op_sel_hi:[1,0]
    v_pk_mul_f32 v[122:123], v[122:123], v[24:25] op_sel_hi:[1,0]
    v_cvt_pk_bf16_f32 v104, v104, v105
    v_cvt_pk_bf16_f32 v105, v106, v107
    v_cvt_pk_bf16_f32 v106, v120, v121
    v_cvt_pk_bf16_f32 v107, v122, v123
    buffer_store_dwordx4 v[104:107], v6, s[40:43], 0 offen offset:2048 sc1
    v_pk_mul_f32 v[136:137], v[136:137], v[24:25] op_sel_hi:[1,0]
    v_pk_mul_f32 v[138:139], v[138:139], v[24:25] op_sel_hi:[1,0]
    v_pk_mul_f32 v[152:153], v[152:153], v[24:25] op_sel_hi:[1,0]
    v_pk_mul_f32 v[154:155], v[154:155], v[24:25] op_sel_hi:[1,0]
    v_cvt_pk_bf16_f32 v136, v136, v137
    v_cvt_pk_bf16_f32 v137, v138, v139
    v_cvt_pk_bf16_f32 v138, v152, v153
    v_cvt_pk_bf16_f32 v139, v154, v155
    buffer_store_dwordx4 v[136:139], v10, s[40:43], s49 offen offset:2048 sc1
    v_accvgpr_read_b32 v104, a72
    v_accvgpr_read_b32 v105, a73
    v_accvgpr_read_b32 v106, a74
    v_accvgpr_read_b32 v107, a75
    v_accvgpr_read_b32 v120, a88
    v_accvgpr_read_b32 v121, a89
    v_accvgpr_read_b32 v122, a90
    v_accvgpr_read_b32 v123, a91
    v_accvgpr_read_b32 v136, a104
    v_accvgpr_read_b32 v137, a105
    v_accvgpr_read_b32 v138, a106
    v_accvgpr_read_b32 v139, a107
    v_accvgpr_read_b32 v152, a120
    v_accvgpr_read_b32 v153, a121
    v_accvgpr_read_b32 v154, a122
    v_accvgpr_read_b32 v155, a123
    v_pk_mul_f32 v[104:105], v[104:105], v[24:25] op_sel_hi:[1,0]
    v_pk_mul_f32 v[106:107], v[106:107], v[24:25] op_sel_hi:[1,0]
    v_pk_mul_f32 v[120:121], v[120:121], v[24:25] op_sel_hi:[1,0]
    v_pk_mul_f32 v[122:123], v[122:123], v[24:25] op_sel_hi:[1,0]
    v_cvt_pk_bf16_f32 v104, v104, v105
    v_cvt_pk_bf16_f32 v105, v106, v107
    v_cvt_pk_bf16_f32 v106, v120, v121
    v_cvt_pk_bf16_f32 v107, v122, v123
    buffer_store_dwordx4 v[104:107], v6, s[40:43], s50 offen offset:2048 sc1
    v_pk_mul_f32 v[136:137], v[136:137], v[24:25] op_sel_hi:[1,0]
    v_pk_mul_f32 v[138:139], v[138:139], v[24:25] op_sel_hi:[1,0]
    v_pk_mul_f32 v[152:153], v[152:153], v[24:25] op_sel_hi:[1,0]
    v_pk_mul_f32 v[154:155], v[154:155], v[24:25] op_sel_hi:[1,0]
    v_cvt_pk_bf16_f32 v136, v136, v137
    v_cvt_pk_bf16_f32 v137, v138, v139
    v_cvt_pk_bf16_f32 v138, v152, v153
    v_cvt_pk_bf16_f32 v139, v154, v155
    buffer_store_dwordx4 v[136:139], v10, s[40:43], s53 offen offset:2048 sc1
    v_accvgpr_read_b32 v24, a236
    v_rcp_f32 v24, v24
    v_accvgpr_read_b32 v108, a12
    v_accvgpr_read_b32 v109, a13
    v_accvgpr_read_b32 v110, a14
    v_accvgpr_read_b32 v111, a15
    v_accvgpr_read_b32 v124, a28
    v_accvgpr_read_b32 v125, a29
    v_accvgpr_read_b32 v126, a30
    v_accvgpr_read_b32 v127, a31
    v_accvgpr_read_b32 v140, a44
    v_accvgpr_read_b32 v141, a45
    v_accvgpr_read_b32 v142, a46
    v_accvgpr_read_b32 v143, a47
    v_accvgpr_read_b32 v156, a60
    v_accvgpr_read_b32 v157, a61
    v_accvgpr_read_b32 v158, a62
    v_accvgpr_read_b32 v159, a63
    v_pk_mul_f32 v[108:109], v[108:109], v[24:25] op_sel_hi:[1,0]
    v_pk_mul_f32 v[110:111], v[110:111], v[24:25] op_sel_hi:[1,0]
    v_pk_mul_f32 v[124:125], v[124:125], v[24:25] op_sel_hi:[1,0]
    v_pk_mul_f32 v[126:127], v[126:127], v[24:25] op_sel_hi:[1,0]
    v_cvt_pk_bf16_f32 v108, v108, v109
    v_cvt_pk_bf16_f32 v109, v110, v111
    v_cvt_pk_bf16_f32 v110, v124, v125
    v_cvt_pk_bf16_f32 v111, v126, v127
    buffer_store_dwordx4 v[108:111], v7, s[40:43], 0 offen offset:3072 sc1
    v_pk_mul_f32 v[140:141], v[140:141], v[24:25] op_sel_hi:[1,0]
    v_pk_mul_f32 v[142:143], v[142:143], v[24:25] op_sel_hi:[1,0]
    v_pk_mul_f32 v[156:157], v[156:157], v[24:25] op_sel_hi:[1,0]
    v_pk_mul_f32 v[158:159], v[158:159], v[24:25] op_sel_hi:[1,0]
    v_cvt_pk_bf16_f32 v140, v140, v141
    v_cvt_pk_bf16_f32 v141, v142, v143
    v_cvt_pk_bf16_f32 v142, v156, v157
    v_cvt_pk_bf16_f32 v143, v158, v159
    buffer_store_dwordx4 v[140:143], v11, s[40:43], s49 offen offset:3072 sc1
    v_accvgpr_read_b32 v108, a76
    v_accvgpr_read_b32 v109, a77
    v_accvgpr_read_b32 v110, a78
    v_accvgpr_read_b32 v111, a79
    v_accvgpr_read_b32 v124, a92
    v_accvgpr_read_b32 v125, a93
    v_accvgpr_read_b32 v126, a94
    v_accvgpr_read_b32 v127, a95
    v_accvgpr_read_b32 v140, a108
    v_accvgpr_read_b32 v141, a109
    v_accvgpr_read_b32 v142, a110
    v_accvgpr_read_b32 v143, a111
    v_accvgpr_read_b32 v156, a124
    v_accvgpr_read_b32 v157, a125
    v_accvgpr_read_b32 v158, a126
    v_accvgpr_read_b32 v159, a127
    v_pk_mul_f32 v[108:109], v[108:109], v[24:25] op_sel_hi:[1,0]
    v_pk_mul_f32 v[110:111], v[110:111], v[24:25] op_sel_hi:[1,0]
    v_pk_mul_f32 v[124:125], v[124:125], v[24:25] op_sel_hi:[1,0]
    v_pk_mul_f32 v[126:127], v[126:127], v[24:25] op_sel_hi:[1,0]
    v_cvt_pk_bf16_f32 v108, v108, v109
    v_cvt_pk_bf16_f32 v109, v110, v111
    v_cvt_pk_bf16_f32 v110, v124, v125
    v_cvt_pk_bf16_f32 v111, v126, v127
    buffer_store_dwordx4 v[108:111], v7, s[40:43], s50 offen offset:3072 sc1
    v_pk_mul_f32 v[140:141], v[140:141], v[24:25] op_sel_hi:[1,0]
    v_pk_mul_f32 v[142:143], v[142:143], v[24:25] op_sel_hi:[1,0]
    v_pk_mul_f32 v[156:157], v[156:157], v[24:25] op_sel_hi:[1,0]
    v_pk_mul_f32 v[158:159], v[158:159], v[24:25] op_sel_hi:[1,0]
    v_cvt_pk_bf16_f32 v140, v140, v141
    v_cvt_pk_bf16_f32 v141, v142, v143
    v_cvt_pk_bf16_f32 v142, v156, v157
    v_cvt_pk_bf16_f32 v143, v158, v159
    buffer_store_dwordx4 v[140:143], v11, s[40:43], s53 offen offset:3072 sc1
    s_branch L_slow_done
.section .rodata,"a"
.p2align 6
.amdhsa_kernel recurrent_scan__sliding_block_cached__geglu_ffn__prompt_kernel
  .amdhsa_next_free_vgpr 512
  .amdhsa_next_free_sgpr 102
  .amdhsa_accum_offset 256
  .amdhsa_group_segment_fixed_size 0
  .amdhsa_kernarg_size 96
  .amdhsa_user_sgpr_count 2
  .amdhsa_user_sgpr_kernarg_segment_ptr 1
  .amdhsa_system_sgpr_workgroup_id_x 1
.end_amdhsa_kernel
```
